```python
import torch

def _softmax(x, axis=-1):
    return torch.softmax(x, dim=axis)

def _gelu(x):
    return torch.nn.functional.gelu(x, approximate='tanh')

def _silu(x):
    return torch.nn.functional.silu(x)

def _sigmoid(x):
    return torch.sigmoid(x)

def _layernorm(x, axis=-1, eps=1e-05):
    m = x.mean(dim=axis, keepdim=True)
    v = x.var(dim=axis, keepdim=True, unbiased=False)
    return (x - m) / torch.sqrt(v + eps)

def _scatter_add(tgt, idx, src, axis=0):
    return tgt.clone().index_add_(axis, idx, src)

def _segment_sum(src, seg, n):
    out = torch.zeros((n,) + src.shape[1:], dtype=src.dtype)
    return out.index_add_(0, seg, src)

def _pad(x, pw):
    flat = tuple((v for pair in reversed(pw) for v in pair))
    return torch.nn.functional.pad(x, flat)
kernel_name = 'adaLN_cond__sliding_block_cached__glu_gated_bilinear__prompt'

def setup_inputs():

    _w = lambda a: (lambda t: t.to(torch.bfloat16) if t.is_floating_point() else t)(torch.as_tensor(a))

    def _A_setup():
        B, Sq, D = (1, 2048, 640)
        Hq, Hkv, Sk, Dh = (32, 32, 2048, 128)
        assert Hq % Hkv == 0, (Hq, Hkv)
        return {'x': _w((lambda *s: torch.randn(*s, dtype=torch.bfloat16) * 0.05)(B, Sq, D)), 'k_cache': _w((lambda *s: torch.randn(*s, dtype=torch.bfloat16) * 1.6)(B, Hkv, Sk, Dh)), 'v_cache': _w((lambda *s: torch.randn(*s, dtype=torch.bfloat16) * 0.8)(B, Hkv, Sk, Dh)), 'wq': _w((lambda *s: torch.randn(*s, dtype=torch.bfloat16) * 1.6)(D, Hq * Dh) * D ** (-0.5)), 'wo': _w((lambda *s: torch.randn(*s, dtype=torch.bfloat16) * 0.8)(Hq * Dh, D) * (Hq * Dh) ** (-0.5))}
    _A_in = _A_setup()

    def _B_setup():
        B, S, D, F = (1, 2048, 640, 1728)
        return {'x': _w((lambda *s: torch.randn(*s, dtype=torch.bfloat16) * 0.05)(B, S, D)), 'w_gate': _w((lambda *s: torch.randn(*s, dtype=torch.bfloat16) * 0.4)(D, F) * D ** (-0.5)), 'w_up': _w((lambda *s: torch.randn(*s, dtype=torch.bfloat16) * 0.4)(D, F) * D ** (-0.5)), 'w_down': _w((lambda *s: torch.randn(*s, dtype=torch.bfloat16) * 0.4)(F, D) * F ** (-0.5))}
    _B_in = _B_setup()
    return {'A_x': _A_in['x'], 'A_k_cache': _A_in['k_cache'], 'A_v_cache': _A_in['v_cache'], 'A_wq': _A_in['wq'], 'A_wo': _A_in['wo'], 'B_x': _B_in['x'], 'B_w_gate': _B_in['w_gate'], 'B_w_up': _B_in['w_up'], 'B_w_down': _B_in['w_down'], 'c': _w((lambda *s: torch.randn(*s, dtype=torch.bfloat16) * 0.2)(1, 640) * 8.0), 'w_mod': _w((lambda *s: torch.randn(*s, dtype=torch.bfloat16) * 0.2)(640, 6 * 640) * 640 ** (-0.5) * 8.0)}

def reference(A_x, A_k_cache, A_v_cache, A_wq, A_wo, B_x, B_w_gate, B_w_up, B_w_down, c, w_mod):

    def _A_ref(x, k_cache, v_cache, wq, wo):
        B, Sq, D = x.shape
        Hq, Dh = (32, 128)
        Hkv, Sk = (k_cache.shape[1], k_cache.shape[2])
        W = min(4096, max(256, Sk // 4))
        rep = Hq // Hkv
        q = (lambda x, *d: x.permute(*d))((x @ wq).reshape(B, Sq, Hq, Dh), 0, 2, 1, 3)
        k = (lambda x, n, axis: torch.repeat_interleave(x, n, dim=axis))(k_cache[:, :, Sk - W:, :], rep, axis=1)
        v = (lambda x, n, axis: torch.repeat_interleave(x, n, dim=axis))(v_cache[:, :, Sk - W:, :], rep, axis=1)
        scores = torch.einsum('bhqd,bhkd->bhqk', q, k) * Dh ** (-0.5)
        p = _softmax(scores, axis=-1)
        o = torch.einsum('bhqk,bhkd->bhqd', p, v)
        return (lambda x, *d: x.permute(*d))(o, 0, 2, 1, 3).reshape(B, Sq, Hq * Dh) @ wo

    def _B_ref(x, w_gate, w_up, w_down):
        g = torch.einsum('bsd,df->bsf', x, w_gate)
        u = torch.einsum('bsd,df->bsf', x, w_up)
        h = g * u
        return torch.einsum('bsf,fd->bsd', h, w_down)
    x = A_x
    mod = (_silu(c) @ w_mod).reshape(c.shape[0], 6, 1, -1)
    sa, ca, ga, sb, cb, gb = (mod[:, 0].clone(), mod[:, 1].clone(), mod[:, 2].clone(), mod[:, 3].clone(), mod[:, 4].clone(), mod[:, 5].clone())
    h = _layernorm(x, axis=-1) * (1 + ca) + sa
    x = x + ga * _A_ref(h, A_k_cache, A_v_cache, A_wq, A_wo)
    h = _layernorm(x, axis=-1) * (1 + cb) + sb
    x = x + gb * _B_ref(h, B_w_gate, B_w_up, B_w_down)
    return x
```

```asm
; @launch grid=(256,1,1) block=(256,1,1) lds=163840
.amdgcn_target "amdgcn-amd-amdhsa--gfx950"
.text
.globl adaLN_cond__sliding_block_cached__glu_gated_bilinear__prompt_kernel
.p2align 8
.type adaLN_cond__sliding_block_cached__glu_gated_bilinear__prompt_kernel,@function
adaLN_cond__sliding_block_cached__glu_gated_bilinear__prompt_kernel:
    s_cmp_ge_u32 s2, 256
    s_cbranch_scc1 L_end
    s_load_dwordx16 s[64:79], s[0:1], 0
    s_load_dwordx8 s[80:87], s[0:1], 64
    s_load_dwordx4 s[88:91], s[0:1], 96
    v_lshrrev_b32 v1, 6, v0
    v_mov_b32 v232, v0
    v_readfirstlane_b32 s60, v1
    s_getpc_b64 s[4:5]
L_pc:
    s_lshr_b32 s3, s2, 3
    s_lshl_b32 s3, s3, 11
    v_lshlrev_b32 v1, 3, v0
    v_add_u32_e64 v1, s3, v1
    v_min_u32 v1, L_codeend-L_pc-8, v1
    global_load_dwordx2 a[220:221], v1, s[4:5]
    s_lshl_b32 s3, s2, 3
    v_lshrrev_b32 v1, 5, v0
    v_add_u32 v222, s3, v1
    v_and_b32 v2, 31, v0
    v_mul_u32_u24 v222, 1280, v222
    v_lshl_add_u32 v222, v2, 3, v222
    s_and_b32 s6, s2, 3
    s_mul_i32 s6, s6, 160
    s_lshr_b32 s7, s2, 2
    s_lshl_b32 s3, s7, 7
    s_cmp_ge_u32 s2, 240
    s_cselect_b32 s3, 0x40000000, s3
    v_lshrrev_b32 v4, 3, v0
    v_add_u32 v4, s6, v4
    v_mul_u32_u24 v224, 7680, v4
    v_and_b32 v6, 7, v0
    v_lshlrev_b32 v6, 4, v6
    v_add3_u32 v224, v224, v6, s3
    v_lshlrev_b32_e64 v223, 1, v4
    s_mov_b32 s10, 2621440
    s_mov_b32 s11, 0x00020000
    s_mov_b32 s14, 1280
    s_mov_b32 s15, 0x00020000
    s_mov_b32 s18, 4915200
    s_mov_b32 s19, 0x00020000
    s_mov_b32 s98, 245760
    s_mov_b32 s99, 491520
    s_mov_b32 s100, 737280
    s_mov_b32 s101, 983040
    s_bfe_u32 s50, s2, 0x20001
    s_and_b32 s56, s2, 1
    s_lshl_b32 s56, s56, 2
    s_bfe_u32 s61, s2, 0x20003
    s_add_u32 s56, s56, s61
    s_lshr_b32 s57, s2, 5
    s_lshl_b32 s45, s50, 3
    s_add_u32 s45, s45, s57
    s_mul_i32 s43, s60, 4192
    s_add_u32 s43, s43, 29696
    v_and_b32 v7, 63, v0
    v_lshlrev_b32 v253, 4, v7
    v_lshrrev_b32 v8, 4, v7
    v_and_b32 v9, 15, v7
    v_lshlrev_b32 v10, 2, v8
    v_xor_b32 v9, v10, v9
    v_lshlrev_b32 v9, 4, v9
    v_lshl_add_u32 v9, v8, 13, v9
    s_lshl_b32 s61, s60, 17
    v_add_u32 v248, s61, v9
    v_add_u32 v249, 31728, v248
    v_add_u32 v250, 63456, v248
    v_add_u32 v251, 95184, v248
    s_waitcnt lgkmcnt(0)
    s_mov_b32 s8, s64
    s_mov_b32 s9, s65
    buffer_load_dwordx2 v[128:129], v222, s[8:11], 0 offen offset:0 nt
    buffer_load_dwordx2 v[130:131], v222, s[8:11], 0 offen offset:256 nt
    buffer_load_dwordx2 v[132:133], v222, s[8:11], 0 offen offset:512 nt
    buffer_load_dwordx2 v[134:135], v222, s[8:11], 0 offen offset:768 nt
    buffer_load_dwordx2 v[136:137], v222, s[8:11], 0 offen offset:1024 nt
    s_mov_b32 s12, s82
    s_mov_b32 s13, s83
    s_mov_b32 s16, s84
    s_mov_b32 s17, s85
    buffer_load_ushort v172, v223, s[12:15], 0 offen offset:0
    buffer_load_ushort v173, v223, s[12:15], 0 offen offset:64
    buffer_load_ushort v174, v223, s[12:15], 0 offen offset:128
    buffer_load_ushort v175, v223, s[12:15], 0 offen offset:192
    buffer_load_ushort v176, v223, s[12:15], 0 offen offset:256
    buffer_load_dwordx4 v[180:183], v224, s[16:19], 0 offen nt
    buffer_load_dwordx4 v[184:187], v224, s[16:19], s98 offen nt
    buffer_load_dwordx4 v[188:191], v224, s[16:19], s99 offen nt
    buffer_load_dwordx4 v[192:195], v224, s[16:19], s100 offen nt
    buffer_load_dwordx4 v[196:199], v224, s[16:19], s101 offen nt
    s_lshl_b32 s3, s2, 2
    s_add_u32 s3, s3, s60
    s_cmp_lg_u32 s3, 1
    s_cbranch_scc1 L_p0_noclr
    v_lshlrev_b32_e64 v10, 4, v253
    v_add_u32 v10, 458752, v10
    v_mov_b32_e64 v11, 0
    global_store_dword v10, v11, s[90:91] sc1
    v_mov_b32_e64 v12, 1
    s_waitcnt vmcnt(0)
    s_mov_b64 exec, 1
    global_store_dword v11, v12, s[88:89] sc1
    s_mov_b64 exec, -1
L_p0_noclr:
    s_lshl_b32 s61, s45, 8
    s_add_u32 s28, s70, s61
    s_addc_u32 s29, s71, 0
    s_sub_u32 s30, 5242880, s61
    s_mov_b32 s31, 0x00020000
    s_mov_b32 s32, s28
    s_mov_b32 s33, s29
    s_mov_b32 s34, s30
    s_mov_b32 s35, 0x00020000
    v_lshrrev_b32 v225, 1, v2
    v_lshlrev_b32_e64 v225, 7, v225
    v_lshl_add_u32 v225, v1, 4, v225
    v_and_b32_e64 v7, 1, v2
    v_lshl_add_u32 v225, v7, 3, v225
    v_add_u32 v225, 1280, v225
    v_lshrrev_b32 v1, 4, v0
    v_lshlrev_b32 v226, 8, v1
    v_lshl_add_u32 v226, v6, 1, v226
    v_add_u32 v226, 11520, v226
    v_lshlrev_b32 v227, 4, v0
    v_add_u32 v227, 1280, v227
    v_lshl_add_u32 v228, v1, 11, v6
    v_bfe_u32 v3, v0, 3, 1
    v_lshl_add_u32 v228, v3, 9, v228
    s_and_b32 s100, s2, 3
    s_mul_i32 s100, s100, 15360
    s_lshl_b32 s7, s7, 8
    s_add_u32 s100, s100, s7
    s_lshl_b32 s61, s56, 2
    s_add_u32 s61, s61, s60
    s_mul_i32 s62, s61, 81920
    s_add_u32 s62, s62, 1048576
    s_add_u32 s16, s90, s62
    s_addc_u32 s17, s91, 0
    s_mov_b32 s18, 81920
    s_mov_b32 s19, 0x00020000
    s_lshl_b32 s61, s61, 19
    s_lshl_b32 s62, s45, 14
    s_add_u32 s61, s61, s62
    s_add_u32 s61, s61, 35651584
    s_add_u32 s20, s90, s61
    s_addc_u32 s21, s91, 0
    s_mov_b32 s22, 16384
    s_mov_b32 s23, 0x00020000
    s_lshl_b32 s61, s45, 19
    s_add_u32 s62, s61, 354272
    s_add_u32 s12, s68, s62
    s_addc_u32 s13, s69, 0
    s_mov_b32 s14, 170016
    s_mov_b32 s15, 0x00020000
    s_add_u32 s62, s61, 380928
    s_add_u32 s8, s66, s62
    s_addc_u32 s9, s67, 0
    s_mov_b32 s10, 143360
    s_mov_b32 s11, 0x00020000
    v_and_b32 v2, 63, v0
    v_lshrrev_b32 v3, 5, v2
    v_mul_u32_u24 v3, 2080, v3
    v_bfe_u32 v4, v2, 2, 2
    v_lshl_add_u32 v3, v4, 8, v3
    v_bfe_u32 v5, v2, 4, 1
    v_lshl_add_u32 v3, v5, 5, v3
    v_and_b32_e64 v5, 1, v2
    v_lshl_add_u32 v3, v5, 4, v3
    v_bfe_u32 v5, v2, 1, 1
    v_lshl_add_u32 v3, v5, 3, v3
    v_add_u32 v3, 29696, v3
    v_xor_b32_e64 v5, 0, v4
    v_lshl_add_u32 v244, v5, 6, v3
    v_xor_b32_e64 v5, 1, v4
    v_lshl_add_u32 v245, v5, 6, v3
    v_xor_b32_e64 v5, 2, v4
    v_lshl_add_u32 v246, v5, 6, v3
    v_xor_b32_e64 v5, 3, v4
    v_lshl_add_u32 v247, v5, 6, v3
    s_lshr_b32 s61, s2, 1
    s_and_b32 s62, s2, 1
    s_lshl_b32 s63, s61, 2
    s_add_u32 s63, s63, s60
    s_mul_i32 s58, s63, 10240
    s_mul_i32 s63, s62, 640
    s_add_u32 s58, s58, s63
    s_mul_i32 s61, s2, 20
    s_add_u32 s61, s61, s60
    s_lshl_b32 s61, s61, 10
    s_add_u32 s63, s61, 31457280
    s_add_u32 s52, s90, s63
    s_addc_u32 s53, s91, 0
    s_mov_b32 s54, 17408
    s_mov_b32 s55, 0x00020000
    s_cmp_lt_u32 s2, 108
    s_cselect_b32 s54, s54, 0
    s_cselect_b32 s59, 2211840, 0
    s_and_b32 s3, s2, 7
    s_lshr_b32 s61, s2, 3
    s_mul_i32 s6, s3, 80
    s_and_b32 s62, s60, 1
    s_lshl_b32 s62, s62, 3
    s_add_u32 s6, s6, s62
    s_mul_i32 s6, s6, 3456
    s_lshl_b32 s62, s61, 7
    s_add_u32 s6, s6, s62
    s_lshl_b32 s61, s61, 2
    s_add_u32 s61, s61, s60
    s_lshl_b32 s61, s61, 10
    s_mul_i32 s5, s3, 552960
    s_add_u32 s5, s5, s61
    s_add_u32 s7, s61, 4423680
    s_lshl_b32 s63, s3, 7
    s_add_u32 s7, s7, s63
    s_mul_i32 s61, s50, 1310720
    s_lshr_b32 s48, s2, 3
    s_lshl_b32 s48, s48, 2
    s_add_u32 s48, s48, s60
    s_mul_i32 s48, s48, 10240
    s_add_u32 s48, s48, s61
    s_mul_i32 s49, s60, 40960
    s_add_u32 s49, s49, s61
    s_mul_i32 s61, s57, 160
    s_add_u32 s49, s49, s61
    s_mul_i32 s51, s60, 5120
    s_lshl_b32 s47, s56, 2
    s_add_u32 s47, s47, s60
    s_lshl_b32 s47, s47, 3
    s_add_u32 s47, s47, s57
    v_add_u32_e64 v3, 0, v2
    v_mul_u32_u24 v4, 6554, v3
    v_lshrrev_b32_e64 v4, 16, v4
    v_mul_u32_u24 v5, 160, v4
    v_lshlrev_b32 v3, 4, v3
    v_sub_u32 v3, v3, v5
    v_lshrrev_b32 v5, 2, v4
    v_xor_b32 v5, v5, v4
    v_and_b32 v5, 4, v5
    v_mul_u32_u24 v5, 5, v5
    v_xor_b32_e64 v4, v5, v4
    v_mul_u32_u24 v5, 1280, v4
    v_add_u32_e64 v5, v5, v3
    v_accvgpr_write_b32 a210, v5
    v_add_u32_e64 v3, 64, v2
    v_mul_u32_u24 v4, 6554, v3
    v_lshrrev_b32_e64 v4, 16, v4
    v_mul_u32_u24 v5, 160, v4
    v_lshlrev_b32 v3, 4, v3
    v_sub_u32 v3, v3, v5
    v_lshrrev_b32 v5, 2, v4
    v_xor_b32 v5, v5, v4
    v_and_b32 v5, 4, v5
    v_mul_u32_u24 v5, 5, v5
    v_xor_b32_e64 v4, v5, v4
    v_mul_u32_u24 v5, 1280, v4
    v_add_u32_e64 v5, v5, v3
    v_subrev_u32 v5, 1024, v5
    v_accvgpr_write_b32 a211, v5
    v_add_u32 v3, 128, v2
    v_mul_u32_u24 v4, 6554, v3
    v_lshrrev_b32_e64 v4, 16, v4
    v_mul_u32_u24 v5, 160, v4
    v_lshlrev_b32 v3, 4, v3
    v_sub_u32 v3, v3, v5
    v_lshrrev_b32 v5, 2, v4
    v_xor_b32 v5, v5, v4
    v_and_b32 v5, 4, v5
    v_mul_u32_u24 v5, 5, v5
    v_xor_b32_e64 v4, v5, v4
    v_mul_u32_u24 v5, 1280, v4
    v_add_u32_e64 v5, v5, v3
    v_subrev_u32 v5, 2048, v5
    v_accvgpr_write_b32 a212, v5
    v_add_u32 v3, 192, v2
    v_mul_u32_u24 v4, 6554, v3
    v_lshrrev_b32_e64 v4, 16, v4
    v_mul_u32_u24 v5, 160, v4
    v_lshlrev_b32 v3, 4, v3
    v_sub_u32 v3, v3, v5
    v_lshrrev_b32 v5, 2, v4
    v_xor_b32 v5, v5, v4
    v_and_b32 v5, 4, v5
    v_mul_u32_u24 v5, 5, v5
    v_xor_b32_e64 v4, v5, v4
    v_mul_u32_u24 v5, 1280, v4
    v_add_u32_e64 v5, v5, v3
    v_subrev_u32 v5, 3072, v5
    v_accvgpr_write_b32 a213, v5
    v_add_u32 v3, 256, v2
    v_mul_u32_u24 v4, 6554, v3
    v_lshrrev_b32_e64 v4, 16, v4
    v_mul_u32_u24 v5, 160, v4
    v_lshlrev_b32 v3, 4, v3
    v_sub_u32 v3, v3, v5
    v_lshrrev_b32 v5, 2, v4
    v_xor_b32 v5, v5, v4
    v_and_b32 v5, 4, v5
    v_mul_u32_u24 v5, 5, v5
    v_xor_b32_e64 v4, v5, v4
    v_mul_u32_u24 v5, 1280, v4
    v_add_u32_e64 v5, v5, v3
    v_accvgpr_write_b32 a214, v5
    v_lshrrev_b32 v3, 4, v2
    v_and_b32 v4, 15, v2
    s_lshl_b32 s61, s56, 2
    s_add_u32 s61, s61, s60
    s_lshl_b32 s61, s61, 2
    s_add_u32 s61, s61, s50
    s_lshl_b32 s61, s61, 4
    v_add_u32 v4, s61, v4
    v_mul_u32_u24 v5, 1280, v4
    v_lshl_add_u32 v5, v3, 3, v5
    s_mul_i32 s61, s57, 160
    v_add_u32 v5, s61, v5
    v_mul_u32_u24 v3, 44, v3
    v_add_u32_e64 v5, v5, v3
    v_accvgpr_write_b32 a215, v5
    v_and_b32 v3, 15, v2
    v_lshrrev_b32 v4, 5, v2
    v_lshlrev_b32_e64 v3, 4, v3
    v_lshl_add_u32 v3, v4, 9, v3
    v_bfe_u32 v4, v2, 4, 1
    v_add_u32 v4, s50, v4
    v_and_b32 v5, 1, v4
    v_lshl_add_u32 v3, v5, 8, v3
    v_bfe_u32 v5, v4, 1, 1
    v_lshl_add_u32 v254, v5, 10, v3
    v_xor_b32 v255, 1024, v254
    v_lshrrev_b32 v3, 5, v2
    v_lshlrev_b32 v3, 6, v3
    v_add_u32 v252, 1280, v3
    v_lshlrev_b32_e64 v6, 4, v0
    v_add_u32 v1, 2560, v6
    v_add_u32_e64 v7, 40, v0
    v_mov_b32 v2, 0x3e0293ee
    v_mov_b32_e64 v3, 1.0
    s_mul_i32 s3, s3, 320
    s_add_u32 s3, s3, 5120
    v_add_u32_e64 v4, s3, v6
    v_cmp_lt_u32 vcc, 159, v0
    v_add_u32 v5, 2560, v4
    v_subrev_u32 v8, 160, v0
    v_cndmask_b32 v1, v1, v5, vcc
    v_cndmask_b32 v7, v7, v8, vcc
    v_cndmask_b32 v242, v2, v3, vcc
    v_cndmask_b32 v9, v6, v4, vcc
    s_mul_i32 s3, s57, 320
    s_add_u32 s3, s3, 2240
    v_cmp_lt_u32 vcc, 179, v0
    v_add_u32_e64 v4, s3, v6
    v_add_u32 v5, 7680, v4
    v_cndmask_b32 v240, v9, v4, vcc
    v_cndmask_b32 v241, v1, v5, vcc
    v_cndmask_b32 v243, v3, 0, vcc
    v_cmp_lt_u32 vcc, 199, v0
    s_nop 1
    v_cndmask_b32 v7, v7, v0, vcc
    v_lshrrev_b32 v4, 1, v7
    v_lshlrev_b32 v4, 6, v4
    v_and_b32 v5, 1, v7
    v_lshl_add_u32 v233, v5, 4, v4
    s_add_u32 s41, s56, 0
    s_and_b32 s41, s41, 3
    s_lshl_b32 s36, s41, 19
    s_mul_i32 s41, s41, 16768
    s_add_u32 m0, s41, s43
    s_nop 0
    buffer_load_dwordx4 v248, s[28:31], s36 offen nt lds
    buffer_load_dwordx4 v249, s[28:31], s36 offen offset:1040 nt lds
    buffer_load_dwordx4 v250, s[32:35], s36 offen offset:2080 nt lds
    buffer_load_dwordx4 v251, s[32:35], s36 offen offset:3120 nt lds
    v_mov_b32 v234, 0
    s_lshr_b32 s3, s2, 3
    s_mul_i32 s3, s3, 81920
    s_bfe_u32 s61, s2, 0x10002
    s_lshl_b32 s61, s61, 10
    s_add_u32 s3, s3, s61
    s_and_b32 s61, s2, 3
    s_lshl_b32 s61, s61, 7
    s_add_u32 s3, s3, s61
    s_add_u32 s3, s3, 1048576
    s_mov_b32 s98, 32768
    s_mov_b32 s99, 65536
    s_add_u32 s24, s90, s3
    s_addc_u32 s25, s91, 0
    s_mov_b32 s26, 80896
    s_mov_b32 s27, 0x00020000
    s_mov_b32 s3, 0x3f803f80
    s_mov_b32 s101, 0xbfb8aa3b
    s_waitcnt vmcnt(14)
    v_dot2_f32_bf16 v160, v128, s3, 0
    v_dot2_f32_bf16 v161, v129, s3, 0
    v_dot2_f32_bf16 v160, v130, s3, v160
    v_dot2_f32_bf16 v161, v131, s3, v161
    v_dot2_f32_bf16 v160, v132, s3, v160
    v_dot2_f32_bf16 v161, v133, s3, v161
    v_dot2_f32_bf16 v160, v134, s3, v160
    v_dot2_f32_bf16 v161, v135, s3, v161
    v_dot2_f32_bf16 v160, v136, s3, v160
    v_dot2_f32_bf16 v161, v137, s3, v161
    s_nop 2
    v_add_f32 v160, v160, v161
    v_lshlrev_b32_e64 v140, 16, v128
    v_and_b32 v141, 0xffff0000, v128
    v_lshlrev_b32_e64 v142, 16, v129
    v_add_f32_dpp v160, v160, v160 row_ror:1 row_mask:0xf bank_mask:0xf
    v_and_b32 v143, 0xffff0000, v129
    v_lshlrev_b32_e64 v144, 16, v130
    v_add_f32_dpp v160, v160, v160 row_ror:2 row_mask:0xf bank_mask:0xf
    v_and_b32 v145, 0xffff0000, v130
    v_lshlrev_b32_e64 v146, 16, v131
    v_add_f32_dpp v160, v160, v160 row_ror:4 row_mask:0xf bank_mask:0xf
    v_and_b32 v147, 0xffff0000, v131
    v_lshlrev_b32_e64 v148, 16, v132
    v_add_f32_dpp v160, v160, v160 row_ror:8 row_mask:0xf bank_mask:0xf
    v_and_b32 v149, 0xffff0000, v132
    v_lshlrev_b32_e64 v150, 16, v133
    v_and_b32 v151, 0xffff0000, v133
    v_mov_b32 v161, v160
    v_lshlrev_b32 v152, 16, v134
    v_and_b32 v153, 0xffff0000, v134
    v_permlane16_swap_b32 v160, v161
    v_lshlrev_b32 v154, 16, v135
    v_and_b32 v155, 0xffff0000, v135
    v_add_f32 v160, v160, v161
    v_lshlrev_b32 v156, 16, v136
    v_and_b32 v157, 0xffff0000, v136
    v_mul_f32 v160, 0xbacccccd, v160
    v_lshlrev_b32_e64 v158, 16, v137
    v_and_b32 v159, 0xffff0000, v137
    v_pk_add_f32 v[166:167], v[140:141], v[160:161] op_sel_hi:[1,0]
    v_pk_mul_f32 v[164:165], v[166:167], v[166:167]
    v_pk_add_f32 v[168:169], v[142:143], v[160:161] op_sel_hi:[1,0]
    v_pk_fma_f32 v[164:165], v[168:169], v[168:169], v[164:165]
    v_pk_add_f32 v[166:167], v[144:145], v[160:161] op_sel_hi:[1,0]
    v_pk_fma_f32 v[164:165], v[166:167], v[166:167], v[164:165]
    v_pk_add_f32 v[168:169], v[146:147], v[160:161] op_sel_hi:[1,0]
    v_pk_fma_f32 v[164:165], v[168:169], v[168:169], v[164:165]
    v_pk_add_f32 v[166:167], v[148:149], v[160:161] op_sel_hi:[1,0]
    v_pk_fma_f32 v[164:165], v[166:167], v[166:167], v[164:165]
    v_pk_add_f32 v[168:169], v[150:151], v[160:161] op_sel_hi:[1,0]
    v_pk_fma_f32 v[164:165], v[168:169], v[168:169], v[164:165]
    v_pk_add_f32 v[166:167], v[152:153], v[160:161] op_sel_hi:[1,0]
    v_pk_fma_f32 v[164:165], v[166:167], v[166:167], v[164:165]
    v_pk_add_f32 v[168:169], v[154:155], v[160:161] op_sel_hi:[1,0]
    v_pk_fma_f32 v[164:165], v[168:169], v[168:169], v[164:165]
    v_pk_add_f32 v[166:167], v[156:157], v[160:161] op_sel_hi:[1,0]
    v_pk_fma_f32 v[164:165], v[166:167], v[166:167], v[164:165]
    v_pk_add_f32 v[168:169], v[158:159], v[160:161] op_sel_hi:[1,0]
    v_pk_fma_f32 v[164:165], v[168:169], v[168:169], v[164:165]
    s_waitcnt vmcnt(9)
    v_add_f32 v164, v164, v165
    v_lshlrev_b32 v172, 16, v172
    v_mul_f32 v200, s101, v172
    v_add_f32_dpp v164, v164, v164 row_ror:1 row_mask:0xf bank_mask:0xf
    v_exp_f32 v200, v200
    v_lshlrev_b32 v173, 16, v173
    v_add_f32_dpp v164, v164, v164 row_ror:2 row_mask:0xf bank_mask:0xf
    v_mul_f32 v202, s101, v173
    v_exp_f32 v202, v202
    v_add_f32_dpp v164, v164, v164 row_ror:4 row_mask:0xf bank_mask:0xf
    v_lshlrev_b32 v174, 16, v174
    v_mul_f32 v204, s101, v174
    v_add_f32_dpp v164, v164, v164 row_ror:8 row_mask:0xf bank_mask:0xf
    v_exp_f32 v204, v204
    v_lshlrev_b32 v175, 16, v175
    v_mov_b32 v165, v164
    v_mul_f32 v206, s101, v175
    v_exp_f32 v206, v206
    v_permlane16_swap_b32 v164, v165
    v_lshlrev_b32 v176, 16, v176
    v_mul_f32 v208, s101, v176
    v_add_f32 v164, v164, v165
    v_exp_f32 v208, v208
    v_add_f32_e64 v200, 1.0, v200
    v_mul_f32 v164, 0x3acccccd, v164
    v_rcp_f32 v200, v200
    v_add_f32 v202, 1.0, v202
    v_cvt_pk_bf16_f32 v164, v164, v164
    v_rcp_f32 v202, v202
    v_add_f32 v204, 1.0, v204
    v_and_b32 v164, 0xffff0000, v164
    v_rcp_f32 v204, v204
    v_add_f32 v206, 1.0, v206
    v_add_f32 v164, 0x3727c5ac, v164
    v_rcp_f32 v206, v206
    v_add_f32 v208, 1.0, v208
    v_cvt_pk_bf16_f32 v164, v164, v164
    v_rcp_f32 v208, v208
    v_mul_f32 v200, v172, v200
    v_and_b32 v164, 0xffff0000, v164
    v_cvt_pk_bf16_f32 v200, v200, v200
    v_and_b32 v200, 0xffff0000, v200
    v_sqrt_f32 v164, v164
    v_mul_f32 v202, v173, v202
    v_cvt_pk_bf16_f32 v202, v202, v202
    v_cvt_pk_bf16_f32 v160, v160, v160
    v_and_b32 v202, 0xffff0000, v202
    v_mul_f32_e64 v204, v174, v204
    v_and_b32 v160, 0xffff0000, v160
    v_cvt_pk_bf16_f32 v204, v204, v204
    v_and_b32 v204, 0xffff0000, v204
    v_cvt_pk_bf16_f32 v164, v164, v164
    v_mul_f32_e64 v206, v175, v206
    v_cvt_pk_bf16_f32 v206, v206, v206
    v_and_b32 v164, 0xffff0000, v164
    v_and_b32 v206, 0xffff0000, v206
    v_mul_f32 v208, v176, v208
    v_rcp_f32 v164, v164
    v_cvt_pk_bf16_f32 v208, v208, v208
    v_and_b32 v208, 0xffff0000, v208
    v_pk_add_f32 v[140:141], v[140:141], v[160:161] op_sel_hi:[1,0]
    v_cvt_pk_bf16_f32 v140, v140, v141
    v_and_b32 v141, 0xffff0000, v140
    v_lshlrev_b32_e64 v140, 16, v140
    v_pk_mul_f32 v[140:141], v[140:141], v[164:165] op_sel_hi:[1,0]
    v_cvt_pk_bf16_f32 v140, v140, v141
    v_and_b32 v141, 0xffff0000, v140
    v_lshlrev_b32_e64 v140, 16, v140
    v_cvt_pk_f16_f32 v128, v140, v141
    v_pk_add_f32 v[142:143], v[142:143], v[160:161] op_sel_hi:[1,0]
    v_cvt_pk_bf16_f32 v142, v142, v143
    v_and_b32 v143, 0xffff0000, v142
    v_lshlrev_b32_e64 v142, 16, v142
    v_pk_mul_f32 v[142:143], v[142:143], v[164:165] op_sel_hi:[1,0]
    v_cvt_pk_bf16_f32 v142, v142, v143
    v_and_b32 v143, 0xffff0000, v142
    v_lshlrev_b32_e64 v142, 16, v142
    v_cvt_pk_f16_f32 v129, v142, v143
    ds_write_b64 v225, v[128:129] offset:0
    v_pk_add_f32 v[144:145], v[144:145], v[160:161] op_sel_hi:[1,0]
    v_cvt_pk_bf16_f32 v144, v144, v145
    v_and_b32 v145, 0xffff0000, v144
    v_lshlrev_b32_e64 v144, 16, v144
    v_pk_mul_f32 v[144:145], v[144:145], v[164:165] op_sel_hi:[1,0]
    v_cvt_pk_bf16_f32 v144, v144, v145
    v_and_b32 v145, 0xffff0000, v144
    v_lshlrev_b32_e64 v144, 16, v144
    v_cvt_pk_f16_f32 v130, v144, v145
    v_pk_add_f32 v[146:147], v[146:147], v[160:161] op_sel_hi:[1,0]
    v_cvt_pk_bf16_f32 v146, v146, v147
    v_and_b32 v147, 0xffff0000, v146
    v_lshlrev_b32_e64 v146, 16, v146
    v_pk_mul_f32 v[146:147], v[146:147], v[164:165] op_sel_hi:[1,0]
    v_cvt_pk_bf16_f32 v146, v146, v147
    v_and_b32 v147, 0xffff0000, v146
    v_lshlrev_b32_e64 v146, 16, v146
    v_cvt_pk_f16_f32 v131, v146, v147
    ds_write_b64 v225, v[130:131] offset:2048
    v_pk_add_f32 v[148:149], v[148:149], v[160:161] op_sel_hi:[1,0]
    v_cvt_pk_bf16_f32 v148, v148, v149
    v_and_b32 v149, 0xffff0000, v148
    v_lshlrev_b32_e64 v148, 16, v148
    v_pk_mul_f32 v[148:149], v[148:149], v[164:165] op_sel_hi:[1,0]
    v_cvt_pk_bf16_f32 v148, v148, v149
    v_and_b32 v149, 0xffff0000, v148
    v_lshlrev_b32_e64 v148, 16, v148
    v_cvt_pk_f16_f32 v132, v148, v149
    v_pk_add_f32 v[150:151], v[150:151], v[160:161] op_sel_hi:[1,0]
    v_cvt_pk_bf16_f32 v150, v150, v151
    v_and_b32 v151, 0xffff0000, v150
    v_lshlrev_b32_e64 v150, 16, v150
    v_pk_mul_f32 v[150:151], v[150:151], v[164:165] op_sel_hi:[1,0]
    v_cvt_pk_bf16_f32 v150, v150, v151
    v_and_b32 v151, 0xffff0000, v150
    v_lshlrev_b32_e64 v150, 16, v150
    v_cvt_pk_f16_f32 v133, v150, v151
    ds_write_b64 v225, v[132:133] offset:4096
    v_pk_add_f32 v[152:153], v[152:153], v[160:161] op_sel_hi:[1,0]
    v_cvt_pk_bf16_f32 v152, v152, v153
    v_and_b32 v153, 0xffff0000, v152
    v_lshlrev_b32_e64 v152, 16, v152
    v_pk_mul_f32 v[152:153], v[152:153], v[164:165] op_sel_hi:[1,0]
    v_cvt_pk_bf16_f32 v152, v152, v153
    v_and_b32 v153, 0xffff0000, v152
    v_lshlrev_b32_e64 v152, 16, v152
    v_cvt_pk_f16_f32 v134, v152, v153
    v_pk_add_f32 v[154:155], v[154:155], v[160:161] op_sel_hi:[1,0]
    v_cvt_pk_bf16_f32 v154, v154, v155
    v_and_b32 v155, 0xffff0000, v154
    v_lshlrev_b32_e64 v154, 16, v154
    v_pk_mul_f32 v[154:155], v[154:155], v[164:165] op_sel_hi:[1,0]
    v_cvt_pk_bf16_f32 v154, v154, v155
    v_and_b32 v155, 0xffff0000, v154
    v_lshlrev_b32_e64 v154, 16, v154
    v_cvt_pk_f16_f32 v135, v154, v155
    ds_write_b64 v225, v[134:135] offset:6144
    v_pk_add_f32 v[156:157], v[156:157], v[160:161] op_sel_hi:[1,0]
    v_cvt_pk_bf16_f32 v156, v156, v157
    v_and_b32 v157, 0xffff0000, v156
    v_lshlrev_b32_e64 v156, 16, v156
    v_pk_mul_f32 v[156:157], v[156:157], v[164:165] op_sel_hi:[1,0]
    v_cvt_pk_bf16_f32 v156, v156, v157
    v_and_b32 v157, 0xffff0000, v156
    v_lshlrev_b32_e64 v156, 16, v156
    v_cvt_pk_f16_f32 v136, v156, v157
    v_pk_add_f32 v[158:159], v[158:159], v[160:161] op_sel_hi:[1,0]
    v_cvt_pk_bf16_f32 v158, v158, v159
    v_and_b32 v159, 0xffff0000, v158
    v_lshlrev_b32_e64 v158, 16, v158
    v_pk_mul_f32 v[158:159], v[158:159], v[164:165] op_sel_hi:[1,0]
    v_cvt_pk_bf16_f32 v158, v158, v159
    v_and_b32 v159, 0xffff0000, v158
    v_lshlrev_b32_e64 v158, 16, v158
    v_cvt_pk_f16_f32 v137, v158, v159
    ds_write_b64 v225, v[136:137] offset:8192
    s_waitcnt vmcnt(4)
    v_lshlrev_b32 v218, 16, v180
    v_and_b32 v219, 0xffff0000, v180
    v_pk_mul_f32 v[210:211], v[218:219], v[200:201] op_sel_hi:[1,0]
    v_lshlrev_b32_e64 v220, 16, v181
    v_and_b32 v221, 0xffff0000, v181
    v_pk_mul_f32 v[212:213], v[220:221], v[200:201] op_sel_hi:[1,0]
    v_lshlrev_b32_e64 v218, 16, v182
    v_and_b32 v219, 0xffff0000, v182
    v_pk_mul_f32 v[214:215], v[218:219], v[200:201] op_sel_hi:[1,0]
    v_lshlrev_b32_e64 v220, 16, v183
    v_and_b32 v221, 0xffff0000, v183
    v_pk_mul_f32 v[216:217], v[220:221], v[200:201] op_sel_hi:[1,0]
    v_lshlrev_b32_e64 v218, 16, v184
    v_and_b32 v219, 0xffff0000, v184
    v_pk_fma_f32 v[210:211], v[218:219], v[202:203], v[210:211] op_sel_hi:[1,0,1]
    v_lshlrev_b32_e64 v220, 16, v185
    v_and_b32 v221, 0xffff0000, v185
    v_pk_fma_f32 v[212:213], v[220:221], v[202:203], v[212:213] op_sel_hi:[1,0,1]
    v_lshlrev_b32_e64 v218, 16, v186
    v_and_b32 v219, 0xffff0000, v186
    v_pk_fma_f32 v[214:215], v[218:219], v[202:203], v[214:215] op_sel_hi:[1,0,1]
    v_lshlrev_b32_e64 v220, 16, v187
    v_and_b32 v221, 0xffff0000, v187
    v_pk_fma_f32 v[216:217], v[220:221], v[202:203], v[216:217] op_sel_hi:[1,0,1]
    v_lshlrev_b32_e64 v218, 16, v188
    v_and_b32 v219, 0xffff0000, v188
    v_pk_fma_f32 v[210:211], v[218:219], v[204:205], v[210:211] op_sel_hi:[1,0,1]
    v_lshlrev_b32_e64 v220, 16, v189
    v_and_b32 v221, 0xffff0000, v189
    v_pk_fma_f32 v[212:213], v[220:221], v[204:205], v[212:213] op_sel_hi:[1,0,1]
    v_lshlrev_b32_e64 v218, 16, v190
    v_and_b32 v219, 0xffff0000, v190
    v_pk_fma_f32 v[214:215], v[218:219], v[204:205], v[214:215] op_sel_hi:[1,0,1]
    v_lshlrev_b32_e64 v220, 16, v191
    v_and_b32 v221, 0xffff0000, v191
    v_pk_fma_f32 v[216:217], v[220:221], v[204:205], v[216:217] op_sel_hi:[1,0,1]
    v_lshlrev_b32_e64 v218, 16, v192
    v_and_b32 v219, 0xffff0000, v192
    v_pk_fma_f32 v[210:211], v[218:219], v[206:207], v[210:211] op_sel_hi:[1,0,1]
    v_lshlrev_b32_e64 v220, 16, v193
    v_and_b32 v221, 0xffff0000, v193
    v_pk_fma_f32 v[212:213], v[220:221], v[206:207], v[212:213] op_sel_hi:[1,0,1]
    v_lshlrev_b32_e64 v218, 16, v194
    v_and_b32 v219, 0xffff0000, v194
    v_pk_fma_f32 v[214:215], v[218:219], v[206:207], v[214:215] op_sel_hi:[1,0,1]
    v_lshlrev_b32_e64 v220, 16, v195
    v_and_b32 v221, 0xffff0000, v195
    v_pk_fma_f32 v[216:217], v[220:221], v[206:207], v[216:217] op_sel_hi:[1,0,1]
    v_lshlrev_b32_e64 v218, 16, v196
    v_and_b32 v219, 0xffff0000, v196
    v_pk_fma_f32 v[210:211], v[218:219], v[208:209], v[210:211] op_sel_hi:[1,0,1]
    v_lshlrev_b32_e64 v220, 16, v197
    v_and_b32 v221, 0xffff0000, v197
    v_pk_fma_f32 v[212:213], v[220:221], v[208:209], v[212:213] op_sel_hi:[1,0,1]
    v_lshlrev_b32_e64 v218, 16, v198
    v_and_b32 v219, 0xffff0000, v198
    v_pk_fma_f32 v[214:215], v[218:219], v[208:209], v[214:215] op_sel_hi:[1,0,1]
    v_lshlrev_b32_e64 v220, 16, v199
    v_and_b32 v221, 0xffff0000, v199
    v_pk_fma_f32 v[216:217], v[220:221], v[208:209], v[216:217] op_sel_hi:[1,0,1]
    v_and_b32 v229, 8, v232
    v_cmp_eq_u32 vcc, 0, v229
    v_add_f32_dpp v210, v210, v210 row_ror:8 row_mask:0xf bank_mask:0xf
    v_add_f32_dpp v211, v211, v211 row_ror:8 row_mask:0xf bank_mask:0xf
    v_add_f32_dpp v212, v212, v212 row_ror:8 row_mask:0xf bank_mask:0xf
    v_add_f32_dpp v213, v213, v213 row_ror:8 row_mask:0xf bank_mask:0xf
    v_add_f32_dpp v214, v214, v214 row_ror:8 row_mask:0xf bank_mask:0xf
    v_add_f32_dpp v215, v215, v215 row_ror:8 row_mask:0xf bank_mask:0xf
    v_add_f32_dpp v216, v216, v216 row_ror:8 row_mask:0xf bank_mask:0xf
    v_add_f32_dpp v217, v217, v217 row_ror:8 row_mask:0xf bank_mask:0xf
    s_and_saveexec_b64 s[92:93], vcc
    ds_write_b128 v226, v[210:213]
    ds_write_b128 v226, v[214:217] offset:16
    s_mov_b64 exec, s[92:93]
    s_waitcnt lgkmcnt(0)
    s_barrier
    ds_read_b128 v[140:143], v227 offset:0
    ds_read_b128 v[144:147], v227 offset:4096
    ds_read_b128 v[148:151], v227 offset:8192
    s_cmp_lg_u32 s60, 3
    s_cbranch_scc1 L_p0_nomod
    s_cmp_ge_u32 s2, 240
    s_cbranch_scc1 L_p0_nomod
    v_lshrrev_b32 v229, 2, v253
    v_add_u32 v230, 11520, v229
    ds_read2st64_b32 v[180:181], v230 offset0:0 offset1:1
    ds_read2st64_b32 v[182:183], v230 offset0:2 offset1:3
    ds_read2st64_b32 v[184:185], v230 offset0:4 offset1:5
    ds_read2st64_b32 v[186:187], v230 offset0:6 offset1:7
    ds_read2st64_b32 v[188:189], v230 offset0:8 offset1:9
    ds_read2st64_b32 v[190:191], v230 offset0:10 offset1:11
    ds_read2st64_b32 v[192:193], v230 offset0:12 offset1:13
    ds_read2st64_b32 v[194:195], v230 offset0:14 offset1:15
    v_add_u32_e64 v229, s100, v229
    s_waitcnt lgkmcnt(3)
    v_pk_add_f32 v[180:181], v[180:181], v[188:189]
    s_waitcnt lgkmcnt(2)
    v_pk_add_f32 v[182:183], v[182:183], v[190:191]
    s_waitcnt lgkmcnt(1)
    v_pk_add_f32 v[184:185], v[184:185], v[192:193]
    s_waitcnt lgkmcnt(0)
    v_pk_add_f32 v[186:187], v[186:187], v[194:195]
    v_pk_add_f32 v[180:181], v[180:181], v[184:185]
    v_pk_add_f32 v[182:183], v[182:183], v[186:187]
    v_pk_add_f32 v[180:181], v[180:181], v[182:183]
    v_add_f32_e64 v180, v180, v181
    global_store_dword v229, v180, s[90:91] sc1
L_p0_nomod:
    s_waitcnt lgkmcnt(0)
    buffer_store_dwordx4 v[140:143], v228, s[24:27], 0 offen sc1
    buffer_store_dwordx4 v[144:147], v228, s[24:27], s98 offen sc1
    buffer_store_dwordx4 v[148:151], v228, s[24:27], s99 offen sc1
    s_add_u32 s24, s90, 262144
    s_addc_u32 s25, s91, 0
    s_mov_b32 s26, 139264
    s_mov_b32 s27, 0x00020000
    s_cmp_lg_u32 s60, 2
    s_cbranch_scc1 L_p0_nozero
    v_lshlrev_b32 v229, 12, v253
    s_lshl_b32 s3, s2, 8
    buffer_store_dword v234, v229, s[24:27], s3 offen sc1
L_p0_nozero:
    global_load_dword v218, v234, s[88:89] sc1
    s_waitcnt vmcnt(0)
    s_barrier
    s_cmp_lg_u32 s60, 0
    s_cbranch_scc1 L_p0_nosig
    v_cmp_gt_u32 vcc, 1, v218
    s_nop 4
    s_cbranch_vccz L_p0_clr
    s_mov_b32 s94, 0
L_poll1:
    global_load_dword v218, v234, s[88:89] sc1
    s_add_u32 s94, s94, 1
    s_waitcnt vmcnt(0)
    v_cmp_gt_u32_e64 vcc, 1, v218
    s_cmp_gt_u32 s94, 65536
    s_cbranch_scc1 L_pdone1
    s_nop 2
    s_cbranch_vccz L_pdone1
    s_sleep 4
    s_branch L_poll1
L_pdone1:
L_p0_clr:
    s_and_b32 s3, s2, 31
    s_addk_i32 s3, 768
    s_lshl_b32 s63, s3, 8
    s_add_u32 s63, s63, 262144
    v_mov_b32 v229, s63
    v_mov_b32 v230, 1
    s_mov_b64 exec, 1
    global_atomic_add v229, v230, s[90:91] sc1
    s_mov_b64 exec, -1
L_p0_nosig:
    v_accvgpr_write_b32 a0, 0
    s_add_u32 s41, s56, 1
    s_and_b32 s41, s41, 3
    s_lshl_b32 s36, s41, 19
    s_mul_i32 s41, s41, 16768
    s_add_u32 m0, s41, s43
    v_accvgpr_write_b32 a1, 0
    v_accvgpr_write_b32 a2, 0
    v_accvgpr_write_b32 a3, 0
    v_accvgpr_write_b32 a4, 0
    v_accvgpr_write_b32 a5, 0
    v_accvgpr_write_b32 a6, 0
    v_accvgpr_write_b32 a7, 0
    v_accvgpr_write_b32 a8, 0
    v_accvgpr_write_b32 a9, 0
    v_accvgpr_write_b32 a10, 0
    v_accvgpr_write_b32 a11, 0
    v_accvgpr_write_b32 a12, 0
    v_accvgpr_write_b32 a13, 0
    v_accvgpr_write_b32 a14, 0
    v_accvgpr_write_b32 a15, 0
    v_accvgpr_write_b32 a16, 0
    v_accvgpr_write_b32 a17, 0
    buffer_load_dwordx4 v248, s[28:31], s36 offen nt lds
    v_accvgpr_write_b32 a18, 0
    v_accvgpr_write_b32 a19, 0
    v_accvgpr_write_b32 a20, 0
    v_accvgpr_write_b32 a21, 0
    v_accvgpr_write_b32 a22, 0
    v_accvgpr_write_b32 a23, 0
    v_accvgpr_write_b32 a24, 0
    v_accvgpr_write_b32 a25, 0
    v_accvgpr_write_b32 a26, 0
    v_accvgpr_write_b32 a27, 0
    v_accvgpr_write_b32 a28, 0
    v_accvgpr_write_b32 a29, 0
    v_accvgpr_write_b32 a30, 0
    v_accvgpr_write_b32 a31, 0
    v_accvgpr_write_b32 a32, 0
    v_accvgpr_write_b32 a33, 0
    v_accvgpr_write_b32 a34, 0
    buffer_load_dwordx4 v249, s[28:31], s36 offen offset:1040 nt lds
    v_accvgpr_write_b32 a35, 0
    v_accvgpr_write_b32 a36, 0
    v_accvgpr_write_b32 a37, 0
    v_accvgpr_write_b32 a38, 0
    v_accvgpr_write_b32 a39, 0
    v_accvgpr_write_b32 a40, 0
    v_accvgpr_write_b32 a41, 0
    v_accvgpr_write_b32 a42, 0
    v_accvgpr_write_b32 a43, 0
    v_accvgpr_write_b32 a44, 0
    v_accvgpr_write_b32 a45, 0
    v_accvgpr_write_b32 a46, 0
    v_accvgpr_write_b32 a47, 0
    v_accvgpr_write_b32 a48, 0
    v_accvgpr_write_b32 a49, 0
    v_accvgpr_write_b32 a50, 0
    v_accvgpr_write_b32 a51, 0
    buffer_load_dwordx4 v250, s[32:35], s36 offen offset:2080 nt lds
    v_accvgpr_write_b32 a52, 0
    v_accvgpr_write_b32 a53, 0
    v_accvgpr_write_b32 a54, 0
    v_accvgpr_write_b32 a55, 0
    v_accvgpr_write_b32 a56, 0
    v_accvgpr_write_b32 a57, 0
    v_accvgpr_write_b32 a58, 0
    v_accvgpr_write_b32 a59, 0
    v_accvgpr_write_b32 a60, 0
    v_accvgpr_write_b32 a61, 0
    v_accvgpr_write_b32 a62, 0
    v_accvgpr_write_b32 a63, 0
    v_accvgpr_write_b32 a64, 0
    v_accvgpr_write_b32 a65, 0
    v_accvgpr_write_b32 a66, 0
    v_accvgpr_write_b32 a67, 0
    v_accvgpr_write_b32 a68, 0
    buffer_load_dwordx4 v251, s[32:35], s36 offen offset:3120 nt lds
    v_accvgpr_write_b32 a69, 0
    v_accvgpr_write_b32 a70, 0
    v_accvgpr_write_b32 a71, 0
    v_accvgpr_write_b32 a72, 0
    v_accvgpr_write_b32 a73, 0
    v_accvgpr_write_b32 a74, 0
    v_accvgpr_write_b32 a75, 0
    v_accvgpr_write_b32 a76, 0
    v_accvgpr_write_b32 a77, 0
    v_accvgpr_write_b32 a78, 0
    v_accvgpr_write_b32 a79, 0
    v_accvgpr_write_b32 a80, 0
    v_accvgpr_write_b32 a81, 0
    v_accvgpr_write_b32 a82, 0
    v_accvgpr_write_b32 a83, 0
    v_accvgpr_write_b32 a84, 0
    v_accvgpr_write_b32 a85, 0
    s_add_u32 s41, s56, 2
    s_and_b32 s41, s41, 3
    s_lshl_b32 s36, s41, 19
    s_mul_i32 s41, s41, 16768
    s_add_u32 m0, s41, s43
    v_accvgpr_write_b32 a86, 0
    v_accvgpr_write_b32 a87, 0
    v_accvgpr_write_b32 a88, 0
    v_accvgpr_write_b32 a89, 0
    v_accvgpr_write_b32 a90, 0
    v_accvgpr_write_b32 a91, 0
    v_accvgpr_write_b32 a92, 0
    v_accvgpr_write_b32 a93, 0
    v_accvgpr_write_b32 a94, 0
    v_accvgpr_write_b32 a95, 0
    v_accvgpr_write_b32 a96, 0
    v_accvgpr_write_b32 a97, 0
    v_accvgpr_write_b32 a98, 0
    v_accvgpr_write_b32 a99, 0
    v_accvgpr_write_b32 a100, 0
    v_accvgpr_write_b32 a101, 0
    v_accvgpr_write_b32 a102, 0
    buffer_load_dwordx4 v248, s[28:31], s36 offen nt lds
    v_accvgpr_write_b32 a103, 0
    v_accvgpr_write_b32 a104, 0
    v_accvgpr_write_b32 a105, 0
    v_accvgpr_write_b32 a106, 0
    v_accvgpr_write_b32 a107, 0
    v_accvgpr_write_b32 a108, 0
    v_accvgpr_write_b32 a109, 0
    v_accvgpr_write_b32 a110, 0
    v_accvgpr_write_b32 a111, 0
    v_accvgpr_write_b32 a112, 0
    v_accvgpr_write_b32 a113, 0
    v_accvgpr_write_b32 a114, 0
    v_accvgpr_write_b32 a115, 0
    v_accvgpr_write_b32 a116, 0
    v_accvgpr_write_b32 a117, 0
    v_accvgpr_write_b32 a118, 0
    v_accvgpr_write_b32 a119, 0
    buffer_load_dwordx4 v249, s[28:31], s36 offen offset:1040 nt lds
    v_accvgpr_write_b32 a120, 0
    v_accvgpr_write_b32 a121, 0
    v_accvgpr_write_b32 a122, 0
    v_accvgpr_write_b32 a123, 0
    v_accvgpr_write_b32 a124, 0
    v_accvgpr_write_b32 a125, 0
    v_accvgpr_write_b32 a126, 0
    v_accvgpr_write_b32 a127, 0
    v_mov_b32 v0, 0
    v_mov_b32 v1, 0
    v_mov_b32 v2, 0
    v_mov_b32 v3, 0
    v_mov_b32 v4, 0
    v_mov_b32 v5, 0
    v_mov_b32 v6, 0
    v_mov_b32 v7, 0
    v_mov_b32_e64 v8, 0
    buffer_load_dwordx4 v250, s[32:35], s36 offen offset:2080 nt lds
    v_mov_b32 v9, 0
    v_mov_b32 v10, 0
    v_mov_b32 v11, 0
    v_mov_b32 v12, 0
    v_mov_b32 v13, 0
    v_mov_b32 v14, 0
    v_mov_b32 v15, 0
    v_mov_b32 v16, 0
    v_mov_b32 v17, 0
    v_mov_b32 v18, 0
    v_mov_b32 v19, 0
    v_mov_b32 v20, 0
    v_mov_b32 v21, 0
    v_mov_b32 v22, 0
    v_mov_b32 v23, 0
    v_mov_b32 v24, 0
    v_mov_b32_e64 v25, 0
    buffer_load_dwordx4 v251, s[32:35], s36 offen offset:3120 nt lds
    v_mov_b32 v26, 0
    v_mov_b32 v27, 0
    v_mov_b32 v28, 0
    v_mov_b32 v29, 0
    v_mov_b32 v30, 0
    v_mov_b32 v31, 0
    v_mov_b32 v32, 0
    v_mov_b32 v33, 0
    v_mov_b32 v34, 0
    v_mov_b32 v35, 0
    v_mov_b32 v36, 0
    v_mov_b32 v37, 0
    v_mov_b32 v38, 0
    v_mov_b32 v39, 0
    v_mov_b32 v40, 0
    v_mov_b32 v41, 0
    v_mov_b32 v42, 0
    s_add_u32 s41, s56, 3
    s_and_b32 s41, s41, 3
    s_lshl_b32 s36, s41, 19
    s_mul_i32 s41, s41, 16768
    s_add_u32 m0, s41, s43
    v_mov_b32 v43, 0
    v_mov_b32 v44, 0
    v_mov_b32 v45, 0
    v_mov_b32 v46, 0
    v_mov_b32 v47, 0
    v_mov_b32 v48, 0
    v_mov_b32 v49, 0
    v_mov_b32 v50, 0
    v_mov_b32 v51, 0
    v_mov_b32 v52, 0
    v_mov_b32 v53, 0
    v_mov_b32 v54, 0
    v_mov_b32 v55, 0
    v_mov_b32 v56, 0
    v_mov_b32 v57, 0
    v_mov_b32 v58, 0
    v_mov_b32 v59, 0
    buffer_load_dwordx4 v248, s[28:31], s36 offen nt lds
    v_mov_b32 v60, 0
    v_mov_b32 v61, 0
    v_mov_b32 v62, 0
    v_mov_b32 v63, 0
    v_mov_b32 v64, 0
    v_mov_b32 v65, 0
    v_mov_b32 v66, 0
    v_mov_b32 v67, 0
    v_mov_b32 v68, 0
    v_mov_b32 v69, 0
    v_mov_b32 v70, 0
    v_mov_b32 v71, 0
    v_mov_b32 v72, 0
    v_mov_b32 v73, 0
    v_mov_b32 v74, 0
    v_mov_b32 v75, 0
    v_mov_b32_e64 v76, 0
    buffer_load_dwordx4 v249, s[28:31], s36 offen offset:1040 nt lds
    v_mov_b32 v77, 0
    v_mov_b32 v78, 0
    v_mov_b32 v79, 0
    v_mov_b32 v80, 0
    v_mov_b32 v81, 0
    v_mov_b32 v82, 0
    v_mov_b32 v83, 0
    v_mov_b32 v84, 0
    v_mov_b32 v85, 0
    v_mov_b32 v86, 0
    v_mov_b32 v87, 0
    v_mov_b32 v88, 0
    v_mov_b32 v89, 0
    v_mov_b32 v90, 0
    v_mov_b32 v91, 0
    v_mov_b32 v92, 0
    v_mov_b32_e64 v93, 0
    buffer_load_dwordx4 v250, s[32:35], s36 offen offset:2080 nt lds
    v_mov_b32 v94, 0
    v_mov_b32 v95, 0
    v_mov_b32 v96, 0
    v_mov_b32 v97, 0
    v_mov_b32 v98, 0
    v_mov_b32 v99, 0
    v_mov_b32 v100, 0
    v_mov_b32 v101, 0
    v_mov_b32 v102, 0
    v_mov_b32 v103, 0
    v_mov_b32 v104, 0
    v_mov_b32 v105, 0
    v_mov_b32 v106, 0
    v_mov_b32 v107, 0
    v_mov_b32 v108, 0
    v_mov_b32 v109, 0
    v_mov_b32_e64 v110, 0
    buffer_load_dwordx4 v251, s[32:35], s36 offen offset:3120 nt lds
    v_mov_b32 v111, 0
    v_mov_b32 v112, 0
    v_mov_b32 v113, 0
    v_mov_b32 v114, 0
    v_mov_b32 v115, 0
    v_mov_b32 v116, 0
    v_mov_b32 v117, 0
    v_mov_b32 v118, 0
    v_mov_b32 v119, 0
    v_mov_b32 v120, 0
    v_mov_b32 v121, 0
    v_mov_b32 v122, 0
    v_mov_b32 v123, 0
    v_mov_b32 v124, 0
    v_mov_b32 v125, 0
    v_mov_b32 v126, 0
    v_mov_b32 v127, 0
    s_mov_b32 s24, s90
    s_mov_b32 s25, s91
    s_mov_b32 s26, 61440
    s_mov_b32 s27, 0x00020000
    s_mov_b32 s42, 0
    s_mov_b32 s44, 4294866688
    s_add_u32 s40, s43, 67072
    s_mov_b32 s36, 2097152
    s_mov_b32 s37, 524288
    s_mov_b32 s39, 0
    s_mov_b32 s38, 0
    s_mov_b32 s98, 15360
    s_mov_b32 s99, 30720
    s_mov_b32 s100, 46080
    s_cmp_lg_u32 s60, 0
    s_cbranch_scc1 L_p0_nopoll
    v_and_b32 v229, 31, v232
    v_lshlrev_b32 v229, 8, v229
    v_add_u32 v229, 458752, v229
    s_mov_b32 s94, 0
L_poll2:
    global_load_dword v230, v229, s[90:91] sc1
    s_add_u32 s94, s94, 1
    s_waitcnt vmcnt(0)
    v_cmp_gt_u32 vcc, 8, v230
    s_cmp_gt_u32 s94, 65536
    s_cbranch_scc1 L_pdone2
    s_nop 2
    s_cbranch_vccz L_pdone2
    s_sleep 4
    s_branch L_poll2
L_pdone2:
L_p0_nopoll:
    s_barrier
    buffer_load_dwordx4 v[192:195], v240, s[24:27], 0 offen sc1
    buffer_load_dwordx4 v[208:211], v241, s[24:27], 0 offen sc1
    buffer_load_dwordx4 v[196:199], v240, s[24:27], s98 offen sc1
    buffer_load_dwordx4 v[212:215], v241, s[24:27], s98 offen sc1
    buffer_load_dwordx4 v[200:203], v240, s[24:27], s99 offen sc1
    buffer_load_dwordx4 v[216:219], v241, s[24:27], s99 offen sc1
    buffer_load_dwordx4 v[204:207], v240, s[24:27], s100 offen sc1
    buffer_load_dwordx4 v[220:223], v241, s[24:27], s100 offen sc1
    buffer_load_dwordx4 v[128:131], v254, s[16:19], s38 offen offset:0 sc1
    buffer_load_dwordx4 v[132:135], v255, s[16:19], s38 offen offset:0 sc1
    buffer_load_dwordx4 v[136:139], v254, s[16:19], s38 offen offset:2048 sc1
    buffer_load_dwordx4 v[140:143], v255, s[16:19], s38 offen offset:2048 sc1
    s_addk_i32 s38, 4096
    s_waitcnt vmcnt(4)
    v_pk_add_f32 v[192:193], v[192:193], v[196:197]
    v_pk_add_f32 v[194:195], v[194:195], v[198:199]
    v_pk_add_f32 v[200:201], v[200:201], v[204:205]
    v_pk_add_f32 v[202:203], v[202:203], v[206:207]
    v_pk_add_f32 v[192:193], v[192:193], v[200:201]
    v_pk_add_f32 v[194:195], v[194:195], v[202:203]
    v_pk_add_f32 v[208:209], v[208:209], v[212:213]
    v_pk_add_f32 v[210:211], v[210:211], v[214:215]
    v_pk_add_f32 v[216:217], v[216:217], v[220:221]
    v_pk_add_f32 v[218:219], v[218:219], v[222:223]
    v_pk_add_f32 v[208:209], v[208:209], v[216:217]
    v_pk_add_f32 v[210:211], v[210:211], v[218:219]
    v_cvt_pk_bf16_f32 v192, v192, v193
    v_and_b32 v193, 0xffff0000, v192
    v_lshlrev_b32_e64 v192, 16, v192
    v_cvt_pk_bf16_f32 v194, v194, v195
    v_and_b32 v195, 0xffff0000, v194
    v_lshlrev_b32_e64 v194, 16, v194
    v_cvt_pk_bf16_f32 v208, v208, v209
    v_and_b32 v209, 0xffff0000, v208
    v_lshlrev_b32_e64 v208, 16, v208
    v_cvt_pk_bf16_f32 v210, v210, v211
    v_and_b32 v211, 0xffff0000, v210
    v_lshlrev_b32 v210, 16, v210
    v_add_f32 v208, v243, v208
    v_add_f32 v209, v243, v209
    v_add_f32 v210, v243, v210
    v_add_f32_e64 v211, v243, v211
    v_cvt_pk_bf16_f32 v208, v208, v209
    v_and_b32 v209, 0xffff0000, v208
    v_lshlrev_b32_e64 v208, 16, v208
    v_cvt_pk_bf16_f32 v210, v210, v211
    v_and_b32 v211, 0xffff0000, v210
    v_lshlrev_b32_e64 v210, 16, v210
    v_pk_mul_f32 v[192:193], v[192:193], v[242:243] op_sel_hi:[1,0]
    v_pk_mul_f32 v[194:195], v[194:195], v[242:243] op_sel_hi:[1,0]
    v_pk_mul_f32 v[208:209], v[208:209], v[242:243] op_sel_hi:[1,0]
    v_pk_mul_f32 v[210:211], v[210:211], v[242:243] op_sel_hi:[1,0]
    ds_write_b128 v233, v[208:211]
    ds_write_b128 v233, v[192:195] offset:32
    buffer_load_dwordx4 v[144:147], v254, s[16:19], s38 offen offset:0 sc1
    buffer_load_dwordx4 v[148:151], v255, s[16:19], s38 offen offset:0 sc1
    buffer_load_dwordx4 v[152:155], v254, s[16:19], s38 offen offset:2048 sc1
    buffer_load_dwordx4 v[156:159], v255, s[16:19], s38 offen offset:2048 sc1
    s_add_u32 s38, s38, 4096
    s_waitcnt lgkmcnt(0)
    s_barrier
    ds_read_b128 v[192:195], v252 offset:0
    ds_read_b128 v[196:199], v252 offset:16
    ds_read_b128 v[200:203], v252 offset:32
    ds_read_b128 v[204:207], v252 offset:48
    ds_read_b64_tr_b16 a[128:129], v244 offset:0
    ds_read_b64_tr_b16 a[130:131], v244 offset:1040
    ds_read_b64_tr_b16 a[132:133], v245 offset:0
    ds_read_b64_tr_b16 a[134:135], v245 offset:1040
    ds_read_b64_tr_b16 a[136:137], v246 offset:0
    ds_read_b64_tr_b16 a[138:139], v246 offset:1040
    ds_read_b64_tr_b16 a[140:141], v247 offset:0
    ds_read_b64_tr_b16 a[142:143], v247 offset:1040
    ds_read_b128 v[208:211], v252 offset:128
    ds_read_b128 v[212:215], v252 offset:144
    ds_read_b128 v[216:219], v252 offset:160
    ds_read_b128 v[220:223], v252 offset:176
    ds_read_b64_tr_b16 a[144:145], v244 offset:4192
    ds_read_b64_tr_b16 a[146:147], v244 offset:5232
    ds_read_b64_tr_b16 a[148:149], v245 offset:4192
    ds_read_b64_tr_b16 a[150:151], v245 offset:5232
    ds_read_b64_tr_b16 a[152:153], v246 offset:4192
    ds_read_b64_tr_b16 a[154:155], v246 offset:5232
    ds_read_b64_tr_b16 a[156:157], v247 offset:4192
    ds_read_b64_tr_b16 a[158:159], v247 offset:5232
    buffer_load_dwordx4 v[160:163], v254, s[16:19], s38 offen offset:0 sc1
    buffer_load_dwordx4 v[164:167], v255, s[16:19], s38 offen offset:0 sc1
    buffer_load_dwordx4 v[168:171], v254, s[16:19], s38 offen offset:2048 sc1
    buffer_load_dwordx4 v[172:175], v255, s[16:19], s38 offen offset:2048 sc1
    s_add_u32 s38, s38, 4096
    buffer_load_dwordx4 v[176:179], v254, s[16:19], s38 offen offset:0 sc1
    buffer_load_dwordx4 v[180:183], v255, s[16:19], s38 offen offset:0 sc1
    buffer_load_dwordx4 v[184:187], v254, s[16:19], s38 offen offset:2048 sc1
    buffer_load_dwordx4 v[188:191], v255, s[16:19], s38 offen offset:2048 sc1
    s_add_u32 s38, s38, 4096
    s_waitcnt vmcnt(15) lgkmcnt(15)
    v_fma_mix_f32 v240, v128, v192, v200 op_sel_hi:[1,0,0]
    v_fma_mix_f32 v241, v128, v193, v201 op_sel:[1,0,0] op_sel_hi:[1,0,0]
    v_cvt_pk_bf16_f32 v224, v240, v241
    v_fma_mix_f32 v242, v129, v194, v202 op_sel_hi:[1,0,0]
    v_fma_mix_f32 v243, v129, v195, v203 op_sel:[1,0,0] op_sel_hi:[1,0,0]
    v_cvt_pk_bf16_f32 v225, v242, v243
    v_fma_mix_f32 v240, v130, v196, v204 op_sel_hi:[1,0,0]
    v_fma_mix_f32 v241, v130, v197, v205 op_sel:[1,0,0] op_sel_hi:[1,0,0]
    v_cvt_pk_bf16_f32 v226, v240, v241
    v_fma_mix_f32 v242, v131, v198, v206 op_sel_hi:[1,0,0]
    v_fma_mix_f32 v243, v131, v199, v207 op_sel:[1,0,0] op_sel_hi:[1,0,0]
    v_cvt_pk_bf16_f32 v227, v242, v243
    s_waitcnt vmcnt(14)
    v_fma_mix_f32 v240, v132, v192, v200 op_sel_hi:[1,0,0]
    v_fma_mix_f32 v241, v132, v193, v201 op_sel:[1,0,0] op_sel_hi:[1,0,0]
    v_cvt_pk_bf16_f32 v228, v240, v241
    v_fma_mix_f32 v242, v133, v194, v202 op_sel_hi:[1,0,0]
    v_fma_mix_f32 v243, v133, v195, v203 op_sel:[1,0,0] op_sel_hi:[1,0,0]
    v_cvt_pk_bf16_f32 v229, v242, v243
    v_fma_mix_f32 v240, v134, v196, v204 op_sel_hi:[1,0,0]
    v_fma_mix_f32 v241, v134, v197, v205 op_sel:[1,0,0] op_sel_hi:[1,0,0]
    v_cvt_pk_bf16_f32 v230, v240, v241
    v_fma_mix_f32 v242, v135, v198, v206 op_sel_hi:[1,0,0]
    v_fma_mix_f32 v243, v135, v199, v207 op_sel:[1,0,0] op_sel_hi:[1,0,0]
    v_cvt_pk_bf16_f32 v231, v242, v243
    s_waitcnt vmcnt(12) lgkmcnt(8)
    s_mov_b32 m0, s40
L_qp:
    v_mfma_f32_32x32x16_bf16 v[0:15], a[128:131], v[224:227], v[0:15]
    ds_read_b128 v[192:195], v252 offset:256
    ds_read_b128 v[196:199], v252 offset:272
    v_fma_mix_f32 v240, v136, v208, v216 op_sel_hi:[1,0,0]
    v_fma_mix_f32 v241, v136, v209, v217 op_sel:[1,0,0] op_sel_hi:[1,0,0]
    v_cvt_pk_bf16_f32 v232, v240, v241
    v_mfma_f32_32x32x16_bf16 v[16:31], a[128:131], v[228:231], v[16:31]
    ds_read_b128 v[200:203], v252 offset:288
    ds_read_b128 v[204:207], v252 offset:304
    v_fma_mix_f32 v242, v137, v210, v218 op_sel_hi:[1,0,0]
    v_fma_mix_f32 v243, v137, v211, v219 op_sel:[1,0,0] op_sel_hi:[1,0,0]
    v_cvt_pk_bf16_f32 v233, v242, v243
    v_mfma_f32_32x32x16_bf16 v[32:47], a[132:135], v[224:227], v[32:47]
    buffer_load_dwordx4 v[128:131], v254, s[16:19], s38 offen offset:0 sc1
    ds_read_b64_tr_b16 a[160:161], v244 offset:8384
    v_fma_mix_f32 v240, v138, v212, v220 op_sel_hi:[1,0,0]
    v_fma_mix_f32 v241, v138, v213, v221 op_sel:[1,0,0] op_sel_hi:[1,0,0]
    v_cvt_pk_bf16_f32 v234, v240, v241
    v_mfma_f32_32x32x16_bf16 v[48:63], a[132:135], v[228:231], v[48:63]
    ds_read_b64_tr_b16 a[162:163], v244 offset:9424
    ds_read_b64_tr_b16 a[164:165], v245 offset:8384
    v_fma_mix_f32 v242, v139, v214, v222 op_sel_hi:[1,0,0]
    v_fma_mix_f32 v243, v139, v215, v223 op_sel:[1,0,0] op_sel_hi:[1,0,0]
    v_cvt_pk_bf16_f32 v235, v242, v243
    v_mfma_f32_32x32x16_bf16 v[64:79], a[136:139], v[224:227], v[64:79]
    buffer_load_dwordx4 v[132:135], v255, s[16:19], s38 offen offset:0 sc1
    ds_read_b64_tr_b16 a[166:167], v245 offset:9424
    v_fma_mix_f32 v240, v140, v208, v216 op_sel_hi:[1,0,0]
    v_fma_mix_f32 v241, v140, v209, v217 op_sel:[1,0,0] op_sel_hi:[1,0,0]
    v_cvt_pk_bf16_f32 v236, v240, v241
    v_mfma_f32_32x32x16_bf16 v[80:95], a[136:139], v[228:231], v[80:95]
    ds_read_b64_tr_b16 a[168:169], v246 offset:8384
    ds_read_b64_tr_b16 a[170:171], v246 offset:9424
    v_fma_mix_f32 v242, v141, v210, v218 op_sel_hi:[1,0,0]
    v_fma_mix_f32 v243, v141, v211, v219 op_sel:[1,0,0] op_sel_hi:[1,0,0]
    v_cvt_pk_bf16_f32 v237, v242, v243
    v_mfma_f32_32x32x16_bf16 v[96:111], a[140:143], v[224:227], v[96:111]
    ds_read_b64_tr_b16 a[172:173], v247 offset:8384
    buffer_load_dwordx4 v248, s[28:31], s36 offen nt lds
    v_fma_mix_f32 v240, v142, v212, v220 op_sel_hi:[1,0,0]
    v_fma_mix_f32 v241, v142, v213, v221 op_sel:[1,0,0] op_sel_hi:[1,0,0]
    v_cvt_pk_bf16_f32 v238, v240, v241
    v_mfma_f32_32x32x16_bf16 v[112:127], a[140:143], v[228:231], v[112:127]
    ds_read_b64_tr_b16 a[174:175], v247 offset:9424
    s_waitcnt vmcnt(13) lgkmcnt(8)
    s_add_u32 s42, s42, 1
    v_fma_mix_f32 v242, v143, v214, v222 op_sel_hi:[1,0,0]
    v_fma_mix_f32 v243, v143, v215, v223 op_sel:[1,0,0] op_sel_hi:[1,0,0]
    v_cvt_pk_bf16_f32 v239, v242, v243
    v_mfma_f32_32x32x16_bf16 v[0:15], a[144:147], v[232:235], v[0:15]
    ds_read_b128 v[208:211], v252 offset:384
    ds_read_b128 v[212:215], v252 offset:400
    v_fma_mix_f32 v240, v144, v192, v200 op_sel_hi:[1,0,0]
    v_fma_mix_f32 v241, v144, v193, v201 op_sel:[1,0,0] op_sel_hi:[1,0,0]
    v_cvt_pk_bf16_f32 v224, v240, v241
    v_mfma_f32_32x32x16_bf16 v[16:31], a[144:147], v[236:239], v[16:31]
    ds_read_b128 v[216:219], v252 offset:416
    ds_read_b128 v[220:223], v252 offset:432
    v_fma_mix_f32 v242, v145, v194, v202 op_sel_hi:[1,0,0]
    v_fma_mix_f32 v243, v145, v195, v203 op_sel:[1,0,0] op_sel_hi:[1,0,0]
    v_cvt_pk_bf16_f32 v225, v242, v243
    v_mfma_f32_32x32x16_bf16 v[32:47], a[148:151], v[232:235], v[32:47]
    buffer_load_dwordx4 v[136:139], v254, s[16:19], s38 offen offset:2048 sc1
    ds_read_b64_tr_b16 a[176:177], v244 offset:12576
    v_fma_mix_f32 v240, v146, v196, v204 op_sel_hi:[1,0,0]
    v_fma_mix_f32 v241, v146, v197, v205 op_sel:[1,0,0] op_sel_hi:[1,0,0]
    v_cvt_pk_bf16_f32 v226, v240, v241
    v_mfma_f32_32x32x16_bf16 v[48:63], a[148:151], v[236:239], v[48:63]
    ds_read_b64_tr_b16 a[178:179], v244 offset:13616
    ds_read_b64_tr_b16 a[180:181], v245 offset:12576
    v_fma_mix_f32 v242, v147, v198, v206 op_sel_hi:[1,0,0]
    v_fma_mix_f32 v243, v147, v199, v207 op_sel:[1,0,0] op_sel_hi:[1,0,0]
    v_cvt_pk_bf16_f32 v227, v242, v243
    v_fma_mix_f32 v240, v148, v192, v200 op_sel_hi:[1,0,0]
    v_mfma_f32_32x32x16_bf16 v[64:79], a[152:155], v[232:235], v[64:79]
    buffer_load_dwordx4 v[140:143], v255, s[16:19], s38 offen offset:2048 sc1
    ds_read_b64_tr_b16 a[182:183], v245 offset:13616
    v_fma_mix_f32 v241, v148, v193, v201 op_sel:[1,0,0] op_sel_hi:[1,0,0]
    v_cvt_pk_bf16_f32 v228, v240, v241
    v_fma_mix_f32 v242, v149, v194, v202 op_sel_hi:[1,0,0]
    v_mfma_f32_32x32x16_bf16 v[80:95], a[152:155], v[236:239], v[80:95]
    ds_read_b64_tr_b16 a[184:185], v246 offset:12576
    ds_read_b64_tr_b16 a[186:187], v246 offset:13616
    v_fma_mix_f32 v243, v149, v195, v203 op_sel:[1,0,0] op_sel_hi:[1,0,0]
    v_cvt_pk_bf16_f32 v229, v242, v243
    v_fma_mix_f32 v240, v150, v196, v204 op_sel_hi:[1,0,0]
    v_fma_mix_f32 v241, v150, v197, v205 op_sel:[1,0,0] op_sel_hi:[1,0,0]
    v_mfma_f32_32x32x16_bf16 v[96:111], a[156:159], v[232:235], v[96:111]
    ds_read_b64_tr_b16 a[188:189], v247 offset:12576
    buffer_load_dwordx4 v249, s[28:31], s36 offen offset:1040 nt lds
    v_cvt_pk_bf16_f32 v230, v240, v241
    v_fma_mix_f32 v242, v151, v198, v206 op_sel_hi:[1,0,0]
    v_fma_mix_f32 v243, v151, v199, v207 op_sel:[1,0,0] op_sel_hi:[1,0,0]
    v_mfma_f32_32x32x16_bf16 v[112:127], a[156:159], v[236:239], v[112:127]
    ds_read_b64_tr_b16 a[190:191], v247 offset:13616
    buffer_load_dwordx4 v250, s[32:35], s36 offen offset:2080 nt lds
    s_waitcnt vmcnt(15) lgkmcnt(8)
    s_addk_i32 s38, 4096
    v_cvt_pk_bf16_f32 v231, v242, v243
    v_mfma_f32_32x32x16_bf16 v[0:15], a[160:163], v[224:227], v[0:15]
    ds_read_b128 v[192:195], v252 offset:512
    ds_read_b128 v[196:199], v252 offset:528
    v_fma_mix_f32 v240, v152, v208, v216 op_sel_hi:[1,0,0]
    v_fma_mix_f32 v241, v152, v209, v217 op_sel:[1,0,0] op_sel_hi:[1,0,0]
    v_cvt_pk_bf16_f32 v232, v240, v241
    v_mfma_f32_32x32x16_bf16 v[16:31], a[160:163], v[228:231], v[16:31]
    ds_read_b128 v[200:203], v252 offset:544
    ds_read_b128 v[204:207], v252 offset:560
    v_fma_mix_f32 v242, v153, v210, v218 op_sel_hi:[1,0,0]
    v_fma_mix_f32 v243, v153, v211, v219 op_sel:[1,0,0] op_sel_hi:[1,0,0]
    v_cvt_pk_bf16_f32 v233, v242, v243
    v_mfma_f32_32x32x16_bf16 v[32:47], a[164:167], v[224:227], v[32:47]
    buffer_load_dwordx4 v[144:147], v254, s[16:19], s38 offen offset:0 sc1
    ds_read_b64_tr_b16 a[128:129], v244 offset:16768
    v_fma_mix_f32 v240, v154, v212, v220 op_sel_hi:[1,0,0]
    v_fma_mix_f32 v241, v154, v213, v221 op_sel:[1,0,0] op_sel_hi:[1,0,0]
    v_cvt_pk_bf16_f32 v234, v240, v241
    v_mfma_f32_32x32x16_bf16 v[48:63], a[164:167], v[228:231], v[48:63]
    ds_read_b64_tr_b16 a[130:131], v244 offset:17808
    ds_read_b64_tr_b16 a[132:133], v245 offset:16768
    v_fma_mix_f32 v242, v155, v214, v222 op_sel_hi:[1,0,0]
    v_fma_mix_f32 v243, v155, v215, v223 op_sel:[1,0,0] op_sel_hi:[1,0,0]
    v_cvt_pk_bf16_f32 v235, v242, v243
    v_mfma_f32_32x32x16_bf16 v[64:79], a[168:171], v[224:227], v[64:79]
    buffer_load_dwordx4 v[148:151], v255, s[16:19], s38 offen offset:0 sc1
    ds_read_b64_tr_b16 a[134:135], v245 offset:17808
    v_fma_mix_f32 v240, v156, v208, v216 op_sel_hi:[1,0,0]
    v_fma_mix_f32 v241, v156, v209, v217 op_sel:[1,0,0] op_sel_hi:[1,0,0]
    v_cvt_pk_bf16_f32 v236, v240, v241
    v_mfma_f32_32x32x16_bf16 v[80:95], a[168:171], v[228:231], v[80:95]
    ds_read_b64_tr_b16 a[136:137], v246 offset:16768
    ds_read_b64_tr_b16 a[138:139], v246 offset:17808
    v_fma_mix_f32 v242, v157, v210, v218 op_sel_hi:[1,0,0]
    v_fma_mix_f32 v243, v157, v211, v219 op_sel:[1,0,0] op_sel_hi:[1,0,0]
    v_cvt_pk_bf16_f32 v237, v242, v243
    v_fma_mix_f32 v240, v158, v212, v220 op_sel_hi:[1,0,0]
    v_mfma_f32_32x32x16_bf16 v[96:111], a[172:175], v[224:227], v[96:111]
    ds_read_b64_tr_b16 a[140:141], v247 offset:16768
    buffer_load_dwordx4 v251, s[32:35], s36 offen offset:3120 nt lds
    v_fma_mix_f32 v241, v158, v213, v221 op_sel:[1,0,0] op_sel_hi:[1,0,0]
    v_cvt_pk_bf16_f32 v238, v240, v241
    v_fma_mix_f32 v242, v159, v214, v222 op_sel_hi:[1,0,0]
    v_mfma_f32_32x32x16_bf16 v[112:127], a[172:175], v[228:231], v[112:127]
    ds_read_b64_tr_b16 a[142:143], v247 offset:17808
    s_waitcnt vmcnt(16) lgkmcnt(8)
    s_add_u32 s36, s36, s37
    s_add_u32 m0, m0, 16768
    v_fma_mix_f32 v243, v159, v215, v223 op_sel:[1,0,0] op_sel_hi:[1,0,0]
    v_cvt_pk_bf16_f32 v239, v242, v243
    v_mfma_f32_32x32x16_bf16 v[0:15], a[176:179], v[232:235], v[0:15]
    ds_read_b128 v[208:211], v252 offset:640
    ds_read_b128 v[212:215], v252 offset:656
    v_fma_mix_f32 v240, v160, v192, v200 op_sel_hi:[1,0,0]
    v_fma_mix_f32 v241, v160, v193, v201 op_sel:[1,0,0] op_sel_hi:[1,0,0]
    v_cvt_pk_bf16_f32 v224, v240, v241
    v_mfma_f32_32x32x16_bf16 v[16:31], a[176:179], v[236:239], v[16:31]
    ds_read_b128 v[216:219], v252 offset:672
    ds_read_b128 v[220:223], v252 offset:688
    v_fma_mix_f32 v242, v161, v194, v202 op_sel_hi:[1,0,0]
    v_fma_mix_f32 v243, v161, v195, v203 op_sel:[1,0,0] op_sel_hi:[1,0,0]
    v_cvt_pk_bf16_f32 v225, v242, v243
    v_mfma_f32_32x32x16_bf16 v[32:47], a[180:183], v[232:235], v[32:47]
    buffer_load_dwordx4 v[152:155], v254, s[16:19], s38 offen offset:2048 sc1
    ds_read_b64_tr_b16 a[144:145], v244 offset:20960
    v_fma_mix_f32 v240, v162, v196, v204 op_sel_hi:[1,0,0]
    v_fma_mix_f32 v241, v162, v197, v205 op_sel:[1,0,0] op_sel_hi:[1,0,0]
    v_cvt_pk_bf16_f32 v226, v240, v241
    v_mfma_f32_32x32x16_bf16 v[48:63], a[180:183], v[236:239], v[48:63]
    ds_read_b64_tr_b16 a[146:147], v244 offset:22000
    ds_read_b64_tr_b16 a[148:149], v245 offset:20960
    v_fma_mix_f32 v242, v163, v198, v206 op_sel_hi:[1,0,0]
    v_fma_mix_f32 v243, v163, v199, v207 op_sel:[1,0,0] op_sel_hi:[1,0,0]
    v_cvt_pk_bf16_f32 v227, v242, v243
    v_mfma_f32_32x32x16_bf16 v[64:79], a[184:187], v[232:235], v[64:79]
    buffer_load_dwordx4 v[156:159], v255, s[16:19], s38 offen offset:2048 sc1
    ds_read_b64_tr_b16 a[150:151], v245 offset:22000
    v_fma_mix_f32 v240, v164, v192, v200 op_sel_hi:[1,0,0]
    v_fma_mix_f32 v241, v164, v193, v201 op_sel:[1,0,0] op_sel_hi:[1,0,0]
    v_cvt_pk_bf16_f32 v228, v240, v241
    v_mfma_f32_32x32x16_bf16 v[80:95], a[184:187], v[236:239], v[80:95]
    ds_read_b64_tr_b16 a[152:153], v246 offset:20960
    ds_read_b64_tr_b16 a[154:155], v246 offset:22000
    v_fma_mix_f32 v242, v165, v194, v202 op_sel_hi:[1,0,0]
    v_fma_mix_f32 v243, v165, v195, v203 op_sel:[1,0,0] op_sel_hi:[1,0,0]
    v_cvt_pk_bf16_f32 v229, v242, v243
    v_mfma_f32_32x32x16_bf16 v[96:111], a[188:191], v[232:235], v[96:111]
    ds_read_b64_tr_b16 a[156:157], v247 offset:20960
    buffer_load_dwordx4 v248, s[28:31], s36 offen nt lds
    v_fma_mix_f32 v240, v166, v196, v204 op_sel_hi:[1,0,0]
    v_fma_mix_f32 v241, v166, v197, v205 op_sel:[1,0,0] op_sel_hi:[1,0,0]
    v_cvt_pk_bf16_f32 v230, v240, v241
    v_mfma_f32_32x32x16_bf16 v[112:127], a[188:191], v[236:239], v[112:127]
    ds_read_b64_tr_b16 a[158:159], v247 offset:22000
    s_waitcnt vmcnt(17) lgkmcnt(8)
    s_addk_i32 s38, 4096
    v_fma_mix_f32 v242, v167, v198, v206 op_sel_hi:[1,0,0]
    v_fma_mix_f32 v243, v167, v199, v207 op_sel:[1,0,0] op_sel_hi:[1,0,0]
    v_cvt_pk_bf16_f32 v231, v242, v243
    v_mfma_f32_32x32x16_bf16 v[0:15], a[128:131], v[224:227], v[0:15]
    ds_read_b128 v[192:195], v252 offset:768
    ds_read_b128 v[196:199], v252 offset:784
    v_fma_mix_f32 v240, v168, v208, v216 op_sel_hi:[1,0,0]
    v_fma_mix_f32 v241, v168, v209, v217 op_sel:[1,0,0] op_sel_hi:[1,0,0]
    v_cvt_pk_bf16_f32 v232, v240, v241
    v_mfma_f32_32x32x16_bf16 v[16:31], a[128:131], v[228:231], v[16:31]
    ds_read_b128 v[200:203], v252 offset:800
    ds_read_b128 v[204:207], v252 offset:816
    v_fma_mix_f32 v242, v169, v210, v218 op_sel_hi:[1,0,0]
    v_fma_mix_f32 v243, v169, v211, v219 op_sel:[1,0,0] op_sel_hi:[1,0,0]
    v_cvt_pk_bf16_f32 v233, v242, v243
    v_fma_mix_f32 v240, v170, v212, v220 op_sel_hi:[1,0,0]
    v_mfma_f32_32x32x16_bf16 v[32:47], a[132:135], v[224:227], v[32:47]
    buffer_load_dwordx4 v[160:163], v254, s[16:19], s38 offen offset:0 sc1
    ds_read_b64_tr_b16 a[160:161], v244 offset:25152
    v_fma_mix_f32 v241, v170, v213, v221 op_sel:[1,0,0] op_sel_hi:[1,0,0]
    v_cvt_pk_bf16_f32 v234, v240, v241
    v_fma_mix_f32 v242, v171, v214, v222 op_sel_hi:[1,0,0]
    v_mfma_f32_32x32x16_bf16 v[48:63], a[132:135], v[228:231], v[48:63]
    ds_read_b64_tr_b16 a[162:163], v244 offset:26192
    ds_read_b64_tr_b16 a[164:165], v245 offset:25152
    v_fma_mix_f32 v243, v171, v215, v223 op_sel:[1,0,0] op_sel_hi:[1,0,0]
    v_cvt_pk_bf16_f32 v235, v242, v243
    v_fma_mix_f32 v240, v172, v208, v216 op_sel_hi:[1,0,0]
    v_fma_mix_f32 v241, v172, v209, v217 op_sel:[1,0,0] op_sel_hi:[1,0,0]
    v_mfma_f32_32x32x16_bf16 v[64:79], a[136:139], v[224:227], v[64:79]
    buffer_load_dwordx4 v[164:167], v255, s[16:19], s38 offen offset:0 sc1
    ds_read_b64_tr_b16 a[166:167], v245 offset:26192
    v_cvt_pk_bf16_f32 v236, v240, v241
    v_fma_mix_f32 v242, v173, v210, v218 op_sel_hi:[1,0,0]
    v_fma_mix_f32 v243, v173, v211, v219 op_sel:[1,0,0] op_sel_hi:[1,0,0]
    v_mfma_f32_32x32x16_bf16 v[80:95], a[136:139], v[228:231], v[80:95]
    ds_read_b64_tr_b16 a[168:169], v246 offset:25152
    ds_read_b64_tr_b16 a[170:171], v246 offset:26192
    v_cvt_pk_bf16_f32 v237, v242, v243
    v_fma_mix_f32 v240, v174, v212, v220 op_sel_hi:[1,0,0]
    v_fma_mix_f32 v241, v174, v213, v221 op_sel:[1,0,0] op_sel_hi:[1,0,0]
    v_cvt_pk_bf16_f32 v238, v240, v241
    v_mfma_f32_32x32x16_bf16 v[96:111], a[140:143], v[224:227], v[96:111]
    ds_read_b64_tr_b16 a[172:173], v247 offset:25152
    buffer_load_dwordx4 v249, s[28:31], s36 offen offset:1040 nt lds
    v_fma_mix_f32 v242, v175, v214, v222 op_sel_hi:[1,0,0]
    v_fma_mix_f32 v243, v175, v215, v223 op_sel:[1,0,0] op_sel_hi:[1,0,0]
    v_cvt_pk_bf16_f32 v239, v242, v243
    v_mfma_f32_32x32x16_bf16 v[112:127], a[140:143], v[228:231], v[112:127]
    ds_read_b64_tr_b16 a[174:175], v247 offset:26192
    buffer_load_dwordx4 v250, s[32:35], s36 offen offset:2080 nt lds
    s_waitcnt vmcnt(19) lgkmcnt(8)
    s_and_b32 s42, s42, 3
    s_cselect_b32 s41, 33536, s44
    v_mfma_f32_32x32x16_bf16 v[0:15], a[144:147], v[232:235], v[0:15]
    ds_read_b128 v[208:211], v252 offset:896
    ds_read_b128 v[212:215], v252 offset:912
    v_fma_mix_f32 v240, v176, v192, v200 op_sel_hi:[1,0,0]
    v_fma_mix_f32 v241, v176, v193, v201 op_sel:[1,0,0] op_sel_hi:[1,0,0]
    v_cvt_pk_bf16_f32 v224, v240, v241
    v_mfma_f32_32x32x16_bf16 v[16:31], a[144:147], v[236:239], v[16:31]
    ds_read_b128 v[216:219], v252 offset:928
    ds_read_b128 v[220:223], v252 offset:944
    v_fma_mix_f32 v242, v177, v194, v202 op_sel_hi:[1,0,0]
    v_fma_mix_f32 v243, v177, v195, v203 op_sel:[1,0,0] op_sel_hi:[1,0,0]
    v_cvt_pk_bf16_f32 v225, v242, v243
    v_mfma_f32_32x32x16_bf16 v[32:47], a[148:151], v[232:235], v[32:47]
    buffer_load_dwordx4 v[168:171], v254, s[16:19], s38 offen offset:2048 sc1
    ds_read_b64_tr_b16 a[176:177], v244 offset:29344
    v_fma_mix_f32 v240, v178, v196, v204 op_sel_hi:[1,0,0]
    v_fma_mix_f32 v241, v178, v197, v205 op_sel:[1,0,0] op_sel_hi:[1,0,0]
    v_cvt_pk_bf16_f32 v226, v240, v241
    v_mfma_f32_32x32x16_bf16 v[48:63], a[148:151], v[236:239], v[48:63]
    ds_read_b64_tr_b16 a[178:179], v244 offset:30384
    ds_read_b64_tr_b16 a[180:181], v245 offset:29344
    v_fma_mix_f32 v242, v179, v198, v206 op_sel_hi:[1,0,0]
    v_fma_mix_f32 v243, v179, v199, v207 op_sel:[1,0,0] op_sel_hi:[1,0,0]
    v_cvt_pk_bf16_f32 v227, v242, v243
    v_mfma_f32_32x32x16_bf16 v[64:79], a[152:155], v[232:235], v[64:79]
    buffer_load_dwordx4 v[172:175], v255, s[16:19], s38 offen offset:2048 sc1
    ds_read_b64_tr_b16 a[182:183], v245 offset:30384
    v_fma_mix_f32 v240, v180, v192, v200 op_sel_hi:[1,0,0]
    v_fma_mix_f32 v241, v180, v193, v201 op_sel:[1,0,0] op_sel_hi:[1,0,0]
    v_cvt_pk_bf16_f32 v228, v240, v241
    v_mfma_f32_32x32x16_bf16 v[80:95], a[152:155], v[236:239], v[80:95]
    ds_read_b64_tr_b16 a[184:185], v246 offset:29344
    ds_read_b64_tr_b16 a[186:187], v246 offset:30384
    v_fma_mix_f32 v242, v181, v194, v202 op_sel_hi:[1,0,0]
    v_fma_mix_f32 v243, v181, v195, v203 op_sel:[1,0,0] op_sel_hi:[1,0,0]
    v_cvt_pk_bf16_f32 v229, v242, v243
    v_fma_mix_f32 v240, v182, v196, v204 op_sel_hi:[1,0,0]
    v_mfma_f32_32x32x16_bf16 v[96:111], a[156:159], v[232:235], v[96:111]
    ds_read_b64_tr_b16 a[188:189], v247 offset:29344
    buffer_load_dwordx4 v251, s[32:35], s36 offen offset:3120 nt lds
    v_fma_mix_f32 v241, v182, v197, v205 op_sel:[1,0,0] op_sel_hi:[1,0,0]
    v_cvt_pk_bf16_f32 v230, v240, v241
    v_fma_mix_f32 v242, v183, v198, v206 op_sel_hi:[1,0,0]
    v_mfma_f32_32x32x16_bf16 v[112:127], a[156:159], v[236:239], v[112:127]
    ds_read_b64_tr_b16 a[190:191], v247 offset:30384
    s_waitcnt vmcnt(20) lgkmcnt(8)
    s_add_u32 s36, s36, s37
    s_add_u32 s38, s38, 4096
    v_fma_mix_f32 v243, v183, v199, v207 op_sel:[1,0,0] op_sel_hi:[1,0,0]
    v_cvt_pk_bf16_f32 v231, v242, v243
    v_mfma_f32_32x32x16_bf16 v[0:15], a[160:163], v[224:227], v[0:15]
    s_barrier
    v_add_u32 v244, s41, v244
    v_fma_mix_f32 v240, v184, v208, v216 op_sel_hi:[1,0,0]
    v_mfma_f32_32x32x16_bf16 v[16:31], a[160:163], v[228:231], v[16:31]
    ds_read_b128 v[192:195], v252 offset:1024
    ds_read_b128 v[196:199], v252 offset:1040
    v_add_u32_e64 v245, s41, v245
    v_fma_mix_f32 v241, v184, v209, v217 op_sel:[1,0,0] op_sel_hi:[1,0,0]
    v_cvt_pk_bf16_f32 v232, v240, v241
    v_fma_mix_f32 v242, v185, v210, v218 op_sel_hi:[1,0,0]
    v_mfma_f32_32x32x16_bf16 v[32:47], a[164:167], v[224:227], v[32:47]
    ds_read_b128 v[200:203], v252 offset:1056
    ds_read_b128 v[204:207], v252 offset:1072
    s_xor_b32 s40, s42, 2
    v_add_u32 v246, s41, v246
    v_add_u32_e64 v247, s41, v247
    v_fma_mix_f32 v243, v185, v211, v219 op_sel:[1,0,0] op_sel_hi:[1,0,0]
    v_mfma_f32_32x32x16_bf16 v[48:63], a[164:167], v[228:231], v[48:63]
    buffer_load_dwordx4 v[176:179], v254, s[16:19], s38 offen offset:0 sc1
    ds_read_b64_tr_b16 a[128:129], v244 offset:0
    v_cvt_pk_bf16_f32 v233, v242, v243
    v_fma_mix_f32 v240, v186, v212, v220 op_sel_hi:[1,0,0]
    v_fma_mix_f32 v241, v186, v213, v221 op_sel:[1,0,0] op_sel_hi:[1,0,0]
    v_cvt_pk_bf16_f32 v234, v240, v241
    v_mfma_f32_32x32x16_bf16 v[64:79], a[168:171], v[224:227], v[64:79]
    ds_read_b64_tr_b16 a[130:131], v244 offset:1040
    ds_read_b64_tr_b16 a[132:133], v245 offset:0
    s_mul_i32 s40, s40, 33536
    v_fma_mix_f32 v242, v187, v214, v222 op_sel_hi:[1,0,0]
    v_fma_mix_f32 v243, v187, v215, v223 op_sel:[1,0,0] op_sel_hi:[1,0,0]
    v_cvt_pk_bf16_f32 v235, v242, v243
    v_mfma_f32_32x32x16_bf16 v[80:95], a[168:171], v[228:231], v[80:95]
    buffer_load_dwordx4 v[180:183], v255, s[16:19], s38 offen offset:0 sc1
    ds_read_b64_tr_b16 a[134:135], v245 offset:1040
    v_fma_mix_f32 v240, v188, v208, v216 op_sel_hi:[1,0,0]
    v_fma_mix_f32 v241, v188, v209, v217 op_sel:[1,0,0] op_sel_hi:[1,0,0]
    v_cvt_pk_bf16_f32 v236, v240, v241
    v_fma_mix_f32 v242, v189, v210, v218 op_sel_hi:[1,0,0]
    v_mfma_f32_32x32x16_bf16 v[96:111], a[172:175], v[224:227], v[96:111]
    ds_read_b64_tr_b16 a[136:137], v246 offset:0
    ds_read_b64_tr_b16 a[138:139], v246 offset:1040
    v_fma_mix_f32 v243, v189, v211, v219 op_sel:[1,0,0] op_sel_hi:[1,0,0]
    v_cvt_pk_bf16_f32 v237, v242, v243
    v_fma_mix_f32 v240, v190, v212, v220 op_sel_hi:[1,0,0]
    v_fma_mix_f32 v241, v190, v213, v221 op_sel:[1,0,0] op_sel_hi:[1,0,0]
    v_cvt_pk_bf16_f32 v238, v240, v241
    v_mfma_f32_32x32x16_bf16 v[112:127], a[172:175], v[228:231], v[112:127]
    ds_read_b64_tr_b16 a[140:141], v247 offset:0
    ds_read_b64_tr_b16 a[142:143], v247 offset:1040
    s_waitcnt vmcnt(20) lgkmcnt(8)
    s_add_u32 s40, s40, s43
    v_fma_mix_f32 v242, v191, v214, v222 op_sel_hi:[1,0,0]
    v_fma_mix_f32 v243, v191, v215, v223 op_sel:[1,0,0] op_sel_hi:[1,0,0]
    v_cvt_pk_bf16_f32 v239, v242, v243
    v_mfma_f32_32x32x16_bf16 v[0:15], a[176:179], v[232:235], v[0:15]
    ds_read_b128 v[208:211], v252 offset:1152
    ds_read_b128 v[212:215], v252 offset:1168
    v_fma_mix_f32 v240, v128, v192, v200 op_sel_hi:[1,0,0]
    v_fma_mix_f32 v241, v128, v193, v201 op_sel:[1,0,0] op_sel_hi:[1,0,0]
    v_cvt_pk_bf16_f32 v224, v240, v241
    v_fma_mix_f32 v242, v129, v194, v202 op_sel_hi:[1,0,0]
    v_mfma_f32_32x32x16_bf16 v[16:31], a[176:179], v[236:239], v[16:31]
    ds_read_b128 v[216:219], v252 offset:1184
    ds_read_b128 v[220:223], v252 offset:1200
    v_fma_mix_f32 v243, v129, v195, v203 op_sel:[1,0,0] op_sel_hi:[1,0,0]
    v_cvt_pk_bf16_f32 v225, v242, v243
    v_fma_mix_f32 v240, v130, v196, v204 op_sel_hi:[1,0,0]
    v_fma_mix_f32 v241, v130, v197, v205 op_sel:[1,0,0] op_sel_hi:[1,0,0]
    v_mfma_f32_32x32x16_bf16 v[32:47], a[180:183], v[232:235], v[32:47]
    buffer_load_dwordx4 v[184:187], v254, s[16:19], s38 offen offset:2048 sc1
    ds_read_b64_tr_b16 a[144:145], v244 offset:4192
    v_cvt_pk_bf16_f32 v226, v240, v241
    v_fma_mix_f32 v242, v131, v198, v206 op_sel_hi:[1,0,0]
    v_fma_mix_f32 v243, v131, v199, v207 op_sel:[1,0,0] op_sel_hi:[1,0,0]
    v_cvt_pk_bf16_f32 v227, v242, v243
    v_mfma_f32_32x32x16_bf16 v[48:63], a[180:183], v[236:239], v[48:63]
    ds_read_b64_tr_b16 a[146:147], v244 offset:5232
    ds_read_b64_tr_b16 a[148:149], v245 offset:4192
    v_add_u32 v252, 1024, v252
    v_fma_mix_f32 v240, v132, v192, v200 op_sel_hi:[1,0,0]
    v_fma_mix_f32 v241, v132, v193, v201 op_sel:[1,0,0] op_sel_hi:[1,0,0]
    v_cvt_pk_bf16_f32 v228, v240, v241
    v_mfma_f32_32x32x16_bf16 v[64:79], a[184:187], v[232:235], v[64:79]
    buffer_load_dwordx4 v[188:191], v255, s[16:19], s38 offen offset:2048 sc1
    ds_read_b64_tr_b16 a[150:151], v245 offset:5232
    s_add_u32 s38, s38, 4096
    v_fma_mix_f32 v242, v133, v194, v202 op_sel_hi:[1,0,0]
    v_fma_mix_f32 v243, v133, v195, v203 op_sel:[1,0,0] op_sel_hi:[1,0,0]
    v_cvt_pk_bf16_f32 v229, v242, v243
    v_mfma_f32_32x32x16_bf16 v[80:95], a[184:187], v[236:239], v[80:95]
    ds_read_b64_tr_b16 a[152:153], v246 offset:4192
    ds_read_b64_tr_b16 a[154:155], v246 offset:5232
    s_mov_b32 m0, s40
    s_add_u32 s39, s39, 1
    v_fma_mix_f32 v240, v134, v196, v204 op_sel_hi:[1,0,0]
    v_fma_mix_f32 v241, v134, v197, v205 op_sel:[1,0,0] op_sel_hi:[1,0,0]
    v_cvt_pk_bf16_f32 v230, v240, v241
    v_mfma_f32_32x32x16_bf16 v[96:111], a[188:191], v[232:235], v[96:111]
    ds_read_b64_tr_b16 a[156:157], v247 offset:4192
    ds_read_b64_tr_b16 a[158:159], v247 offset:5232
    s_waitcnt vmcnt(19) lgkmcnt(8)
    s_bitcmp1_b32 22, s39
    v_fma_mix_f32 v242, v135, v198, v206 op_sel_hi:[1,0,0]
    v_fma_mix_f32 v243, v135, v199, v207 op_sel:[1,0,0] op_sel_hi:[1,0,0]
    v_cvt_pk_bf16_f32 v231, v242, v243
    v_mfma_f32_32x32x16_bf16 v[112:127], a[188:191], v[236:239], v[112:127]
    s_cbranch_scc1 L_qp
    s_cmp_eq_u32 s39, 3
    s_cbranch_scc1 L_switch
    v_mbcnt_lo_u32_b32 v224, -1, 0
    v_mbcnt_hi_u32_b32 v224, -1, v224
    v_bfe_u32 v225, v224, 3, 2
    v_mul_u32_u24 v225, 4192, v225
    v_bfe_u32 v226, v224, 2, 1
    v_mul_u32_u24 v226, 1040, v226
    v_add_u32 v225, v225, v226
    v_add_u32 v225, 63232, v225
    v_and_b32_e64 v226, 3, v224
    v_lshl_add_u32 v225, v226, 8, v225
    v_lshrrev_b32_e64 v227, 5, v224
    v_lshl_add_u32 v225, v227, 4, v225
    v_xor_b32_e64 v228, 0, v226
    v_lshl_add_u32 v240, v228, 6, v225
    v_xor_b32_e64 v228, 1, v226
    v_lshl_add_u32 v241, v228, 6, v225
    v_xor_b32_e64 v228, 2, v226
    v_lshl_add_u32 v242, v228, 6, v225
    v_xor_b32_e64 v228, 3, v226
    v_lshl_add_u32 v243, v228, 6, v225
    s_waitcnt lgkmcnt(0)
    ds_read_b128 a[128:131], v240 offset:16768
    ds_read_b128 a[132:135], v240 offset:16800
    ds_read_b128 a[136:139], v241 offset:16768
    ds_read_b128 a[140:143], v241 offset:16800
    ds_read_b128 a[144:147], v242 offset:16768
    ds_read_b128 a[148:151], v242 offset:16800
    ds_read_b128 a[152:155], v243 offset:16768
    ds_read_b128 a[156:159], v243 offset:16800
    s_mov_b32 s34, s14
    s_add_u32 s37, s43, 33536
    s_mov_b32 s44, 4294900224
    s_mov_b32 s4, 20480
    s_mov_b32 m0, s40
    s_nop 0
    buffer_load_dwordx4 v248, s[28:31], s36 offen nt lds
    buffer_load_dwordx4 v249, s[28:31], s36 offen offset:1040 nt lds
    buffer_load_dwordx4 v250, s[32:35], s36 offen offset:2080 nt lds
    buffer_load_dwordx4 v251, s[32:35], s36 offen offset:3120 nt lds
    s_add_u32 s36, s36, 8192
    s_addk_i32 m0, 16768
    s_nop 0
    buffer_load_dwordx4 v248, s[28:31], s36 offen nt lds
    buffer_load_dwordx4 v249, s[28:31], s36 offen offset:1040 nt lds
    buffer_load_dwordx4 v250, s[32:35], s36 offen offset:2080 nt lds
    buffer_load_dwordx4 v251, s[32:35], s36 offen offset:3120 nt lds
    s_add_u32 s36, s36, 8192
    v_mul_u32_u24 v225, 1040, v227
    v_bfe_u32 v226, v224, 2, 2
    v_lshl_add_u32 v225, v226, 8, v225
    v_bfe_u32 v228, v224, 4, 1
    v_lshl_add_u32 v225, v228, 5, v225
    v_and_b32_e64 v228, 3, v224
    v_lshl_add_u32 v225, v228, 3, v225
    v_add_u32 v225, 63232, v225
    v_xor_b32_e64 v229, 0, v226
    v_lshl_add_u32 v244, v229, 6, v225
    v_xor_b32_e64 v229, 1, v226
    v_lshl_add_u32 v245, v229, 6, v225
    v_xor_b32_e64 v229, 2, v226
    v_lshl_add_u32 v246, v229, 6, v225
    v_xor_b32_e64 v229, 3, v226
    v_lshl_add_u32 v247, v229, 6, v225
    v_mov_b32 v254, 0
    v_mov_b32 v255, 0
    v_cvt_pk_bf16_f32 v0, v0, v1
    v_cvt_pk_bf16_f32 v1, v2, v3
    v_cvt_pk_bf16_f32 v2, v4, v5
    v_cvt_pk_bf16_f32 v3, v6, v7
    v_cvt_pk_bf16_f32 v4, v8, v9
    v_cvt_pk_bf16_f32 v5, v10, v11
    v_cvt_pk_bf16_f32 v6, v12, v13
    v_cvt_pk_bf16_f32 v7, v14, v15
    v_cvt_pk_bf16_f32 v8, v16, v17
    v_cvt_pk_bf16_f32 v9, v18, v19
    v_cvt_pk_bf16_f32 v10, v20, v21
    v_cvt_pk_bf16_f32 v11, v22, v23
    v_cvt_pk_bf16_f32 v12, v24, v25
    v_cvt_pk_bf16_f32 v13, v26, v27
    v_cvt_pk_bf16_f32 v14, v28, v29
    v_cvt_pk_bf16_f32 v15, v30, v31
    v_cvt_pk_bf16_f32 v16, v32, v33
    v_cvt_pk_bf16_f32 v17, v34, v35
    v_cvt_pk_bf16_f32 v18, v36, v37
    v_cvt_pk_bf16_f32 v19, v38, v39
    v_cvt_pk_bf16_f32 v20, v40, v41
    v_cvt_pk_bf16_f32 v21, v42, v43
    v_cvt_pk_bf16_f32 v22, v44, v45
    v_cvt_pk_bf16_f32 v23, v46, v47
    v_cvt_pk_bf16_f32 v24, v48, v49
    v_cvt_pk_bf16_f32 v25, v50, v51
    v_cvt_pk_bf16_f32 v26, v52, v53
    v_cvt_pk_bf16_f32 v27, v54, v55
    v_cvt_pk_bf16_f32 v28, v56, v57
    v_cvt_pk_bf16_f32 v29, v58, v59
    v_cvt_pk_bf16_f32 v30, v60, v61
    v_cvt_pk_bf16_f32 v31, v62, v63
    v_cvt_pk_bf16_f32 v32, v64, v65
    v_cvt_pk_bf16_f32 v33, v66, v67
    v_cvt_pk_bf16_f32 v34, v68, v69
    v_cvt_pk_bf16_f32 v35, v70, v71
    v_cvt_pk_bf16_f32 v36, v72, v73
    v_cvt_pk_bf16_f32 v37, v74, v75
    v_cvt_pk_bf16_f32 v38, v76, v77
    v_cvt_pk_bf16_f32 v39, v78, v79
    v_cvt_pk_bf16_f32 v40, v80, v81
    v_cvt_pk_bf16_f32 v41, v82, v83
    v_cvt_pk_bf16_f32 v42, v84, v85
    v_cvt_pk_bf16_f32 v43, v86, v87
    v_cvt_pk_bf16_f32 v44, v88, v89
    v_cvt_pk_bf16_f32 v45, v90, v91
    v_cvt_pk_bf16_f32 v46, v92, v93
    v_cvt_pk_bf16_f32 v47, v94, v95
    v_cvt_pk_bf16_f32 v48, v96, v97
    v_cvt_pk_bf16_f32 v49, v98, v99
    v_cvt_pk_bf16_f32 v50, v100, v101
    v_cvt_pk_bf16_f32 v51, v102, v103
    v_cvt_pk_bf16_f32 v52, v104, v105
    v_cvt_pk_bf16_f32 v53, v106, v107
    v_cvt_pk_bf16_f32 v54, v108, v109
    v_cvt_pk_bf16_f32 v55, v110, v111
    v_cvt_pk_bf16_f32 v56, v112, v113
    v_cvt_pk_bf16_f32 v57, v114, v115
    v_cvt_pk_bf16_f32 v58, v116, v117
    v_cvt_pk_bf16_f32 v59, v118, v119
    v_cvt_pk_bf16_f32 v60, v120, v121
    v_cvt_pk_bf16_f32 v61, v122, v123
    v_cvt_pk_bf16_f32 v62, v124, v125
    v_cvt_pk_bf16_f32 v63, v126, v127
    s_add_u32 s42, s42, 1
    s_cmp_eq_u32 s42, 4
    s_cselect_b32 s42, 1, s42
    s_cselect_b32 s41, s44, 33536
    s_mov_b32 s40, s37
    s_add_u32 s37, s37, s41
    v_add_u32 v244, s41, v244
    v_add_u32 v245, s41, v245
    v_add_u32 v246, s41, v246
    v_add_u32 v247, s41, v247
    v_add_u32 v240, s41, v240
    v_add_u32 v241, s41, v241
    v_add_u32 v242, s41, v242
    v_add_u32 v243, s41, v243
    s_mov_b32 s16, s72
    s_mov_b32 s17, s73
    s_mov_b32 s18, 5242880
    s_mov_b32 s19, 0x00020000
    s_mov_b32 s24, s80
    s_mov_b32 s25, s81
    s_mov_b32 s26, s59
    s_mov_b32 s27, 0x00020000
    s_cmp_lt_u32 s60, 2
    s_cselect_b32 s8, s76, s78
    s_cselect_b32 s9, s77, s79
    s_cmp_lt_u32 s2, 216
    s_cselect_b32 s10, 2211840, 0
    s_waitcnt vmcnt(12) lgkmcnt(0)
    v_mfma_f32_32x32x16_bf16 v[64:79], a[128:131], v[0:3], 0
    s_barrier
    s_mov_b32 m0, s40
    v_mfma_f32_32x32x16_bf16 v[80:95], a[128:131], v[8:11], 0
    buffer_load_dwordx4 v248, s[28:31], s36 offen nt lds
    v_mfma_f32_32x32x16_bf16 v[64:79], a[132:135], v[4:7], v[64:79]
    v_mfma_f32_32x32x16_bf16 v[80:95], a[132:135], v[12:15], v[80:95]
    buffer_load_dwordx4 v249, s[28:31], s36 offen offset:1040 nt lds
    v_mfma_f32_32x32x16_bf16 v[64:79], a[136:139], v[16:19], v[64:79]
    v_mfma_f32_32x32x16_bf16 v[80:95], a[136:139], v[24:27], v[80:95]
    buffer_load_dwordx4 v250, s[32:35], s36 offen offset:2080 nt lds
    v_mfma_f32_32x32x16_bf16 v[64:79], a[140:143], v[20:23], v[64:79]
    v_mfma_f32_32x32x16_bf16 v[80:95], a[140:143], v[28:31], v[80:95]
    buffer_load_dwordx4 v251, s[32:35], s36 offen offset:3120 nt lds
    s_add_u32 s36, s36, 8192
    v_mfma_f32_32x32x16_bf16 v[64:79], a[144:147], v[32:35], v[64:79]
    s_add_u32 m0, m0, 16768
    v_mfma_f32_32x32x16_bf16 v[80:95], a[144:147], v[40:43], v[80:95]
    buffer_load_dwordx4 v248, s[28:31], s36 offen nt lds
    v_mfma_f32_32x32x16_bf16 v[64:79], a[148:151], v[36:39], v[64:79]
    buffer_load_dwordx4 v249, s[28:31], s36 offen offset:1040 nt lds
    v_mfma_f32_32x32x16_bf16 v[80:95], a[148:151], v[44:47], v[80:95]
    v_accvgpr_read_b32 v232, a215
    v_mfma_f32_32x32x16_bf16 v[64:79], a[152:155], v[48:51], v[64:79]
    buffer_load_dwordx4 v250, s[32:35], s36 offen offset:2080 nt lds
    v_mfma_f32_32x32x16_bf16 v[80:95], a[152:155], v[56:59], v[80:95]
    global_load_dword a197, v232, s[64:65]
    v_mfma_f32_32x32x16_bf16 v[64:79], a[156:159], v[52:55], v[64:79]
    buffer_load_dwordx4 v251, s[32:35], s36 offen offset:3120 nt lds
    s_add_u32 s36, s36, 8192
    v_mfma_f32_32x32x16_bf16 v[80:95], a[156:159], v[60:63], v[80:95]
    ds_read_b128 a[128:131], v240 offset:0
    ds_read_b128 a[132:135], v240 offset:32
    ds_read_b128 a[136:139], v241 offset:0
    ds_read_b128 a[140:143], v241 offset:32
    ds_read_b128 a[144:147], v242 offset:0
    ds_read_b128 a[148:151], v242 offset:32
    ds_read_b128 a[152:155], v243 offset:0
    ds_read_b128 a[156:159], v243 offset:32
    s_nop 0
    v_max3_f32 v192, v64, v65, v66
    v_max3_f32 v193, v67, v68, v69
    v_max3_f32 v192, v192, v70, v71
    v_max3_f32 v193, v193, v72, v73
    v_max3_f32 v192, v192, v74, v75
    v_max3_f32 v193, v193, v76, v77
    v_max3_f32 v192, v192, v78, v79
    v_max_f32 v192, v192, v193
    v_mov_b32_e64 v193, v192
    v_max3_f32 v208, v80, v81, v82
    v_max3_f32 v209, v83, v84, v85
    v_max3_f32 v208, v208, v86, v87
    v_max3_f32 v209, v209, v88, v89
    v_max3_f32 v208, v208, v90, v91
    v_max3_f32 v209, v209, v92, v93
    v_max3_f32 v208, v208, v94, v95
    v_max_f32 v208, v208, v209
    v_mov_b32 v209, v208
    v_permlane32_swap_b32 v192, v193
    s_nop 0
    v_permlane32_swap_b32 v208, v209
    v_max_f32 v192, v192, v193
    v_sub_f32 v192, 0, v192
    v_max_f32 v208, v208, v209
    v_sub_f32 v208, 0, v208
    v_mov_b32 v193, v192
    v_mov_b32 v194, v192
    v_mov_b32 v195, v192
    v_mov_b32 v196, v192
    v_mov_b32 v197, v192
    v_mov_b32 v198, v192
    v_mov_b32 v199, v192
    v_mov_b32 v200, v192
    v_mov_b32 v201, v192
    v_mov_b32 v202, v192
    v_mov_b32 v203, v192
    v_mov_b32 v204, v192
    v_mov_b32 v205, v192
    v_mov_b32 v206, v192
    v_mov_b32 v207, v192
    v_mov_b32 v209, v208
    v_mov_b32 v210, v208
    v_mov_b32 v211, v208
    v_mov_b32 v212, v208
    v_mov_b32 v213, v208
    v_mov_b32 v214, v208
    v_mov_b32 v215, v208
    v_mov_b32 v216, v208
    v_mov_b32 v217, v208
    v_mov_b32 v218, v208
    v_mov_b32 v219, v208
    v_mov_b32 v220, v208
    v_mov_b32 v221, v208
    v_mov_b32 v222, v208
    v_mov_b32 v223, v208
    v_lshrrev_b32 v225, 5, v224
    v_bfe_u32 v227, v224, 2, 3
    v_lshl_add_u32 v225, v225, 4, v227
    v_lshlrev_b32_e64 v225, 7, v225
    v_lshl_add_u32 v225, v228, 3, v225
    s_lshl_b32 s61, s60, 5
    s_addk_i32 s61, 17664
    v_lshlrev_b32 v147, 5, v224
    v_add_u32 v144, s61, v225
    v_lshrrev_b32 v225, 3, v224
    v_and_b32 v227, 7, v224
    v_lshlrev_b32_e64 v227, 4, v227
    v_mul_u32_u24 v145, 1280, v225
    v_add_u32_e64 v145, v145, v227
    v_mul_u32_u24 v146, 3456, v225
    v_add_u32 v146, v146, v227
    s_lshl_b32 s38, s60, 10
    s_addk_i32 s38, 1280
    s_waitcnt lgkmcnt(0)
    v_mfma_f32_32x32x16_bf16 v[96:111], a[128:131], v[0:3], v[192:207]
    v_add_f32 v64, v192, v64
    v_add_f32 v65, v192, v65
    v_exp_f32 v64, v64
    v_add_f32 v66, v192, v66
    v_exp_f32 v65, v65
    v_add_f32 v67, v192, v67
    v_add_f32_e64 v254, v254, v64
    v_mfma_f32_32x32x16_bf16 v[112:127], a[128:131], v[8:11], v[208:223]
    v_exp_f32 v66, v66
    v_add_f32 v68, v192, v68
    v_add_f32_e64 v254, v254, v65
    v_cvt_pk_bf16_f32 v224, v64, v65
    v_exp_f32 v67, v67
    v_add_f32 v69, v192, v69
    v_add_f32_e64 v254, v254, v66
    v_mfma_f32_32x32x16_bf16 v[96:111], a[132:135], v[4:7], v[96:111]
    v_exp_f32 v68, v68
    v_add_f32 v70, v192, v70
    v_add_f32_e64 v254, v254, v67
    v_cvt_pk_bf16_f32 v225, v66, v67
    v_exp_f32 v69, v69
    v_add_f32 v71, v192, v71
    v_add_f32_e64 v254, v254, v68
    v_mfma_f32_32x32x16_bf16 v[112:127], a[132:135], v[12:15], v[112:127]
    v_exp_f32 v70, v70
    v_add_f32 v80, v208, v80
    v_add_f32_e64 v254, v254, v69
    v_cvt_pk_bf16_f32 v226, v68, v69
    v_exp_f32 v71, v71
    v_add_f32 v81, v208, v81
    v_add_f32_e64 v254, v254, v70
    v_mfma_f32_32x32x16_bf16 v[96:111], a[136:139], v[16:19], v[96:111]
    v_exp_f32 v80, v80
    v_add_f32 v82, v208, v82
    v_add_f32_e64 v254, v254, v71
    v_cvt_pk_bf16_f32 v227, v70, v71
    v_exp_f32 v81, v81
    v_add_f32 v83, v208, v83
    v_add_f32_e64 v255, v255, v80
    v_mfma_f32_32x32x16_bf16 v[112:127], a[136:139], v[24:27], v[112:127]
    v_exp_f32 v82, v82
    v_add_f32 v84, v208, v84
    v_add_f32_e64 v255, v255, v81
    v_cvt_pk_bf16_f32 v232, v80, v81
    v_exp_f32 v83, v83
    v_add_f32 v85, v208, v85
    v_add_f32_e64 v255, v255, v82
    v_mfma_f32_32x32x16_bf16 v[96:111], a[140:143], v[20:23], v[96:111]
    v_exp_f32 v84, v84
    v_add_f32 v86, v208, v86
    v_add_f32_e64 v255, v255, v83
    v_cvt_pk_bf16_f32 v233, v82, v83
    v_exp_f32 v85, v85
    v_add_f32 v87, v208, v87
    v_add_f32_e64 v255, v255, v84
    v_mfma_f32_32x32x16_bf16 v[112:127], a[140:143], v[28:31], v[112:127]
    v_exp_f32 v86, v86
    v_add_f32 v72, v192, v72
    v_add_f32_e64 v255, v255, v85
    v_cvt_pk_bf16_f32 v234, v84, v85
    v_exp_f32 v87, v87
    v_add_f32 v73, v192, v73
    v_add_f32_e64 v255, v255, v86
    v_mfma_f32_32x32x16_bf16 v[96:111], a[144:147], v[32:35], v[96:111]
    v_exp_f32 v72, v72
    v_add_f32 v74, v192, v74
    v_add_f32_e64 v255, v255, v87
    v_cvt_pk_bf16_f32 v235, v86, v87
    v_exp_f32 v73, v73
    v_add_f32 v75, v192, v75
    v_add_f32 v254, v254, v72
    v_exp_f32 v74, v74
    v_mfma_f32_32x32x16_bf16 v[112:127], a[144:147], v[40:43], v[112:127]
    v_add_f32 v76, v192, v76
    v_add_f32 v254, v254, v73
    v_cvt_pk_bf16_f32 v228, v72, v73
    v_exp_f32 v75, v75
    v_add_f32 v77, v192, v77
    v_add_f32 v254, v254, v74
    v_exp_f32 v76, v76
    v_add_f32_e64 v78, v192, v78
    v_mfma_f32_32x32x16_bf16 v[96:111], a[148:151], v[36:39], v[96:111]
    v_add_f32_e64 v254, v254, v75
    v_cvt_pk_bf16_f32 v229, v74, v75
    v_exp_f32 v77, v77
    v_add_f32 v79, v192, v79
    v_add_f32 v254, v254, v76
    v_exp_f32 v78, v78
    v_add_f32 v88, v208, v88
    v_add_f32 v254, v254, v77
    v_mfma_f32_32x32x16_bf16 v[112:127], a[148:151], v[44:47], v[112:127]
    v_cvt_pk_bf16_f32 v230, v76, v77
    v_exp_f32 v79, v79
    v_add_f32 v89, v208, v89
    v_add_f32 v254, v254, v78
    v_exp_f32 v88, v88
    v_add_f32 v90, v208, v90
    v_add_f32 v254, v254, v79
    v_cvt_pk_bf16_f32 v231, v78, v79
    v_mfma_f32_32x32x16_bf16 v[96:111], a[152:155], v[48:51], v[96:111]
    v_exp_f32 v89, v89
    v_add_f32 v91, v208, v91
    v_add_f32 v255, v255, v88
    v_exp_f32 v90, v90
    v_add_f32 v92, v208, v92
    v_add_f32 v255, v255, v89
    v_cvt_pk_bf16_f32 v236, v88, v89
    v_exp_f32_e64 v91, v91
    v_mfma_f32_32x32x16_bf16 v[112:127], a[152:155], v[56:59], v[112:127]
    v_add_f32 v93, v208, v93
    v_add_f32 v255, v255, v90
    v_exp_f32 v92, v92
    v_add_f32 v94, v208, v94
    v_add_f32_e64 v255, v255, v91
    v_cvt_pk_bf16_f32 v237, v90, v91
    v_exp_f32 v93, v93
    v_add_f32 v95, v208, v95
    v_mfma_f32_32x32x16_bf16 v[96:111], a[156:159], v[52:55], v[96:111]
    v_add_f32 v255, v255, v92
    v_exp_f32 v94, v94
    v_add_f32_e64 v255, v255, v93
    v_cvt_pk_bf16_f32 v238, v92, v93
    v_exp_f32 v95, v95
    v_add_f32 v255, v255, v94
    v_add_f32_e64 v255, v255, v95
    v_cvt_pk_bf16_f32 v239, v94, v95
    v_mfma_f32_32x32x16_bf16 v[112:127], a[156:159], v[60:63], v[112:127]
    ds_read_b128 a[128:131], v240 offset:16768
    ds_read_b128 a[132:135], v240 offset:16800
    ds_read_b128 a[136:139], v241 offset:16768
    ds_read_b128 a[140:143], v241 offset:16800
    ds_read_b128 a[144:147], v242 offset:16768
    ds_read_b128 a[148:151], v242 offset:16800
    ds_read_b128 a[152:155], v243 offset:16768
    ds_read_b128 a[156:159], v243 offset:16800
    s_add_u32 s42, s42, 1
    s_cmp_eq_u32 s42, 4
    s_cselect_b32 s42, 1, s42
    s_cselect_b32 s41, s44, 33536
    s_mov_b32 s40, s37
    s_add_u32 s37, s37, s41
    v_add_u32 v244, s41, v244
    v_add_u32 v245, s41, v245
    v_add_u32 v246, s41, v246
    v_add_u32 v247, s41, v247
    v_add_u32 v240, s41, v240
    v_add_u32 v241, s41, v241
    v_add_u32 v242, s41, v242
    v_add_u32 v243, s41, v243
    s_mov_b32 s39, 0
    s_waitcnt vmcnt(9) lgkmcnt(0)
L_at:
    v_mfma_f32_32x32x16_bf16 v[64:79], a[128:131], v[0:3], v[192:207]
    s_barrier
    v_mfma_f32_32x32x16_bf16 v[80:95], a[128:131], v[8:11], v[208:223]
    ds_read_b64_tr_b16 a[160:161], v244 offset:2080
    ds_read_b64_tr_b16 a[162:163], v244 offset:6272
    v_exp_f32_e64 v96, v96
    v_mfma_f32_32x32x16_bf16 v[64:79], a[132:135], v[4:7], v[64:79]
    ds_read_b64_tr_b16 a[164:165], v245 offset:2080
    s_mov_b32 m0, s38
    v_exp_f32 v97, v97
    v_add_f32_e64 v254, v254, v96
    v_mfma_f32_32x32x16_bf16 v[80:95], a[132:135], v[12:15], v[80:95]
    ds_read_b64_tr_b16 a[166:167], v245 offset:6272
    buffer_load_dwordx4 v146, s[8:11], s6 offen nt lds
    v_exp_f32_e64 v98, v98
    v_mfma_f32_32x32x16_bf16 v[64:79], a[136:139], v[16:19], v[64:79]
    ds_read_b64_tr_b16 a[168:169], v246 offset:2080
    v_add_f32_e64 v254, v254, v97
    v_cvt_pk_bf16_f32 v128, v96, v97
    v_exp_f32_e64 v99, v99
    v_mfma_f32_32x32x16_bf16 v[80:95], a[136:139], v[24:27], v[80:95]
    ds_read_b64_tr_b16 a[170:171], v246 offset:6272
    s_add_u32 m0, m0, 20480
    v_add_f32 v254, v254, v98
    v_exp_f32 v100, v100
    v_mfma_f32_32x32x16_bf16 v[64:79], a[140:143], v[20:23], v[64:79]
    ds_read_b64_tr_b16 a[172:173], v247 offset:2080
    buffer_load_dwordx4 v145, s[24:27], s58 offen nt lds
    v_add_f32_e64 v254, v254, v99
    v_cvt_pk_bf16_f32 v129, v98, v99
    v_mfma_f32_32x32x16_bf16 v[80:95], a[140:143], v[28:31], v[80:95]
    ds_read_b64_tr_b16 a[174:175], v247 offset:6272
    v_exp_f32 v101, v101
    v_add_f32 v254, v254, v100
    v_exp_f32_e64 v102, v102
    v_mfma_f32_32x32x16_bf16 v[64:79], a[144:147], v[32:35], v[64:79]
    ds_read_b64_tr_b16 a[176:177], v244 offset:10464
    v_add_f32_e64 v254, v254, v101
    v_cvt_pk_bf16_f32 v130, v100, v101
    v_exp_f32_e64 v103, v103
    v_mfma_f32_32x32x16_bf16 v[80:95], a[144:147], v[40:43], v[80:95]
    ds_read_b64_tr_b16 a[178:179], v244 offset:14656
    buffer_load_dword a196, v147, s[16:19], s48 offen
    v_add_f32 v254, v254, v102
    v_exp_f32 v112, v112
    v_mfma_f32_32x32x16_bf16 v[64:79], a[148:151], v[36:39], v[64:79]
    ds_read_b64_tr_b16 a[180:181], v245 offset:10464
    v_add_f32_e64 v254, v254, v103
    v_cvt_pk_bf16_f32 v131, v102, v103
    v_exp_f32_e64 v113, v113
    v_mfma_f32_32x32x16_bf16 v[80:95], a[148:151], v[44:47], v[80:95]
    ds_read_b64_tr_b16 a[182:183], v245 offset:14656
    v_add_f32 v255, v255, v112
    v_exp_f32 v114, v114
    v_add_f32_e64 v255, v255, v113
    v_mfma_f32_32x32x16_bf16 v[64:79], a[152:155], v[48:51], v[64:79]
    ds_read_b64_tr_b16 a[184:185], v246 offset:10464
    v_cvt_pk_bf16_f32 v136, v112, v113
    v_exp_f32 v115, v115
    v_add_f32 v255, v255, v114
    v_mfma_f32_32x32x16_bf16 v[80:95], a[152:155], v[56:59], v[80:95]
    ds_read_b64_tr_b16 a[186:187], v246 offset:14656
    ds_read_b64_tr_b16 a[188:189], v247 offset:10464
    v_exp_f32_e64 v116, v116
    v_mfma_f32_32x32x16_bf16 v[64:79], a[156:159], v[52:55], v[64:79]
    ds_read_b64_tr_b16 a[190:191], v247 offset:14656
    v_add_f32_e64 v255, v255, v115
    v_cvt_pk_bf16_f32 v137, v114, v115
    v_exp_f32_e64 v117, v117
    v_mfma_f32_32x32x16_bf16 v[80:95], a[156:159], v[60:63], v[80:95]
    s_waitcnt lgkmcnt(8)
    v_add_f32 v255, v255, v116
    v_exp_f32 v118, v118
    v_add_f32 v255, v255, v117
    v_mfma_f32_32x32x16_bf16 a[0:15], a[160:163], v[224:227], a[0:15]
    ds_read_b128 a[128:131], v240 offset:0
    v_cvt_pk_bf16_f32 v138, v116, v117
    v_exp_f32 v119, v119
    v_add_f32 v255, v255, v118
    v_mfma_f32_32x32x16_bf16 a[16:31], a[160:163], v[232:235], a[16:31]
    ds_read_b128 a[132:135], v240 offset:32
    s_mov_b32 m0, s40
    v_exp_f32 v104, v104
    v_add_f32_e64 v255, v255, v119
    v_mfma_f32_32x32x16_bf16 a[32:47], a[164:167], v[224:227], a[32:47]
    ds_read_b128 a[136:139], v241 offset:0
    buffer_load_dwordx4 v248, s[28:31], s36 offen nt lds
    v_cvt_pk_bf16_f32 v139, v118, v119
    v_exp_f32_e64 v105, v105
    v_mfma_f32_32x32x16_bf16 a[48:63], a[164:167], v[232:235], a[48:63]
    ds_read_b128 a[140:143], v241 offset:32
    v_add_f32 v254, v254, v104
    v_exp_f32 v106, v106
    v_add_f32_e64 v254, v254, v105
    v_mfma_f32_32x32x16_bf16 a[64:79], a[168:171], v[224:227], a[64:79]
    ds_read_b128 a[144:147], v242 offset:0
    buffer_load_dwordx4 v249, s[28:31], s36 offen offset:1040 nt lds
    v_cvt_pk_bf16_f32 v132, v104, v105
    v_exp_f32_e64 v107, v107
    v_mfma_f32_32x32x16_bf16 a[80:95], a[168:171], v[232:235], a[80:95]
    ds_read_b128 a[148:151], v242 offset:32
    v_add_f32 v254, v254, v106
    v_exp_f32 v108, v108
    v_add_f32 v254, v254, v107
    v_mfma_f32_32x32x16_bf16 a[96:111], a[172:175], v[224:227], a[96:111]
    s_waitcnt lgkmcnt(6)
    v_cvt_pk_bf16_f32 v133, v106, v107
    v_exp_f32 v109, v109
    v_add_f32 v254, v254, v108
    v_mfma_f32_32x32x16_bf16 a[112:127], a[172:175], v[232:235], a[112:127]
    ds_read_b128 a[152:155], v243 offset:0
    buffer_load_dwordx4 v250, s[32:35], s36 offen offset:2080 nt lds
    v_exp_f32_e64 v110, v110
    v_mfma_f32_32x32x16_bf16 a[0:15], a[176:179], v[228:231], a[0:15]
    ds_read_b128 a[156:159], v243 offset:32
    v_add_f32_e64 v254, v254, v109
    v_cvt_pk_bf16_f32 v134, v108, v109
    v_exp_f32_e64 v111, v111
    v_mfma_f32_32x32x16_bf16 a[16:31], a[176:179], v[236:239], a[16:31]
    ds_read_b64_tr_b16 a[192:193], v144 offset:0
    v_add_f32 v254, v254, v110
    v_exp_f32 v120, v120
    v_add_f32_e64 v254, v254, v111
    v_mfma_f32_32x32x16_bf16 a[32:47], a[180:183], v[228:231], a[32:47]
    ds_read_b64_tr_b16 a[194:195], v144 offset:1024
    v_cvt_pk_bf16_f32 v135, v110, v111
    v_exp_f32 v121, v121
    v_add_f32 v255, v255, v120
    v_mfma_f32_32x32x16_bf16 a[48:63], a[180:183], v[236:239], a[48:63]
    v_exp_f32 v122, v122
    v_add_f32 v255, v255, v121
    v_cvt_pk_bf16_f32 v140, v120, v121
    v_exp_f32_e64 v123, v123
    v_mfma_f32_32x32x16_bf16 a[64:79], a[184:187], v[228:231], a[64:79]
    v_add_f32 v255, v255, v122
    v_exp_f32 v124, v124
    v_add_f32_e64 v255, v255, v123
    v_cvt_pk_bf16_f32 v141, v122, v123
    v_mfma_f32_32x32x16_bf16 a[80:95], a[184:187], v[236:239], a[80:95]
    buffer_load_dwordx4 v251, s[32:35], s36 offen offset:3120 nt lds
    v_exp_f32 v125, v125
    v_add_f32 v255, v255, v124
    v_mfma_f32_32x32x16_bf16 a[96:111], a[188:191], v[228:231], a[96:111]
    s_add_u32 s36, s36, 8192
    v_exp_f32 v126, v126
    v_add_f32 v255, v255, v125
    v_cvt_pk_bf16_f32 v142, v124, v125
    v_mfma_f32_32x32x16_bf16 a[112:127], a[188:191], v[236:239], a[112:127]
    s_waitcnt lgkmcnt(0)
    v_exp_f32 v127, v127
    v_add_f32 v255, v255, v126
    v_add_f32 v255, v255, v127
    v_cvt_pk_bf16_f32 v143, v126, v127
    v_mfma_f32_32x32x16_bf16 v[96:111], a[128:131], v[0:3], v[192:207]
    ds_read_b64_tr_b16 a[160:161], v244 offset:18848
    s_add_u32 m0, m0, 16768
    v_exp_f32 v64, v64
    v_exp_f32 v65, v65
    v_mfma_f32_32x32x16_bf16 v[112:127], a[128:131], v[8:11], v[208:223]
    ds_read_b64_tr_b16 a[162:163], v244 offset:23040
    buffer_store_dwordx4 a[192:195], v253, s[52:55], s4 offen sc1
    v_add_f32 v254, v254, v64
    v_exp_f32 v66, v66
    v_mfma_f32_32x32x16_bf16 v[96:111], a[132:135], v[4:7], v[96:111]
    ds_read_b64_tr_b16 a[164:165], v245 offset:18848
    s_add_u32 s58, s58, 128
    v_add_f32_e64 v254, v254, v65
    v_cvt_pk_bf16_f32 v224, v64, v65
    v_exp_f32_e64 v67, v67
    v_mfma_f32_32x32x16_bf16 v[112:127], a[132:135], v[12:15], v[112:127]
    ds_read_b64_tr_b16 a[166:167], v245 offset:23040
    s_add_u32 s6, s6, 55296
    v_add_f32 v254, v254, v66
    v_exp_f32 v68, v68
    v_mfma_f32_32x32x16_bf16 v[96:111], a[136:139], v[16:19], v[96:111]
    ds_read_b64_tr_b16 a[168:169], v246 offset:18848
    v_add_f32_e64 v254, v254, v67
    v_cvt_pk_bf16_f32 v225, v66, v67
    v_exp_f32_e64 v69, v69
    v_mfma_f32_32x32x16_bf16 v[112:127], a[136:139], v[24:27], v[112:127]
    ds_read_b64_tr_b16 a[170:171], v246 offset:23040
    s_lshl_b32 s4, s39, 12
    v_add_f32 v254, v254, v68
    v_exp_f32 v70, v70
    v_add_f32 v254, v254, v69
    v_mfma_f32_32x32x16_bf16 v[96:111], a[140:143], v[20:23], v[96:111]
    ds_read_b64_tr_b16 a[172:173], v247 offset:18848
    s_add_u32 s38, s38, 4096
    v_cvt_pk_bf16_f32 v226, v68, v69
    v_exp_f32 v71, v71
    v_add_f32 v254, v254, v70
    v_mfma_f32_32x32x16_bf16 v[112:127], a[140:143], v[28:31], v[112:127]
    ds_read_b64_tr_b16 a[174:175], v247 offset:23040
    s_add_u32 s48, s48, 2048
    v_exp_f32 v80, v80
    v_add_f32 v254, v254, v71
    v_cvt_pk_bf16_f32 v227, v70, v71
    v_mfma_f32_32x32x16_bf16 v[96:111], a[144:147], v[32:35], v[96:111]
    ds_read_b64_tr_b16 a[176:177], v244 offset:27232
    v_exp_f32 v81, v81
    v_add_f32 v255, v255, v80
    v_exp_f32_e64 v82, v82
    v_mfma_f32_32x32x16_bf16 v[112:127], a[144:147], v[40:43], v[112:127]
    ds_read_b64_tr_b16 a[178:179], v244 offset:31424
    v_add_f32_e64 v255, v255, v81
    v_cvt_pk_bf16_f32 v232, v80, v81
    v_exp_f32_e64 v83, v83
    v_mfma_f32_32x32x16_bf16 v[96:111], a[148:151], v[36:39], v[96:111]
    ds_read_b64_tr_b16 a[180:181], v245 offset:27232
    s_add_u32 s42, s42, 1
    v_add_f32 v255, v255, v82
    v_exp_f32_e64 v84, v84
    v_mfma_f32_32x32x16_bf16 v[112:127], a[148:151], v[44:47], v[112:127]
    ds_read_b64_tr_b16 a[182:183], v245 offset:31424
    s_cmp_eq_u32 s42, 4
    s_cselect_b32 s42, 1, s42
    s_cselect_b32 s41, s44, 33536
    v_add_f32_e64 v255, v255, v83
    v_mfma_f32_32x32x16_bf16 v[96:111], a[152:155], v[48:51], v[96:111]
    ds_read_b64_tr_b16 a[184:185], v246 offset:27232
    s_mov_b32 s40, s37
    s_add_u32 s37, s37, s41
    v_cvt_pk_bf16_f32 v233, v82, v83
    v_exp_f32_e64 v85, v85
    v_mfma_f32_32x32x16_bf16 v[112:127], a[152:155], v[56:59], v[112:127]
    ds_read_b64_tr_b16 a[186:187], v246 offset:31424
    ds_read_b64_tr_b16 a[188:189], v247 offset:27232
    v_add_f32 v255, v255, v84
    v_exp_f32 v86, v86
    v_mfma_f32_32x32x16_bf16 v[96:111], a[156:159], v[52:55], v[96:111]
    ds_read_b64_tr_b16 a[190:191], v247 offset:31424
    v_add_u32 v144, 4096, v144
    v_add_f32_e64 v255, v255, v85
    v_cvt_pk_bf16_f32 v234, v84, v85
    v_exp_f32_e64 v87, v87
    v_mfma_f32_32x32x16_bf16 v[112:127], a[156:159], v[60:63], v[112:127]
    s_waitcnt lgkmcnt(8)
    v_add_f32 v255, v255, v86
    v_exp_f32 v72, v72
    v_add_f32 v255, v255, v87
    v_mfma_f32_32x32x16_bf16 a[0:15], a[160:163], v[128:131], a[0:15]
    ds_read_b128 a[128:131], v240 offset:16768
    buffer_load_dwordx4 v248, s[28:31], s36 offen nt lds
    v_cvt_pk_bf16_f32 v235, v86, v87
    v_exp_f32_e64 v73, v73
    v_mfma_f32_32x32x16_bf16 a[16:31], a[160:163], v[136:139], a[16:31]
    ds_read_b128 a[132:135], v240 offset:16800
    v_add_u32 v244, s41, v244
    v_add_f32 v254, v254, v72
    v_exp_f32 v74, v74
    v_add_f32 v254, v254, v73
    v_mfma_f32_32x32x16_bf16 a[32:47], a[164:167], v[128:131], a[32:47]
    ds_read_b128 a[136:139], v241 offset:16768
    buffer_load_dwordx4 v249, s[28:31], s36 offen offset:1040 nt lds
    v_cvt_pk_bf16_f32 v228, v72, v73
    v_exp_f32_e64 v75, v75
    v_mfma_f32_32x32x16_bf16 a[48:63], a[164:167], v[136:139], a[48:63]
    ds_read_b128 a[140:143], v241 offset:16800
    v_add_u32 v245, s41, v245
    v_add_f32 v254, v254, v74
    v_exp_f32 v76, v76
    v_add_f32 v254, v254, v75
    v_mfma_f32_32x32x16_bf16 a[64:79], a[168:171], v[128:131], a[64:79]
    ds_read_b128 a[144:147], v242 offset:16768
    buffer_load_dwordx4 v250, s[32:35], s36 offen offset:2080 nt lds
    v_cvt_pk_bf16_f32 v229, v74, v75
    v_exp_f32_e64 v77, v77
    v_mfma_f32_32x32x16_bf16 a[80:95], a[168:171], v[136:139], a[80:95]
    ds_read_b128 a[148:151], v242 offset:16800
    v_add_u32 v246, s41, v246
    v_add_f32 v254, v254, v76
    v_exp_f32_e64 v78, v78
    v_mfma_f32_32x32x16_bf16 a[96:111], a[172:175], v[128:131], a[96:111]
    s_waitcnt lgkmcnt(6)
    v_add_f32 v254, v254, v77
    v_cvt_pk_bf16_f32 v230, v76, v77
    v_exp_f32_e64 v79, v79
    v_mfma_f32_32x32x16_bf16 a[112:127], a[172:175], v[136:139], a[112:127]
    ds_read_b128 a[152:155], v243 offset:16768
    v_add_u32 v247, s41, v247
    v_add_f32 v254, v254, v78
    v_exp_f32_e64 v88, v88
    v_mfma_f32_32x32x16_bf16 a[0:15], a[176:179], v[132:135], a[0:15]
    ds_read_b128 a[156:159], v243 offset:16800
    v_add_f32_e64 v254, v254, v79
    v_cvt_pk_bf16_f32 v231, v78, v79
    v_exp_f32_e64 v89, v89
    v_mfma_f32_32x32x16_bf16 a[16:31], a[176:179], v[140:143], a[16:31]
    buffer_load_dwordx4 v251, s[32:35], s36 offen offset:3120 nt lds
    v_add_f32 v255, v255, v88
    v_exp_f32 v90, v90
    v_mfma_f32_32x32x16_bf16 a[32:47], a[180:183], v[132:135], a[32:47]
    v_add_u32 v240, s41, v240
    v_add_f32 v255, v255, v89
    v_cvt_pk_bf16_f32 v236, v88, v89
    v_exp_f32_e64 v91, v91
    v_mfma_f32_32x32x16_bf16 a[48:63], a[180:183], v[140:143], a[48:63]
    v_add_u32 v241, s41, v241
    v_add_f32 v255, v255, v90
    v_exp_f32 v92, v92
    v_add_f32 v255, v255, v91
    v_cvt_pk_bf16_f32 v237, v90, v91
    v_mfma_f32_32x32x16_bf16 a[64:79], a[184:187], v[132:135], a[64:79]
    v_add_u32 v242, s41, v242
    v_exp_f32 v93, v93
    v_add_f32 v255, v255, v92
    v_exp_f32 v94, v94
    v_mfma_f32_32x32x16_bf16 a[80:95], a[184:187], v[140:143], a[80:95]
    s_add_u32 s36, s36, 8192
    v_add_u32 v243, s41, v243
    v_add_f32 v255, v255, v93
    v_cvt_pk_bf16_f32 v238, v92, v93
    v_exp_f32_e64 v95, v95
    v_mfma_f32_32x32x16_bf16 a[96:111], a[188:191], v[132:135], a[96:111]
    s_add_u32 s39, s39, 1
    s_cmp_lt_u32 s39, 6
    s_waitcnt vmcnt(10) lgkmcnt(0)
    v_add_f32 v255, v255, v94
    v_add_f32_e64 v255, v255, v95
    v_cvt_pk_bf16_f32 v239, v94, v95
    v_mfma_f32_32x32x16_bf16 a[112:127], a[188:191], v[140:143], a[112:127]
    s_cbranch_scc1 L_at
    v_mfma_f32_32x32x16_bf16 v[64:79], a[128:131], v[0:3], v[192:207]
    s_barrier
    v_mfma_f32_32x32x16_bf16 v[80:95], a[128:131], v[8:11], v[208:223]
    ds_read_b64_tr_b16 a[160:161], v244 offset:2080
    ds_read_b64_tr_b16 a[162:163], v244 offset:6272
    v_accvgpr_read_b32 v148, a210
    v_exp_f32_e64 v96, v96
    v_mfma_f32_32x32x16_bf16 v[64:79], a[132:135], v[4:7], v[64:79]
    ds_read_b64_tr_b16 a[164:165], v245 offset:2080
    v_accvgpr_read_b32 v149, a211
    v_accvgpr_read_b32 v150, a212
    v_exp_f32 v97, v97
    v_mfma_f32_32x32x16_bf16 v[80:95], a[132:135], v[12:15], v[80:95]
    ds_read_b64_tr_b16 a[166:167], v245 offset:6272
    s_mov_b32 s62, s57
    s_mul_i32 s62, s62, 163840
    v_accvgpr_read_b32 v151, a213
    v_accvgpr_read_b32 v152, a214
    v_mfma_f32_32x32x16_bf16 v[64:79], a[136:139], v[16:19], v[64:79]
    ds_read_b64_tr_b16 a[168:169], v246 offset:2080
    s_add_u32 s62, s62, s49
    s_add_u32 m0, s51, 25600
    v_add_f32 v254, v254, v96
    v_exp_f32_e64 v98, v98
    v_mfma_f32_32x32x16_bf16 v[80:95], a[136:139], v[24:27], v[80:95]
    ds_read_b64_tr_b16 a[170:171], v246 offset:6272
    v_add_f32_e64 v254, v254, v97
    v_cvt_pk_bf16_f32 v128, v96, v97
    v_exp_f32_e64 v99, v99
    v_mfma_f32_32x32x16_bf16 v[64:79], a[140:143], v[20:23], v[64:79]
    ds_read_b64_tr_b16 a[172:173], v247 offset:2080
    buffer_load_dwordx4 v148, s[16:19], s62 offen offset:0 lds
    v_add_f32 v254, v254, v98
    v_exp_f32 v100, v100
    v_mfma_f32_32x32x16_bf16 v[80:95], a[140:143], v[28:31], v[80:95]
    ds_read_b64_tr_b16 a[174:175], v247 offset:6272
    v_add_f32_e64 v254, v254, v99
    v_cvt_pk_bf16_f32 v129, v98, v99
    v_exp_f32_e64 v101, v101
    v_mfma_f32_32x32x16_bf16 v[64:79], a[144:147], v[32:35], v[64:79]
    ds_read_b64_tr_b16 a[176:177], v244 offset:10464
    buffer_load_dwordx4 v149, s[16:19], s62 offen offset:1024 lds
    v_add_f32 v254, v254, v100
    v_exp_f32 v102, v102
    v_mfma_f32_32x32x16_bf16 v[80:95], a[144:147], v[40:43], v[80:95]
    ds_read_b64_tr_b16 a[178:179], v244 offset:14656
    v_add_f32_e64 v254, v254, v101
    v_cvt_pk_bf16_f32 v130, v100, v101
    v_exp_f32_e64 v103, v103
    v_mfma_f32_32x32x16_bf16 v[64:79], a[148:151], v[36:39], v[64:79]
    ds_read_b64_tr_b16 a[180:181], v245 offset:10464
    v_add_f32 v254, v254, v102
    v_exp_f32 v112, v112
    v_add_f32_e64 v254, v254, v103
    v_mfma_f32_32x32x16_bf16 v[80:95], a[148:151], v[44:47], v[80:95]
    ds_read_b64_tr_b16 a[182:183], v245 offset:14656
    buffer_load_dwordx4 v150, s[16:19], s62 offen offset:2048 lds
    v_cvt_pk_bf16_f32 v131, v102, v103
    v_exp_f32_e64 v113, v113
    v_mfma_f32_32x32x16_bf16 v[64:79], a[152:155], v[48:51], v[64:79]
    ds_read_b64_tr_b16 a[184:185], v246 offset:10464
    v_add_f32 v255, v255, v112
    v_exp_f32 v114, v114
    v_add_f32_e64 v255, v255, v113
    v_mfma_f32_32x32x16_bf16 v[80:95], a[152:155], v[56:59], v[80:95]
    ds_read_b64_tr_b16 a[186:187], v246 offset:14656
    ds_read_b64_tr_b16 a[188:189], v247 offset:10464
    v_cvt_pk_bf16_f32 v136, v112, v113
    v_exp_f32_e64 v115, v115
    v_mfma_f32_32x32x16_bf16 v[64:79], a[156:159], v[52:55], v[64:79]
    ds_read_b64_tr_b16 a[190:191], v247 offset:14656
    v_add_f32 v255, v255, v114
    v_exp_f32 v116, v116
    v_add_f32_e64 v255, v255, v115
    v_mfma_f32_32x32x16_bf16 v[80:95], a[156:159], v[60:63], v[80:95]
    buffer_load_dwordx4 v151, s[16:19], s62 offen offset:3072 lds
    s_waitcnt lgkmcnt(8)
    s_addk_i32 m0, 4096
    v_cvt_pk_bf16_f32 v137, v114, v115
    v_mfma_f32_32x32x16_bf16 a[0:15], a[160:163], v[224:227], a[0:15]
    ds_read_b128 a[128:131], v240 offset:0
    v_exp_f32 v117, v117
    v_add_f32 v255, v255, v116
    v_exp_f32_e64 v118, v118
    v_mfma_f32_32x32x16_bf16 a[16:31], a[160:163], v[232:235], a[16:31]
    ds_read_b128 a[132:135], v240 offset:32
    v_add_f32_e64 v255, v255, v117
    v_cvt_pk_bf16_f32 v138, v116, v117
    v_exp_f32_e64 v119, v119
    v_mfma_f32_32x32x16_bf16 a[32:47], a[164:167], v[224:227], a[32:47]
    ds_read_b128 a[136:139], v241 offset:0
    v_add_f32 v255, v255, v118
    v_exp_f32 v104, v104
    v_add_f32_e64 v255, v255, v119
    v_mfma_f32_32x32x16_bf16 a[48:63], a[164:167], v[232:235], a[48:63]
    ds_read_b128 a[140:143], v241 offset:32
    buffer_load_dwordx4 v152, s[16:19], s62 offen lds
    s_cmp_gt_u32 s57, 0
    s_cselect_b32 s62, 0, 1
    s_mul_i32 s62, s62, 163840
    v_mfma_f32_32x32x16_bf16 a[64:79], a[168:171], v[224:227], a[64:79]
    ds_read_b128 a[144:147], v242 offset:0
    s_add_u32 s62, s62, s49
    s_add_u32 m0, s51, 97280
    v_cvt_pk_bf16_f32 v139, v118, v119
    v_exp_f32 v105, v105
    v_mfma_f32_32x32x16_bf16 a[80:95], a[168:171], v[232:235], a[80:95]
    ds_read_b128 a[148:151], v242 offset:32
    v_add_f32 v254, v254, v104
    v_exp_f32 v106, v106
    v_add_f32_e64 v254, v254, v105
    v_cvt_pk_bf16_f32 v132, v104, v105
    v_mfma_f32_32x32x16_bf16 a[96:111], a[172:175], v[224:227], a[96:111]
    s_waitcnt lgkmcnt(6)
    v_exp_f32 v107, v107
    v_add_f32 v254, v254, v106
    v_exp_f32 v108, v108
    v_mfma_f32_32x32x16_bf16 a[112:127], a[172:175], v[232:235], a[112:127]
    ds_read_b128 a[152:155], v243 offset:0
    v_add_f32_e64 v254, v254, v107
    v_cvt_pk_bf16_f32 v133, v106, v107
    v_exp_f32_e64 v109, v109
    v_mfma_f32_32x32x16_bf16 a[0:15], a[176:179], v[228:231], a[0:15]
    ds_read_b128 a[156:159], v243 offset:32
    v_add_f32 v254, v254, v108
    v_exp_f32 v110, v110
    v_add_f32_e64 v254, v254, v109
    v_mfma_f32_32x32x16_bf16 a[16:31], a[176:179], v[236:239], a[16:31]
    buffer_load_dwordx4 v148, s[16:19], s62 offen offset:0 lds
    v_cvt_pk_bf16_f32 v134, v108, v109
    v_exp_f32 v111, v111
    v_add_f32 v254, v254, v110
    v_mfma_f32_32x32x16_bf16 a[32:47], a[180:183], v[228:231], a[32:47]
    v_exp_f32 v120, v120
    v_add_f32 v254, v254, v111
    v_cvt_pk_bf16_f32 v135, v110, v111
    v_exp_f32_e64 v121, v121
    v_mfma_f32_32x32x16_bf16 a[48:63], a[180:183], v[236:239], a[48:63]
    buffer_load_dwordx4 v149, s[16:19], s62 offen offset:1024 lds
    v_add_f32 v255, v255, v120
    v_exp_f32 v122, v122
    v_add_f32_e64 v255, v255, v121
    v_mfma_f32_32x32x16_bf16 a[64:79], a[184:187], v[228:231], a[64:79]
    v_cvt_pk_bf16_f32 v140, v120, v121
    v_exp_f32 v123, v123
    v_add_f32 v255, v255, v122
    v_exp_f32_e64 v124, v124
    v_mfma_f32_32x32x16_bf16 a[80:95], a[184:187], v[236:239], a[80:95]
    buffer_load_dwordx4 v150, s[16:19], s62 offen offset:2048 lds
    v_add_f32_e64 v255, v255, v123
    v_cvt_pk_bf16_f32 v141, v122, v123
    v_exp_f32_e64 v125, v125
    v_mfma_f32_32x32x16_bf16 a[96:111], a[188:191], v[228:231], a[96:111]
    v_add_f32 v255, v255, v124
    v_exp_f32 v126, v126
    v_add_f32_e64 v255, v255, v125
    v_cvt_pk_bf16_f32 v142, v124, v125
    v_mfma_f32_32x32x16_bf16 a[112:127], a[188:191], v[236:239], a[112:127]
    s_waitcnt lgkmcnt(0)
    v_exp_f32 v127, v127
    v_add_f32 v255, v255, v126
    v_add_f32 v255, v255, v127
    v_cvt_pk_bf16_f32 v143, v126, v127
    v_mfma_f32_32x32x16_bf16 v[96:111], a[128:131], v[0:3], v[192:207]
    ds_read_b64_tr_b16 a[160:161], v244 offset:18848
    v_exp_f32 v64, v64
    v_exp_f32 v65, v65
    v_mfma_f32_32x32x16_bf16 v[112:127], a[128:131], v[8:11], v[208:223]
    ds_read_b64_tr_b16 a[162:163], v244 offset:23040
    v_add_f32 v254, v254, v64
    v_exp_f32 v66, v66
    v_mfma_f32_32x32x16_bf16 v[96:111], a[132:135], v[4:7], v[96:111]
    ds_read_b64_tr_b16 a[164:165], v245 offset:18848
    buffer_load_dwordx4 v151, s[16:19], s62 offen offset:3072 lds
    s_add_u32 m0, m0, 4096
    v_mfma_f32_32x32x16_bf16 v[112:127], a[132:135], v[12:15], v[112:127]
    ds_read_b64_tr_b16 a[166:167], v245 offset:23040
    v_add_f32_e64 v254, v254, v65
    v_cvt_pk_bf16_f32 v224, v64, v65
    v_exp_f32_e64 v67, v67
    v_mfma_f32_32x32x16_bf16 v[96:111], a[136:139], v[16:19], v[96:111]
    ds_read_b64_tr_b16 a[168:169], v246 offset:18848
    v_add_f32 v254, v254, v66
    v_exp_f32 v68, v68
    v_add_f32_e64 v254, v254, v67
    v_mfma_f32_32x32x16_bf16 v[112:127], a[136:139], v[24:27], v[112:127]
    ds_read_b64_tr_b16 a[170:171], v246 offset:23040
    v_cvt_pk_bf16_f32 v225, v66, v67
    v_exp_f32 v69, v69
    v_add_f32 v254, v254, v68
    v_mfma_f32_32x32x16_bf16 v[96:111], a[140:143], v[20:23], v[96:111]
    ds_read_b64_tr_b16 a[172:173], v247 offset:18848
    buffer_load_dwordx4 v152, s[16:19], s62 offen lds
    s_cmp_gt_u32 s57, 1
    s_cselect_b32 s62, 1, 2
    s_mul_i32 s62, s62, 163840
    v_mfma_f32_32x32x16_bf16 v[112:127], a[140:143], v[28:31], v[112:127]
    ds_read_b64_tr_b16 a[174:175], v247 offset:23040
    s_add_u32 s62, s62, s49
    s_add_u32 m0, s51, 46080
    s_cmp_eq_u32 s60, 3
    s_cselect_b32 m0, 117760, m0
    v_exp_f32_e64 v70, v70
    v_mfma_f32_32x32x16_bf16 v[96:111], a[144:147], v[32:35], v[96:111]
    ds_read_b64_tr_b16 a[176:177], v244 offset:27232
    v_add_f32_e64 v254, v254, v69
    v_cvt_pk_bf16_f32 v226, v68, v69
    v_exp_f32_e64 v71, v71
    v_mfma_f32_32x32x16_bf16 v[112:127], a[144:147], v[40:43], v[112:127]
    ds_read_b64_tr_b16 a[178:179], v244 offset:31424
    v_add_f32 v254, v254, v70
    v_exp_f32 v80, v80
    v_mfma_f32_32x32x16_bf16 v[96:111], a[148:151], v[36:39], v[96:111]
    ds_read_b64_tr_b16 a[180:181], v245 offset:27232
    v_add_f32_e64 v254, v254, v71
    v_cvt_pk_bf16_f32 v227, v70, v71
    v_exp_f32_e64 v81, v81
    v_mfma_f32_32x32x16_bf16 v[112:127], a[148:151], v[44:47], v[112:127]
    ds_read_b64_tr_b16 a[182:183], v245 offset:31424
    v_add_f32 v255, v255, v80
    v_exp_f32 v82, v82
    v_add_f32_e64 v255, v255, v81
    v_mfma_f32_32x32x16_bf16 v[96:111], a[152:155], v[48:51], v[96:111]
    ds_read_b64_tr_b16 a[184:185], v246 offset:27232
    v_cvt_pk_bf16_f32 v232, v80, v81
    v_exp_f32 v83, v83
    v_add_f32 v255, v255, v82
    v_mfma_f32_32x32x16_bf16 v[112:127], a[152:155], v[56:59], v[112:127]
    ds_read_b64_tr_b16 a[186:187], v246 offset:31424
    ds_read_b64_tr_b16 a[188:189], v247 offset:27232
    v_exp_f32_e64 v84, v84
    v_mfma_f32_32x32x16_bf16 v[96:111], a[156:159], v[52:55], v[96:111]
    ds_read_b64_tr_b16 a[190:191], v247 offset:31424
    v_add_f32_e64 v255, v255, v83
    v_cvt_pk_bf16_f32 v233, v82, v83
    v_exp_f32_e64 v85, v85
    v_mfma_f32_32x32x16_bf16 v[112:127], a[156:159], v[60:63], v[112:127]
    s_waitcnt lgkmcnt(8)
    v_add_f32 v255, v255, v84
    v_exp_f32 v86, v86
    v_add_f32 v255, v255, v85
    v_mfma_f32_32x32x16_bf16 a[0:15], a[160:163], v[128:131], a[0:15]
    buffer_load_dwordx4 v148, s[16:19], s62 offen offset:0 lds
    v_cvt_pk_bf16_f32 v234, v84, v85
    v_exp_f32_e64 v87, v87
    v_mfma_f32_32x32x16_bf16 a[16:31], a[160:163], v[136:139], a[16:31]
    v_subrev_u32 v244, 67072, v244
    v_add_f32 v255, v255, v86
    v_exp_f32 v72, v72
    v_mfma_f32_32x32x16_bf16 a[32:47], a[164:167], v[128:131], a[32:47]
    v_subrev_u32 v245, 67072, v245
    v_add_f32_e64 v255, v255, v87
    v_cvt_pk_bf16_f32 v235, v86, v87
    v_exp_f32_e64 v73, v73
    v_mfma_f32_32x32x16_bf16 a[48:63], a[164:167], v[136:139], a[48:63]
    buffer_load_dwordx4 v149, s[16:19], s62 offen offset:1024 lds
    v_add_f32 v254, v254, v72
    v_exp_f32 v74, v74
    v_mfma_f32_32x32x16_bf16 a[64:79], a[168:171], v[128:131], a[64:79]
    v_subrev_u32 v246, 67072, v246
    v_add_f32_e64 v254, v254, v73
    v_cvt_pk_bf16_f32 v228, v72, v73
    v_exp_f32_e64 v75, v75
    v_mfma_f32_32x32x16_bf16 a[80:95], a[168:171], v[136:139], a[80:95]
    v_subrev_u32 v247, 67072, v247
    v_add_f32 v254, v254, v74
    v_exp_f32 v76, v76
    v_mfma_f32_32x32x16_bf16 a[96:111], a[172:175], v[128:131], a[96:111]
    s_waitcnt lgkmcnt(0)
    v_add_f32 v254, v254, v75
    v_cvt_pk_bf16_f32 v229, v74, v75
    v_exp_f32_e64 v77, v77
    v_mfma_f32_32x32x16_bf16 a[112:127], a[172:175], v[136:139], a[112:127]
    buffer_load_dwordx4 v150, s[16:19], s62 offen offset:2048 lds
    v_add_f32 v254, v254, v76
    v_exp_f32 v78, v78
    v_mfma_f32_32x32x16_bf16 a[0:15], a[176:179], v[132:135], a[0:15]
    v_add_f32_e64 v254, v254, v77
    v_cvt_pk_bf16_f32 v230, v76, v77
    v_exp_f32_e64 v79, v79
    v_mfma_f32_32x32x16_bf16 a[16:31], a[176:179], v[140:143], a[16:31]
    v_add_f32 v254, v254, v78
    v_exp_f32 v88, v88
    v_add_f32_e64 v254, v254, v79
    v_cvt_pk_bf16_f32 v231, v78, v79
    v_mfma_f32_32x32x16_bf16 a[32:47], a[180:183], v[132:135], a[32:47]
    buffer_load_dwordx4 v151, s[16:19], s62 offen offset:3072 lds
    s_add_u32 m0, m0, 4096
    v_exp_f32_e64 v89, v89
    v_mfma_f32_32x32x16_bf16 a[48:63], a[180:183], v[140:143], a[48:63]
    v_add_f32 v255, v255, v88
    v_exp_f32 v90, v90
    v_add_f32_e64 v255, v255, v89
    v_cvt_pk_bf16_f32 v236, v88, v89
    v_mfma_f32_32x32x16_bf16 a[64:79], a[184:187], v[132:135], a[64:79]
    v_exp_f32 v91, v91
    v_add_f32 v255, v255, v90
    v_exp_f32_e64 v92, v92
    v_mfma_f32_32x32x16_bf16 a[80:95], a[184:187], v[140:143], a[80:95]
    buffer_load_dwordx4 v152, s[16:19], s62 offen lds
    v_add_f32_e64 v255, v255, v91
    v_cvt_pk_bf16_f32 v237, v90, v91
    v_exp_f32_e64 v93, v93
    v_mfma_f32_32x32x16_bf16 a[96:111], a[188:191], v[132:135], a[96:111]
    v_add_f32 v255, v255, v92
    v_exp_f32 v94, v94
    v_add_f32_e64 v255, v255, v93
    v_cvt_pk_bf16_f32 v238, v92, v93
    v_mfma_f32_32x32x16_bf16 a[112:127], a[188:191], v[140:143], a[112:127]
    s_waitcnt vmcnt(10)
    v_exp_f32 v95, v95
    v_add_f32_e64 v255, v255, v94
    v_add_f32 v255, v255, v95
    v_cvt_pk_bf16_f32 v239, v94, v95
    s_barrier
    ds_read_b64_tr_b16 a[160:161], v244 offset:2080
    ds_read_b64_tr_b16 a[162:163], v244 offset:6272
    ds_read_b64_tr_b16 a[164:165], v245 offset:2080
    ds_read_b64_tr_b16 a[166:167], v245 offset:6272
    ds_read_b64_tr_b16 a[168:169], v246 offset:2080
    ds_read_b64_tr_b16 a[170:171], v246 offset:6272
    ds_read_b64_tr_b16 a[172:173], v247 offset:2080
    ds_read_b64_tr_b16 a[174:175], v247 offset:6272
    ds_read_b64_tr_b16 a[176:177], v244 offset:10464
    ds_read_b64_tr_b16 a[178:179], v244 offset:14656
    ds_read_b64_tr_b16 a[180:181], v245 offset:10464
    ds_read_b64_tr_b16 a[182:183], v245 offset:14656
    ds_read_b64_tr_b16 a[184:185], v246 offset:10464
    ds_read_b64_tr_b16 a[186:187], v246 offset:14656
    ds_read_b64_tr_b16 a[188:189], v247 offset:10464
    ds_read_b64_tr_b16 a[190:191], v247 offset:14656
    v_exp_f32 v96, v96
    v_exp_f32 v97, v97
    v_add_f32 v254, v254, v96
    v_exp_f32 v98, v98
    v_add_f32_e64 v254, v254, v97
    v_cvt_pk_bf16_f32 v128, v96, v97
    v_exp_f32 v99, v99
    v_add_f32 v254, v254, v98
    v_exp_f32_e64 v100, v100
    v_add_f32 v254, v254, v99
    s_waitcnt lgkmcnt(14)
    v_mfma_f32_32x32x16_bf16 a[0:15], a[160:163], v[224:227], a[0:15]
    ds_read_b64_tr_b16 a[128:129], v244 offset:18848
    ds_read_b64_tr_b16 a[130:131], v244 offset:23040
    v_cvt_pk_bf16_f32 v129, v98, v99
    v_exp_f32 v101, v101
    v_add_f32 v254, v254, v100
    v_exp_f32_e64 v102, v102
    v_mfma_f32_32x32x16_bf16 a[16:31], a[160:163], v[232:235], a[16:31]
    ds_read_b64_tr_b16 a[132:133], v245 offset:18848
    s_cmp_gt_u32 s57, 2
    s_cselect_b32 s62, 2, 3
    s_mul_i32 s62, s62, 163840
    v_add_f32_e64 v254, v254, v101
    v_cvt_pk_bf16_f32 v130, v100, v101
    v_exp_f32 v103, v103
    s_waitcnt lgkmcnt(15)
    v_mfma_f32_32x32x16_bf16 a[32:47], a[164:167], v[224:227], a[32:47]
    ds_read_b64_tr_b16 a[134:135], v245 offset:23040
    s_add_u32 s62, s62, s49
    s_add_u32 m0, s51, 122880
    v_add_f32 v254, v254, v102
    v_exp_f32 v112, v112
    v_add_f32 v254, v254, v103
    v_cvt_pk_bf16_f32 v131, v102, v103
    v_mfma_f32_32x32x16_bf16 a[48:63], a[164:167], v[232:235], a[48:63]
    ds_read_b64_tr_b16 a[136:137], v246 offset:18848
    ds_read_b64_tr_b16 a[138:139], v246 offset:23040
    v_exp_f32 v113, v113
    v_add_f32 v255, v255, v112
    v_exp_f32 v114, v114
    s_waitcnt lgkmcnt(15)
    v_mfma_f32_32x32x16_bf16 a[64:79], a[168:171], v[224:227], a[64:79]
    ds_read_b64_tr_b16 a[140:141], v247 offset:18848
    buffer_load_dwordx4 v148, s[16:19], s62 offen offset:0 lds
    v_add_f32_e64 v255, v255, v113
    v_cvt_pk_bf16_f32 v136, v112, v113
    v_exp_f32 v115, v115
    v_add_f32 v255, v255, v114
    v_mfma_f32_32x32x16_bf16 a[80:95], a[168:171], v[232:235], a[80:95]
    ds_read_b64_tr_b16 a[142:143], v247 offset:23040
    v_exp_f32 v116, v116
    v_add_f32 v255, v255, v115
    v_cvt_pk_bf16_f32 v137, v114, v115
    v_exp_f32_e64 v117, v117
    v_add_f32 v255, v255, v116
    s_waitcnt lgkmcnt(15)
    v_mfma_f32_32x32x16_bf16 a[96:111], a[172:175], v[224:227], a[96:111]
    ds_read_b64_tr_b16 a[144:145], v244 offset:27232
    ds_read_b64_tr_b16 a[146:147], v244 offset:31424
    v_exp_f32 v118, v118
    v_add_f32 v255, v255, v117
    v_cvt_pk_bf16_f32 v138, v116, v117
    v_exp_f32_e64 v119, v119
    v_mfma_f32_32x32x16_bf16 a[112:127], a[172:175], v[232:235], a[112:127]
    ds_read_b64_tr_b16 a[148:149], v245 offset:27232
    buffer_load_dwordx4 v149, s[16:19], s62 offen offset:1024 lds
    v_add_f32 v255, v255, v118
    v_exp_f32 v104, v104
    v_add_f32 v255, v255, v119
    v_cvt_pk_bf16_f32 v139, v118, v119
    s_waitcnt lgkmcnt(15)
    v_mfma_f32_32x32x16_bf16 a[0:15], a[176:179], v[228:231], a[0:15]
    ds_read_b64_tr_b16 a[150:151], v245 offset:31424
    v_exp_f32 v105, v105
    v_add_f32 v254, v254, v104
    v_exp_f32 v106, v106
    v_add_f32 v254, v254, v105
    v_cvt_pk_bf16_f32 v132, v104, v105
    v_mfma_f32_32x32x16_bf16 a[16:31], a[176:179], v[236:239], a[16:31]
    ds_read_b64_tr_b16 a[152:153], v246 offset:27232
    ds_read_b64_tr_b16 a[154:155], v246 offset:31424
    v_exp_f32 v107, v107
    v_add_f32 v254, v254, v106
    v_exp_f32 v108, v108
    v_add_f32 v254, v254, v107
    v_mfma_f32_32x32x16_bf16 a[32:47], a[180:183], v[228:231], a[32:47]
    ds_read_b64_tr_b16 a[156:157], v247 offset:27232
    v_cvt_pk_bf16_f32 v133, v106, v107
    v_exp_f32 v109, v109
    v_add_f32 v254, v254, v108
    v_exp_f32 v110, v110
    v_add_f32 v254, v254, v109
    v_mfma_f32_32x32x16_bf16 a[48:63], a[180:183], v[236:239], a[48:63]
    ds_read_b64_tr_b16 a[158:159], v247 offset:31424
    v_cvt_pk_bf16_f32 v134, v108, v109
    v_exp_f32 v111, v111
    v_add_f32 v254, v254, v110
    v_exp_f32_e64 v120, v120
    v_add_f32 v254, v254, v111
    s_waitcnt lgkmcnt(15)
    v_mfma_f32_32x32x16_bf16 a[64:79], a[184:187], v[228:231], a[64:79]
    buffer_load_dwordx4 v150, s[16:19], s62 offen offset:2048 lds
    v_cvt_pk_bf16_f32 v135, v110, v111
    v_exp_f32 v121, v121
    v_add_f32 v255, v255, v120
    v_exp_f32_e64 v122, v122
    v_mfma_f32_32x32x16_bf16 a[80:95], a[184:187], v[236:239], a[80:95]
    buffer_load_dwordx4 v151, s[16:19], s62 offen offset:3072 lds
    s_add_u32 m0, m0, 4096
    v_add_f32_e64 v255, v255, v121
    v_cvt_pk_bf16_f32 v140, v120, v121
    v_exp_f32 v123, v123
    v_add_f32 v255, v255, v122
    v_mfma_f32_32x32x16_bf16 a[96:111], a[188:191], v[228:231], a[96:111]
    buffer_load_dwordx4 v152, s[16:19], s62 offen lds
    v_exp_f32 v124, v124
    v_add_f32 v255, v255, v123
    v_cvt_pk_bf16_f32 v141, v122, v123
    v_exp_f32 v125, v125
    v_add_f32 v255, v255, v124
    v_mfma_f32_32x32x16_bf16 a[112:127], a[188:191], v[236:239], a[112:127]
    v_exp_f32 v126, v126
    v_add_f32 v255, v255, v125
    v_cvt_pk_bf16_f32 v142, v124, v125
    v_exp_f32 v127, v127
    v_add_f32 v255, v255, v126
    v_add_f32_e64 v255, v255, v127
    v_cvt_pk_bf16_f32 v143, v126, v127
    v_mov_b32 v88, v254
    v_mov_b32 v89, v255
    s_nop 0
    v_permlane32_swap_b32 v254, v88
    v_permlane32_swap_b32 v255, v89
    v_add_f32 v254, v254, v88
    v_add_f32_e64 v255, v255, v89
    s_mov_b32 s3, 0x67800000
    v_add_f32 v88, v254, v255
    v_cmp_ngt_f32 vcc, s3, v88
    v_mbcnt_lo_u32_b32 v90, -1, 0
    v_mbcnt_hi_u32_b32 v90, -1, v90
    s_nop 2
    s_cbranch_vccnz L_exact
L_exact_ret:
    s_waitcnt lgkmcnt(14)
    v_mfma_f32_32x32x16_bf16 a[0:15], a[128:131], v[128:131], a[0:15]
    s_cmp_gt_u32 s57, 3
    s_cselect_b32 s62, 3, 4
    s_mul_i32 s62, s62, 163840
    v_rcp_f32 v92, v254
    s_waitcnt lgkmcnt(6)
    v_mfma_f32_32x32x16_bf16 a[0:15], a[144:147], v[132:135], a[0:15]
    s_add_u32 s62, s62, s49
    s_add_u32 m0, s51, 143360
    v_rcp_f32 v94, v255
    v_lshrrev_b32 v88, 5, v90
    v_mfma_f32_32x32x16_bf16 a[16:31], a[128:131], v[136:139], a[16:31]
    buffer_load_dwordx4 v148, s[16:19], s62 offen offset:0 lds
    v_bfe_u32 v89, v90, 2, 3
    v_lshl_add_u32 v88, v88, 4, v89
    v_mul_u32_u24 v88, 160, v88
    v_mfma_f32_32x32x16_bf16 a[16:31], a[144:147], v[140:143], a[16:31]
    buffer_load_dwordx4 v149, s[16:19], s62 offen offset:1024 lds
    v_and_b32_e64 v89, 3, v90
    v_lshl_add_u32 v84, v89, 3, v88
    v_add_u32 v85, 57344, v84
    v_mfma_f32_32x32x16_bf16 a[32:47], a[132:135], v[128:131], a[32:47]
    buffer_load_dwordx4 v150, s[16:19], s62 offen offset:2048 lds
    v_add_u32 v86, 114688, v84
    s_mov_b32 s98, 0
    s_mov_b32 s99, 4096
    s_waitcnt lgkmcnt(4)
    v_mfma_f32_32x32x16_bf16 a[32:47], a[148:151], v[132:135], a[32:47]
    buffer_load_dwordx4 v151, s[16:19], s62 offen offset:3072 lds
    s_add_u32 m0, m0, 4096
    s_mov_b32 s100, 8192
    s_mov_b32 s101, 12288
    v_mfma_f32_32x32x16_bf16 a[48:63], a[132:135], v[136:139], a[48:63]
    buffer_load_dwordx4 v152, s[16:19], s62 offen lds
    v_accvgpr_read_b32 v0, a0
    v_accvgpr_read_b32 v1, a1
    v_accvgpr_read_b32 v2, a2
    v_mfma_f32_32x32x16_bf16 a[48:63], a[148:151], v[140:143], a[48:63]
    v_accvgpr_read_b32 v3, a3
    v_accvgpr_read_b32 v4, a4
    v_accvgpr_read_b32 v5, a5
    v_accvgpr_read_b32 v6, a6
    v_accvgpr_read_b32 v7, a7
    v_mfma_f32_32x32x16_bf16 a[64:79], a[136:139], v[128:131], a[64:79]
    v_accvgpr_read_b32 v8, a8
    v_accvgpr_read_b32 v9, a9
    v_accvgpr_read_b32 v10, a10
    v_accvgpr_read_b32 v11, a11
    v_accvgpr_read_b32 v12, a12
    s_waitcnt lgkmcnt(2)
    v_mfma_f32_32x32x16_bf16 a[64:79], a[152:155], v[132:135], a[64:79]
    v_accvgpr_read_b32 v13, a13
    v_accvgpr_read_b32 v14, a14
    v_accvgpr_read_b32 v15, a15
    v_mul_f32 v0, v92, v0
    v_mul_f32_e64 v1, v92, v1
    v_mfma_f32_32x32x16_bf16 a[80:95], a[136:139], v[136:139], a[80:95]
    v_mul_f32 v2, v92, v2
    v_mul_f32 v3, v92, v3
    v_mul_f32 v4, v92, v4
    v_mul_f32 v5, v92, v5
    v_mul_f32_e64 v6, v92, v6
    v_mfma_f32_32x32x16_bf16 a[80:95], a[152:155], v[140:143], a[80:95]
    v_mul_f32 v7, v92, v7
    v_mul_f32 v8, v92, v8
    v_mul_f32 v9, v92, v9
    v_mul_f32 v10, v92, v10
    v_mul_f32_e64 v11, v92, v11
    v_mfma_f32_32x32x16_bf16 a[96:111], a[140:143], v[128:131], a[96:111]
    v_mul_f32 v12, v92, v12
    v_mul_f32 v13, v92, v13
    v_mul_f32_e64 v14, v92, v14
    v_mul_f32 v15, v92, v15
    v_cvt_pk_bf16_f32 v160, v0, v1
    s_waitcnt lgkmcnt(0)
    v_mfma_f32_32x32x16_bf16 a[96:111], a[156:159], v[132:135], a[96:111]
    v_cvt_pk_bf16_f32 v161, v2, v3
    v_cvt_pk_bf16_f32 v162, v4, v5
    v_cvt_pk_bf16_f32 v163, v6, v7
    v_cvt_pk_bf16_f32 v164, v8, v9
    v_cvt_pk_bf16_f32 v165, v10, v11
    v_mfma_f32_32x32x16_bf16 a[112:127], a[140:143], v[136:139], a[112:127]
    v_cvt_pk_bf16_f32 v166, v12, v13
    v_cvt_pk_bf16_f32 v167, v14, v15
    v_permlane16_swap_b32 v160, v164
    v_permlane16_swap_b32 v161, v165
    v_permlane16_swap_b32 v162, v166
    v_mfma_f32_32x32x16_bf16 a[112:127], a[156:159], v[140:143], a[112:127]
    v_permlane16_swap_b32 v163, v167
    buffer_store_dwordx4 v[160:163], v253, s[20:23], s98 offen offset:0 sc1
    buffer_store_dwordx4 v[164:167], v253, s[20:23], s98 offen offset:1024 sc1
    v_accvgpr_read_b32 v16, a16
    v_accvgpr_read_b32 v17, a17
    v_accvgpr_read_b32 v18, a18
    v_accvgpr_read_b32 v19, a19
    v_accvgpr_read_b32 v20, a20
    v_accvgpr_read_b32 v21, a21
    v_accvgpr_read_b32 v22, a22
    v_accvgpr_read_b32 v23, a23
    v_accvgpr_read_b32 v24, a24
    v_accvgpr_read_b32 v25, a25
    v_accvgpr_read_b32 v26, a26
    v_accvgpr_read_b32 v27, a27
    v_accvgpr_read_b32 v28, a28
    v_accvgpr_read_b32 v29, a29
    v_accvgpr_read_b32 v30, a30
    v_accvgpr_read_b32 v31, a31
    v_pk_mul_f32 v[16:17], v[16:17], v[94:95] op_sel_hi:[1,0]
    v_pk_mul_f32 v[18:19], v[18:19], v[94:95] op_sel_hi:[1,0]
    v_pk_mul_f32 v[20:21], v[20:21], v[94:95] op_sel_hi:[1,0]
    v_pk_mul_f32 v[22:23], v[22:23], v[94:95] op_sel_hi:[1,0]
    v_pk_mul_f32 v[24:25], v[24:25], v[94:95] op_sel_hi:[1,0]
    v_pk_mul_f32 v[26:27], v[26:27], v[94:95] op_sel_hi:[1,0]
    v_pk_mul_f32 v[28:29], v[28:29], v[94:95] op_sel_hi:[1,0]
    v_pk_mul_f32 v[30:31], v[30:31], v[94:95] op_sel_hi:[1,0]
    v_cvt_pk_bf16_f32 v168, v16, v17
    v_cvt_pk_bf16_f32 v169, v18, v19
    v_cvt_pk_bf16_f32 v170, v20, v21
    v_cvt_pk_bf16_f32 v171, v22, v23
    v_cvt_pk_bf16_f32 v172, v24, v25
    v_cvt_pk_bf16_f32 v173, v26, v27
    v_cvt_pk_bf16_f32 v174, v28, v29
    v_cvt_pk_bf16_f32 v175, v30, v31
    v_permlane16_swap_b32 v168, v172
    v_permlane16_swap_b32 v169, v173
    v_permlane16_swap_b32 v170, v174
    v_permlane16_swap_b32 v171, v175
    buffer_store_dwordx4 v[168:171], v253, s[20:23], s98 offen offset:2048 sc1
    buffer_store_dwordx4 v[172:175], v253, s[20:23], s98 offen offset:3072 sc1
    v_accvgpr_read_b32 v32, a32
    v_accvgpr_read_b32 v33, a33
    v_accvgpr_read_b32 v34, a34
    v_accvgpr_read_b32 v35, a35
    v_accvgpr_read_b32 v36, a36
    v_accvgpr_read_b32 v37, a37
    v_accvgpr_read_b32 v38, a38
    v_accvgpr_read_b32 v39, a39
    v_accvgpr_read_b32 v40, a40
    v_accvgpr_read_b32 v41, a41
    v_accvgpr_read_b32 v42, a42
    v_accvgpr_read_b32 v43, a43
    v_accvgpr_read_b32 v44, a44
    v_accvgpr_read_b32 v45, a45
    v_accvgpr_read_b32 v46, a46
    v_accvgpr_read_b32 v47, a47
    v_pk_mul_f32 v[32:33], v[32:33], v[92:93] op_sel_hi:[1,0]
    v_pk_mul_f32 v[34:35], v[34:35], v[92:93] op_sel_hi:[1,0]
    v_pk_mul_f32 v[36:37], v[36:37], v[92:93] op_sel_hi:[1,0]
    v_pk_mul_f32 v[38:39], v[38:39], v[92:93] op_sel_hi:[1,0]
    v_pk_mul_f32 v[40:41], v[40:41], v[92:93] op_sel_hi:[1,0]
    v_pk_mul_f32 v[42:43], v[42:43], v[92:93] op_sel_hi:[1,0]
    v_pk_mul_f32 v[44:45], v[44:45], v[92:93] op_sel_hi:[1,0]
    v_pk_mul_f32 v[46:47], v[46:47], v[92:93] op_sel_hi:[1,0]
    v_cvt_pk_bf16_f32 v176, v32, v33
    v_cvt_pk_bf16_f32 v177, v34, v35
    v_cvt_pk_bf16_f32 v178, v36, v37
    v_cvt_pk_bf16_f32 v179, v38, v39
    v_cvt_pk_bf16_f32 v180, v40, v41
    v_cvt_pk_bf16_f32 v181, v42, v43
    v_cvt_pk_bf16_f32 v182, v44, v45
    v_cvt_pk_bf16_f32 v183, v46, v47
    v_permlane16_swap_b32 v176, v180
    v_permlane16_swap_b32 v177, v181
    v_permlane16_swap_b32 v178, v182
    v_permlane16_swap_b32 v179, v183
    buffer_store_dwordx4 v[176:179], v253, s[20:23], s99 offen offset:0 sc1
    buffer_store_dwordx4 v[180:183], v253, s[20:23], s99 offen offset:1024 sc1
    v_accvgpr_read_b32 v48, a48
    v_accvgpr_read_b32 v49, a49
    v_accvgpr_read_b32 v50, a50
    v_accvgpr_read_b32 v51, a51
    v_accvgpr_read_b32 v52, a52
    v_accvgpr_read_b32 v53, a53
    v_accvgpr_read_b32 v54, a54
    v_accvgpr_read_b32 v55, a55
    v_accvgpr_read_b32 v56, a56
    v_accvgpr_read_b32 v57, a57
    v_accvgpr_read_b32 v58, a58
    v_accvgpr_read_b32 v59, a59
    v_accvgpr_read_b32 v60, a60
    v_accvgpr_read_b32 v61, a61
    v_accvgpr_read_b32 v62, a62
    v_accvgpr_read_b32 v63, a63
    v_pk_mul_f32 v[48:49], v[48:49], v[94:95] op_sel_hi:[1,0]
    v_pk_mul_f32 v[50:51], v[50:51], v[94:95] op_sel_hi:[1,0]
    v_pk_mul_f32 v[52:53], v[52:53], v[94:95] op_sel_hi:[1,0]
    v_pk_mul_f32 v[54:55], v[54:55], v[94:95] op_sel_hi:[1,0]
    v_pk_mul_f32 v[56:57], v[56:57], v[94:95] op_sel_hi:[1,0]
    v_pk_mul_f32 v[58:59], v[58:59], v[94:95] op_sel_hi:[1,0]
    v_pk_mul_f32 v[60:61], v[60:61], v[94:95] op_sel_hi:[1,0]
    v_pk_mul_f32 v[62:63], v[62:63], v[94:95] op_sel_hi:[1,0]
    v_cvt_pk_bf16_f32 v184, v48, v49
    v_cvt_pk_bf16_f32 v185, v50, v51
    v_cvt_pk_bf16_f32 v186, v52, v53
    v_cvt_pk_bf16_f32 v187, v54, v55
    v_cvt_pk_bf16_f32 v188, v56, v57
    v_cvt_pk_bf16_f32 v189, v58, v59
    v_cvt_pk_bf16_f32 v190, v60, v61
    v_cvt_pk_bf16_f32 v191, v62, v63
    v_permlane16_swap_b32 v184, v188
    v_permlane16_swap_b32 v185, v189
    v_permlane16_swap_b32 v186, v190
    v_permlane16_swap_b32 v187, v191
    buffer_store_dwordx4 v[184:187], v253, s[20:23], s99 offen offset:2048 sc1
    buffer_store_dwordx4 v[188:191], v253, s[20:23], s99 offen offset:3072 sc1
    v_accvgpr_read_b32 v0, a64
    v_accvgpr_read_b32 v1, a65
    v_accvgpr_read_b32 v2, a66
    v_accvgpr_read_b32 v3, a67
    v_accvgpr_read_b32 v4, a68
    v_accvgpr_read_b32 v5, a69
    v_accvgpr_read_b32 v6, a70
    v_accvgpr_read_b32 v7, a71
    v_accvgpr_read_b32 v8, a72
    v_accvgpr_read_b32 v9, a73
    v_accvgpr_read_b32 v10, a74
    v_accvgpr_read_b32 v11, a75
    v_accvgpr_read_b32 v12, a76
    v_accvgpr_read_b32 v13, a77
    v_accvgpr_read_b32 v14, a78
    v_accvgpr_read_b32 v15, a79
    v_pk_mul_f32 v[0:1], v[0:1], v[92:93] op_sel_hi:[1,0]
    v_pk_mul_f32 v[2:3], v[2:3], v[92:93] op_sel_hi:[1,0]
    v_pk_mul_f32 v[4:5], v[4:5], v[92:93] op_sel_hi:[1,0]
    v_pk_mul_f32 v[6:7], v[6:7], v[92:93] op_sel_hi:[1,0]
    v_pk_mul_f32 v[8:9], v[8:9], v[92:93] op_sel_hi:[1,0]
    v_pk_mul_f32 v[10:11], v[10:11], v[92:93] op_sel_hi:[1,0]
    v_pk_mul_f32 v[12:13], v[12:13], v[92:93] op_sel_hi:[1,0]
    v_pk_mul_f32 v[14:15], v[14:15], v[92:93] op_sel_hi:[1,0]
    v_cvt_pk_bf16_f32 v192, v0, v1
    v_cvt_pk_bf16_f32 v193, v2, v3
    v_cvt_pk_bf16_f32 v194, v4, v5
    v_cvt_pk_bf16_f32 v195, v6, v7
    v_cvt_pk_bf16_f32 v196, v8, v9
    v_cvt_pk_bf16_f32 v197, v10, v11
    v_cvt_pk_bf16_f32 v198, v12, v13
    v_cvt_pk_bf16_f32 v199, v14, v15
    v_permlane16_swap_b32 v192, v196
    v_permlane16_swap_b32 v193, v197
    v_permlane16_swap_b32 v194, v198
    v_permlane16_swap_b32 v195, v199
    buffer_store_dwordx4 v[192:195], v253, s[20:23], s100 offen offset:0 sc1
    buffer_store_dwordx4 v[196:199], v253, s[20:23], s100 offen offset:1024 sc1
    v_accvgpr_read_b32 v16, a80
    v_accvgpr_read_b32 v17, a81
    v_accvgpr_read_b32 v18, a82
    v_accvgpr_read_b32 v19, a83
    v_accvgpr_read_b32 v20, a84
    v_accvgpr_read_b32 v21, a85
    v_accvgpr_read_b32 v22, a86
    v_accvgpr_read_b32 v23, a87
    v_accvgpr_read_b32 v24, a88
    v_accvgpr_read_b32 v25, a89
    v_accvgpr_read_b32 v26, a90
    v_accvgpr_read_b32 v27, a91
    v_accvgpr_read_b32 v28, a92
    v_accvgpr_read_b32 v29, a93
    v_accvgpr_read_b32 v30, a94
    v_accvgpr_read_b32 v31, a95
    v_pk_mul_f32 v[16:17], v[16:17], v[94:95] op_sel_hi:[1,0]
    v_pk_mul_f32 v[18:19], v[18:19], v[94:95] op_sel_hi:[1,0]
    v_pk_mul_f32 v[20:21], v[20:21], v[94:95] op_sel_hi:[1,0]
    v_pk_mul_f32 v[22:23], v[22:23], v[94:95] op_sel_hi:[1,0]
    v_pk_mul_f32 v[24:25], v[24:25], v[94:95] op_sel_hi:[1,0]
    v_pk_mul_f32 v[26:27], v[26:27], v[94:95] op_sel_hi:[1,0]
    v_pk_mul_f32 v[28:29], v[28:29], v[94:95] op_sel_hi:[1,0]
    v_pk_mul_f32 v[30:31], v[30:31], v[94:95] op_sel_hi:[1,0]
    v_cvt_pk_bf16_f32 v200, v16, v17
    v_cvt_pk_bf16_f32 v201, v18, v19
    v_cvt_pk_bf16_f32 v202, v20, v21
    v_cvt_pk_bf16_f32 v203, v22, v23
    v_cvt_pk_bf16_f32 v204, v24, v25
    v_cvt_pk_bf16_f32 v205, v26, v27
    v_cvt_pk_bf16_f32 v206, v28, v29
    v_cvt_pk_bf16_f32 v207, v30, v31
    v_permlane16_swap_b32 v200, v204
    v_permlane16_swap_b32 v201, v205
    v_permlane16_swap_b32 v202, v206
    v_permlane16_swap_b32 v203, v207
    buffer_store_dwordx4 v[200:203], v253, s[20:23], s100 offen offset:2048 sc1
    buffer_store_dwordx4 v[204:207], v253, s[20:23], s100 offen offset:3072 sc1
    ds_read_b64_tr_b16 a[160:161], v84 offset:25600
    ds_read_b64_tr_b16 a[162:163], v84 offset:26880
    ds_read_b64_tr_b16 a[164:165], v84 offset:25632
    ds_read_b64_tr_b16 a[166:167], v84 offset:26912
    ds_read_b64_tr_b16 a[168:169], v84 offset:25664
    ds_read_b64_tr_b16 a[170:171], v84 offset:26944
    ds_read_b64_tr_b16 a[172:173], v84 offset:25696
    ds_read_b64_tr_b16 a[174:175], v84 offset:26976
    ds_read_b64_tr_b16 a[176:177], v84 offset:25728
    ds_read_b64_tr_b16 a[178:179], v84 offset:27008
    v_accvgpr_read_b32 v32, a96
    v_accvgpr_read_b32 v33, a97
    v_accvgpr_read_b32 v34, a98
    v_accvgpr_read_b32 v35, a99
    v_accvgpr_read_b32 v36, a100
    v_accvgpr_read_b32 v37, a101
    v_accvgpr_read_b32 v38, a102
    v_accvgpr_read_b32 v39, a103
    v_accvgpr_read_b32 v40, a104
    v_accvgpr_read_b32 v41, a105
    v_accvgpr_read_b32 v42, a106
    v_accvgpr_read_b32 v43, a107
    v_accvgpr_read_b32 v44, a108
    v_accvgpr_read_b32 v45, a109
    v_accvgpr_read_b32 v46, a110
    v_accvgpr_read_b32 v47, a111
    v_pk_mul_f32 v[32:33], v[32:33], v[92:93] op_sel_hi:[1,0]
    v_pk_mul_f32 v[34:35], v[34:35], v[92:93] op_sel_hi:[1,0]
    v_pk_mul_f32 v[36:37], v[36:37], v[92:93] op_sel_hi:[1,0]
    v_pk_mul_f32 v[38:39], v[38:39], v[92:93] op_sel_hi:[1,0]
    v_pk_mul_f32 v[40:41], v[40:41], v[92:93] op_sel_hi:[1,0]
    v_pk_mul_f32 v[42:43], v[42:43], v[92:93] op_sel_hi:[1,0]
    v_pk_mul_f32 v[44:45], v[44:45], v[92:93] op_sel_hi:[1,0]
    v_pk_mul_f32 v[46:47], v[46:47], v[92:93] op_sel_hi:[1,0]
    v_cvt_pk_bf16_f32 v208, v32, v33
    v_cvt_pk_bf16_f32 v209, v34, v35
    v_cvt_pk_bf16_f32 v210, v36, v37
    v_cvt_pk_bf16_f32 v211, v38, v39
    v_cvt_pk_bf16_f32 v212, v40, v41
    v_cvt_pk_bf16_f32 v213, v42, v43
    v_cvt_pk_bf16_f32 v214, v44, v45
    v_cvt_pk_bf16_f32 v215, v46, v47
    v_permlane16_swap_b32 v208, v212
    v_permlane16_swap_b32 v209, v213
    v_permlane16_swap_b32 v210, v214
    v_permlane16_swap_b32 v211, v215
    buffer_store_dwordx4 v[208:211], v253, s[20:23], s101 offen offset:0 sc1
    buffer_store_dwordx4 v[212:215], v253, s[20:23], s101 offen offset:1024 sc1
    v_accvgpr_read_b32 v48, a112
    v_accvgpr_read_b32 v49, a113
    v_accvgpr_read_b32 v50, a114
    v_accvgpr_read_b32 v51, a115
    v_accvgpr_read_b32 v52, a116
    v_accvgpr_read_b32 v53, a117
    v_accvgpr_read_b32 v54, a118
    v_accvgpr_read_b32 v55, a119
    v_accvgpr_read_b32 v56, a120
    v_accvgpr_read_b32 v57, a121
    v_accvgpr_read_b32 v58, a122
    v_accvgpr_read_b32 v59, a123
    v_accvgpr_read_b32 v60, a124
    v_accvgpr_read_b32 v61, a125
    v_accvgpr_read_b32 v62, a126
    v_accvgpr_read_b32 v63, a127
    v_pk_mul_f32 v[48:49], v[48:49], v[94:95] op_sel_hi:[1,0]
    v_pk_mul_f32 v[50:51], v[50:51], v[94:95] op_sel_hi:[1,0]
    v_pk_mul_f32 v[52:53], v[52:53], v[94:95] op_sel_hi:[1,0]
    v_pk_mul_f32 v[54:55], v[54:55], v[94:95] op_sel_hi:[1,0]
    v_pk_mul_f32 v[56:57], v[56:57], v[94:95] op_sel_hi:[1,0]
    v_pk_mul_f32 v[58:59], v[58:59], v[94:95] op_sel_hi:[1,0]
    v_pk_mul_f32 v[60:61], v[60:61], v[94:95] op_sel_hi:[1,0]
    v_pk_mul_f32 v[62:63], v[62:63], v[94:95] op_sel_hi:[1,0]
    v_cvt_pk_bf16_f32 v216, v48, v49
    v_cvt_pk_bf16_f32 v217, v50, v51
    v_cvt_pk_bf16_f32 v218, v52, v53
    v_cvt_pk_bf16_f32 v219, v54, v55
    v_cvt_pk_bf16_f32 v220, v56, v57
    v_cvt_pk_bf16_f32 v221, v58, v59
    v_cvt_pk_bf16_f32 v222, v60, v61
    v_cvt_pk_bf16_f32 v223, v62, v63
    v_permlane16_swap_b32 v216, v220
    v_permlane16_swap_b32 v217, v221
    v_permlane16_swap_b32 v218, v222
    v_permlane16_swap_b32 v219, v223
    buffer_store_dwordx4 v[216:219], v253, s[20:23], s101 offen offset:2048 sc1
    buffer_store_dwordx4 v[220:223], v253, s[20:23], s101 offen offset:3072 sc1
    s_waitcnt lgkmcnt(0)
    v_mfma_f32_16x16x32_bf16 v[0:3], a[160:163], v[160:163], 0
    v_mfma_f32_16x16x32_bf16 v[20:23], a[160:163], v[164:167], 0
    ds_read_b64_tr_b16 a[180:181], v84 offset:30720
    v_mfma_f32_16x16x32_bf16 v[40:43], a[160:163], v[168:171], 0
    ds_read_b64_tr_b16 a[182:183], v84 offset:32000
    v_mfma_f32_16x16x32_bf16 v[60:63], a[160:163], v[172:175], 0
    ds_read_b64_tr_b16 a[184:185], v84 offset:30752
    v_mfma_f32_16x16x32_bf16 v[4:7], a[164:167], v[160:163], 0
    ds_read_b64_tr_b16 a[186:187], v84 offset:32032
    v_mfma_f32_16x16x32_bf16 v[24:27], a[164:167], v[164:167], 0
    s_lshl_b32 s62, s56, 2
    v_mfma_f32_16x16x32_bf16 v[44:47], a[164:167], v[168:171], 0
    ds_read_b64_tr_b16 a[188:189], v84 offset:30784
    v_mfma_f32_16x16x32_bf16 v[64:67], a[164:167], v[172:175], 0
    ds_read_b64_tr_b16 a[190:191], v84 offset:32064
    v_mfma_f32_16x16x32_bf16 v[8:11], a[168:171], v[160:163], 0
    ds_read_b64_tr_b16 a[192:193], v84 offset:30816
    v_mfma_f32_16x16x32_bf16 v[28:31], a[168:171], v[164:167], 0
    s_add_u32 s62, s62, s60
    v_mfma_f32_16x16x32_bf16 v[48:51], a[168:171], v[168:171], 0
    ds_read_b64_tr_b16 a[194:195], v84 offset:32096
    v_mfma_f32_16x16x32_bf16 v[68:71], a[168:171], v[172:175], 0
    ds_read_b64_tr_b16 a[196:197], v84 offset:30848
    v_mfma_f32_16x16x32_bf16 v[12:15], a[172:175], v[160:163], 0
    ds_read_b64_tr_b16 a[198:199], v84 offset:32128
    v_mfma_f32_16x16x32_bf16 v[32:35], a[172:175], v[164:167], 0
    s_lshl_b32 s62, s62, 2
    v_mfma_f32_16x16x32_bf16 v[52:55], a[172:175], v[168:171], 0
    s_add_u32 s62, s62, s50
    v_mfma_f32_16x16x32_bf16 v[72:75], a[172:175], v[172:175], 0
    s_add_u32 s4, s62, 32
    v_mfma_f32_16x16x32_bf16 v[16:19], a[176:179], v[160:163], 0
    s_lshl_b32 s61, s62, 17
    v_mfma_f32_16x16x32_bf16 v[36:39], a[176:179], v[164:167], 0
    s_add_u32 s61, s61, 35651584
    v_mfma_f32_16x16x32_bf16 v[56:59], a[176:179], v[168:171], 0
    s_cmp_eq_u32 s57, 0
    s_cselect_b32 s12, 16384, 0
    v_mfma_f32_16x16x32_bf16 v[76:79], a[176:179], v[172:175], 0
    s_waitcnt lgkmcnt(0)
    v_mfma_f32_16x16x32_bf16 v[0:3], a[180:183], v[176:179], v[0:3]
    v_mfma_f32_16x16x32_bf16 v[20:23], a[180:183], v[180:183], v[20:23]
    ds_read_b64_tr_b16 a[160:161], v84 offset:35840
    v_mfma_f32_16x16x32_bf16 v[40:43], a[180:183], v[184:187], v[40:43]
    ds_read_b64_tr_b16 a[162:163], v84 offset:37120
    v_mfma_f32_16x16x32_bf16 v[60:63], a[180:183], v[188:191], v[60:63]
    ds_read_b64_tr_b16 a[164:165], v84 offset:35872
    v_mfma_f32_16x16x32_bf16 v[4:7], a[184:187], v[176:179], v[4:7]
    ds_read_b64_tr_b16 a[166:167], v84 offset:37152
    v_mfma_f32_16x16x32_bf16 v[24:27], a[184:187], v[180:183], v[24:27]
    s_mov_b32 s98, s12
    v_mfma_f32_16x16x32_bf16 v[44:47], a[184:187], v[184:187], v[44:47]
    ds_read_b64_tr_b16 a[168:169], v84 offset:35904
    v_mfma_f32_16x16x32_bf16 v[64:67], a[184:187], v[188:191], v[64:67]
    ds_read_b64_tr_b16 a[170:171], v84 offset:37184
    v_mfma_f32_16x16x32_bf16 v[8:11], a[188:191], v[176:179], v[8:11]
    ds_read_b64_tr_b16 a[172:173], v84 offset:35936
    v_mfma_f32_16x16x32_bf16 v[28:31], a[188:191], v[180:183], v[28:31]
    s_add_u32 s8, s90, s61
    s_addc_u32 s9, s91, 0
    v_mfma_f32_16x16x32_bf16 v[48:51], a[188:191], v[184:187], v[48:51]
    ds_read_b64_tr_b16 a[174:175], v84 offset:37216
    v_mfma_f32_16x16x32_bf16 v[68:71], a[188:191], v[188:191], v[68:71]
    ds_read_b64_tr_b16 a[176:177], v84 offset:35968
    v_mfma_f32_16x16x32_bf16 v[12:15], a[192:195], v[176:179], v[12:15]
    ds_read_b64_tr_b16 a[178:179], v84 offset:37248
    v_mfma_f32_16x16x32_bf16 v[32:35], a[192:195], v[180:183], v[32:35]
    s_mov_b32 s10, 131072
    v_mfma_f32_16x16x32_bf16 v[52:55], a[192:195], v[184:187], v[52:55]
    s_mov_b32 s11, 0x00020000
    v_mfma_f32_16x16x32_bf16 v[72:75], a[192:195], v[188:191], v[72:75]
    v_lshrrev_b32_e64 v252, 4, v90
    v_mfma_f32_16x16x32_bf16 v[16:19], a[196:199], v[176:179], v[16:19]
    v_and_b32 v251, 15, v90
    v_mfma_f32_16x16x32_bf16 v[36:39], a[196:199], v[180:183], v[36:39]
    s_lshl_b32 s61, s56, 2
    v_mfma_f32_16x16x32_bf16 v[56:59], a[196:199], v[184:187], v[56:59]
    s_add_u32 s61, s61, s60
    v_mfma_f32_16x16x32_bf16 v[76:79], a[196:199], v[188:191], v[76:79]
    s_waitcnt lgkmcnt(0)
    v_mfma_f32_16x16x32_bf16 v[0:3], a[160:163], v[192:195], v[0:3]
    v_mfma_f32_16x16x32_bf16 v[20:23], a[160:163], v[196:199], v[20:23]
    ds_read_b64_tr_b16 a[180:181], v84 offset:40960
    v_mfma_f32_16x16x32_bf16 v[40:43], a[160:163], v[200:203], v[40:43]
    ds_read_b64_tr_b16 a[182:183], v84 offset:42240
    v_mfma_f32_16x16x32_bf16 v[60:63], a[160:163], v[204:207], v[60:63]
    ds_read_b64_tr_b16 a[184:185], v84 offset:40992
    v_mfma_f32_16x16x32_bf16 v[4:7], a[164:167], v[192:195], v[4:7]
    ds_read_b64_tr_b16 a[186:187], v84 offset:42272
    v_mfma_f32_16x16x32_bf16 v[24:27], a[164:167], v[196:199], v[24:27]
    s_lshl_b32 s61, s61, 2
    v_mfma_f32_16x16x32_bf16 v[44:47], a[164:167], v[200:203], v[44:47]
    ds_read_b64_tr_b16 a[188:189], v84 offset:41024
    v_mfma_f32_16x16x32_bf16 v[64:67], a[164:167], v[204:207], v[64:67]
    ds_read_b64_tr_b16 a[190:191], v84 offset:42304
    v_mfma_f32_16x16x32_bf16 v[8:11], a[168:171], v[192:195], v[8:11]
    ds_read_b64_tr_b16 a[192:193], v84 offset:41056
    v_mfma_f32_16x16x32_bf16 v[28:31], a[168:171], v[196:199], v[28:31]
    s_add_u32 s61, s61, s50
    v_mfma_f32_16x16x32_bf16 v[48:51], a[168:171], v[200:203], v[48:51]
    ds_read_b64_tr_b16 a[194:195], v84 offset:42336
    v_mfma_f32_16x16x32_bf16 v[68:71], a[168:171], v[204:207], v[68:71]
    ds_read_b64_tr_b16 a[196:197], v84 offset:41088
    v_mfma_f32_16x16x32_bf16 v[12:15], a[172:175], v[192:195], v[12:15]
    ds_read_b64_tr_b16 a[198:199], v84 offset:42368
    v_mfma_f32_16x16x32_bf16 v[32:35], a[172:175], v[196:199], v[32:35]
    s_lshl_b32 s61, s61, 4
    v_mfma_f32_16x16x32_bf16 v[52:55], a[172:175], v[200:203], v[52:55]
    v_add_u32 v251, s61, v251
    v_mfma_f32_16x16x32_bf16 v[72:75], a[172:175], v[204:207], v[72:75]
    v_mul_u32_u24 v250, 1280, v251
    v_mfma_f32_16x16x32_bf16 v[16:19], a[176:179], v[192:195], v[16:19]
    v_lshl_add_u32 v250, v252, 3, v250
    v_mfma_f32_16x16x32_bf16 v[36:39], a[176:179], v[196:199], v[36:39]
    s_mul_i32 s61, s57, 160
    v_mfma_f32_16x16x32_bf16 v[56:59], a[176:179], v[200:203], v[56:59]
    v_add_u32 v250, s61, v250
    v_mfma_f32_16x16x32_bf16 v[76:79], a[176:179], v[204:207], v[76:79]
    s_waitcnt lgkmcnt(0)
    v_mfma_f32_16x16x32_bf16 v[0:3], a[180:183], v[208:211], v[0:3]
    v_mfma_f32_16x16x32_bf16 v[20:23], a[180:183], v[212:215], v[20:23]
    v_mfma_f32_16x16x32_bf16 v[40:43], a[180:183], v[216:219], v[40:43]
    v_mfma_f32_16x16x32_bf16 v[60:63], a[180:183], v[220:223], v[60:63]
    v_mfma_f32_16x16x32_bf16 v[4:7], a[184:187], v[208:211], v[4:7]
    v_mfma_f32_16x16x32_bf16 v[24:27], a[184:187], v[212:215], v[24:27]
    v_mfma_f32_16x16x32_bf16 v[44:47], a[184:187], v[216:219], v[44:47]
    v_mfma_f32_16x16x32_bf16 v[64:67], a[184:187], v[220:223], v[64:67]
    v_mfma_f32_16x16x32_bf16 v[8:11], a[188:191], v[208:211], v[8:11]
    v_mfma_f32_16x16x32_bf16 v[28:31], a[188:191], v[212:215], v[28:31]
    v_mfma_f32_16x16x32_bf16 v[48:51], a[188:191], v[216:219], v[48:51]
    v_mfma_f32_16x16x32_bf16 v[68:71], a[188:191], v[220:223], v[68:71]
    v_mfma_f32_16x16x32_bf16 v[12:15], a[192:195], v[208:211], v[12:15]
    v_mfma_f32_16x16x32_bf16 v[32:35], a[192:195], v[212:215], v[32:35]
    v_mfma_f32_16x16x32_bf16 v[52:55], a[192:195], v[216:219], v[52:55]
    v_mfma_f32_16x16x32_bf16 v[72:75], a[192:195], v[220:223], v[72:75]
    v_add_u32 v254, 4096, v253
    v_mfma_f32_16x16x32_bf16 v[16:19], a[196:199], v[208:211], v[16:19]
    v_lshrrev_b32_e64 v88, 1, v252
    v_mfma_f32_16x16x32_bf16 v[36:39], a[196:199], v[212:215], v[36:39]
    v_lshlrev_b32_e64 v88, 6, v88
    v_mfma_f32_16x16x32_bf16 v[56:59], a[196:199], v[216:219], v[56:59]
    v_and_b32_e64 v89, 1, v252
    v_mfma_f32_16x16x32_bf16 v[76:79], a[196:199], v[220:223], v[76:79]
    v_lshl_add_u32 v88, v89, 4, v88
    s_waitcnt vmcnt(0)
    s_lshl_b32 s63, s4, 8
    s_add_u32 s63, s63, 262144
    v_mov_b32 v91, s63
    v_mov_b32 v92, 1
    s_mov_b64 exec, 1
    global_atomic_add v91, v92, s[90:91] sc1
    s_mov_b64 exec, -1
    ds_read_b128 v[220:223], v88 offset:640
    ds_read_b128 a[200:203], v88 offset:672
    ds_read_b128 v[224:227], v88 offset:768
    ds_read_b128 a[204:207], v88 offset:800
    ds_read_b128 v[228:231], v88 offset:896
    ds_read_b128 a[208:211], v88 offset:928
    ds_read_b128 v[232:235], v88 offset:1024
    ds_read_b128 a[212:215], v88 offset:1056
    ds_read_b128 v[236:239], v88 offset:1152
    ds_read_b128 a[216:219], v88 offset:1184
    v_lshrrev_b32 v214, 5, v90
    v_lshlrev_b32 v218, 6, v214
    v_lshlrev_b32_e64 v219, 10, v214
    v_bfe_u32 v214, v90, 2, 2
    v_lshl_add_u32 v219, v214, 7, v219
    v_bfe_u32 v214, v90, 4, 1
    v_lshl_add_u32 v219, v214, 11, v219
    v_and_b32_e64 v214, 3, v90
    v_lshl_add_u32 v219, v214, 3, v219
    s_lshl_b32 s3, s60, 5
    v_add_u32 v219, s3, v219
    ds_read_b64_tr_b16 v[192:193], v219 offset:1280
    ds_read_b64_tr_b16 v[194:195], v219 offset:1792
    ds_read_b128 v[96:99], v218 offset:0
    ds_read_b128 v[100:103], v218 offset:16
    ds_read_b128 v[104:107], v218 offset:32
    ds_read_b128 v[108:111], v218 offset:48
    ds_read_b64_tr_b16 v[196:197], v219 offset:5376
    ds_read_b64_tr_b16 v[198:199], v219 offset:5888
    ds_read_b128 v[112:115], v218 offset:128
    ds_read_b128 v[116:119], v218 offset:144
    ds_read_b128 v[120:123], v218 offset:160
    ds_read_b128 v[124:127], v218 offset:176
    ds_read_b64_tr_b16 v[200:201], v219 offset:9472
    ds_read_b64_tr_b16 v[202:203], v219 offset:9984
    ds_read_b128 v[128:131], v218 offset:256
    ds_read_b128 v[132:135], v218 offset:272
    ds_read_b128 v[136:139], v218 offset:288
    ds_read_b128 v[140:143], v218 offset:304
    ds_read_b64_tr_b16 v[204:205], v219 offset:13568
    ds_read_b64_tr_b16 v[206:207], v219 offset:14080
    ds_read_b128 v[160:163], v218 offset:384
    ds_read_b128 v[164:167], v218 offset:400
    ds_read_b128 v[168:171], v218 offset:416
    ds_read_b128 v[172:175], v218 offset:432
    ds_read_b64_tr_b16 v[208:209], v219 offset:17664
    ds_read_b64_tr_b16 v[210:211], v219 offset:18176
    ds_read_b128 v[176:179], v218 offset:512
    ds_read_b128 v[180:183], v218 offset:528
    ds_read_b128 v[184:187], v218 offset:544
    ds_read_b128 v[188:191], v218 offset:560
    s_waitcnt lgkmcnt(0)
    s_barrier
    ds_read_b64_tr_b16 a[160:161], v85 offset:39936
    ds_read_b64_tr_b16 a[162:163], v85 offset:41216
    ds_read_b64_tr_b16 a[164:165], v85 offset:39968
    ds_read_b64_tr_b16 a[166:167], v85 offset:41248
    ds_read_b64_tr_b16 a[168:169], v85 offset:40000
    ds_read_b64_tr_b16 a[170:171], v85 offset:41280
    ds_read_b64_tr_b16 a[172:173], v85 offset:40032
    ds_read_b64_tr_b16 a[174:175], v85 offset:41312
    ds_read_b64_tr_b16 a[176:177], v85 offset:40064
    ds_read_b64_tr_b16 a[178:179], v85 offset:41344
    s_mov_b32 s3, 0x3f803f80
    s_cmp_gt_u32 s57, 4
    s_cselect_b32 s62, 4, 5
    v_mov_b32 v216, 0
    v_mov_b32 v217, 0
    v_lshlrev_b32_e64 v214, 16, v192
    v_and_b32 v215, 0xffff0000, v192
    v_fmac_f32_e64 v217, v104, v214
    s_mul_i32 s62, s62, 163840
    v_fmac_f32_e64 v217, v105, v215
    v_pk_mul_f32 v[214:215], v[96:97], v[214:215]
    v_cvt_pk_bf16_f32 v192, v214, v215
    v_dot2_f32_bf16 v216, v192, s3, v216
    v_lshlrev_b32_e64 v214, 16, v193
    v_and_b32 v215, 0xffff0000, v193
    s_add_u32 s62, s62, s49
    v_fmac_f32 v217, v106, v214
    v_fmac_f32_e64 v217, v107, v215
    v_pk_mul_f32 v[214:215], v[98:99], v[214:215]
    v_cvt_pk_bf16_f32 v193, v214, v215
    v_dot2_f32_bf16 v216, v193, s3, v216
    s_add_u32 m0, s51, 0
    v_lshlrev_b32 v214, 16, v194
    v_and_b32 v215, 0xffff0000, v194
    v_fmac_f32 v217, v108, v214
    v_fmac_f32 v217, v109, v215
    v_pk_mul_f32 v[214:215], v[100:101], v[214:215]
    v_cvt_pk_bf16_f32 v194, v214, v215
    buffer_load_dwordx4 v148, s[16:19], s62 offen offset:0 lds
    v_dot2_f32_bf16 v216, v194, s3, v216
    v_lshlrev_b32_e64 v214, 16, v195
    v_and_b32 v215, 0xffff0000, v195
    v_fmac_f32 v217, v110, v214
    v_fmac_f32 v217, v111, v215
    buffer_load_dwordx4 v149, s[16:19], s62 offen offset:1024 lds
    v_pk_mul_f32 v[214:215], v[102:103], v[214:215]
    v_cvt_pk_bf16_f32 v195, v214, v215
    v_dot2_f32_bf16 v216, v195, s3, v216
    v_lshlrev_b32_e64 v214, 16, v196
    v_and_b32 v215, 0xffff0000, v196
    v_fmac_f32_e64 v217, v120, v214
    buffer_load_dwordx4 v150, s[16:19], s62 offen offset:2048 lds
    v_fmac_f32_e64 v217, v121, v215
    v_pk_mul_f32 v[214:215], v[112:113], v[214:215]
    v_cvt_pk_bf16_f32 v196, v214, v215
    v_dot2_f32_bf16 v216, v196, s3, v216
    v_lshlrev_b32_e64 v214, 16, v197
    buffer_load_dwordx4 v151, s[16:19], s62 offen offset:3072 lds
    v_and_b32 v215, 0xffff0000, v197
    v_fmac_f32 v217, v122, v214
    v_fmac_f32 v217, v123, v215
    v_pk_mul_f32 v[214:215], v[114:115], v[214:215]
    v_cvt_pk_bf16_f32 v197, v214, v215
    v_dot2_f32_bf16 v216, v197, s3, v216
    s_add_u32 m0, m0, 4096
    v_lshlrev_b32_e64 v214, 16, v198
    v_and_b32 v215, 0xffff0000, v198
    v_fmac_f32 v217, v124, v214
    v_fmac_f32 v217, v125, v215
    v_pk_mul_f32 v[214:215], v[116:117], v[214:215]
    v_cvt_pk_bf16_f32 v198, v214, v215
    buffer_load_dwordx4 v152, s[16:19], s62 offen lds
    v_dot2_f32_bf16 v216, v198, s3, v216
    v_lshlrev_b32_e64 v214, 16, v199
    v_and_b32 v215, 0xffff0000, v199
    v_fmac_f32 v217, v126, v214
    v_fmac_f32 v217, v127, v215
    s_cmp_gt_u32 s57, 5
    s_cselect_b32 s62, 5, 6
    v_pk_mul_f32 v[214:215], v[118:119], v[214:215]
    v_cvt_pk_bf16_f32 v199, v214, v215
    v_dot2_f32_bf16 v216, v199, s3, v216
    v_lshlrev_b32_e64 v214, 16, v200
    v_and_b32 v215, 0xffff0000, v200
    v_fmac_f32_e64 v217, v136, v214
    s_mul_i32 s62, s62, 163840
    v_fmac_f32_e64 v217, v137, v215
    v_pk_mul_f32 v[214:215], v[128:129], v[214:215]
    v_cvt_pk_bf16_f32 v200, v214, v215
    v_dot2_f32_bf16 v216, v200, s3, v216
    v_lshlrev_b32 v214, 16, v201
    s_add_u32 s62, s62, s49
    v_and_b32 v215, 0xffff0000, v201
    v_fmac_f32 v217, v138, v214
    v_fmac_f32 v217, v139, v215
    v_pk_mul_f32 v[214:215], v[130:131], v[214:215]
    v_cvt_pk_bf16_f32 v201, v214, v215
    v_dot2_f32_bf16 v216, v201, s3, v216
    s_add_u32 m0, s51, 61440
    v_lshlrev_b32_e64 v214, 16, v202
    v_and_b32 v215, 0xffff0000, v202
    v_fmac_f32 v217, v140, v214
    v_fmac_f32 v217, v141, v215
    v_pk_mul_f32 v[214:215], v[132:133], v[214:215]
    buffer_load_dwordx4 v148, s[16:19], s62 offen offset:0 lds
    v_cvt_pk_bf16_f32 v202, v214, v215
    v_dot2_f32_bf16 v216, v202, s3, v216
    v_lshlrev_b32_e64 v214, 16, v203
    v_and_b32 v215, 0xffff0000, v203
    v_fmac_f32 v217, v142, v214
    v_fmac_f32 v217, v143, v215
    buffer_load_dwordx4 v149, s[16:19], s62 offen offset:1024 lds
    v_pk_mul_f32 v[214:215], v[134:135], v[214:215]
    v_cvt_pk_bf16_f32 v203, v214, v215
    v_dot2_f32_bf16 v216, v203, s3, v216
    v_lshlrev_b32_e64 v214, 16, v204
    v_and_b32 v215, 0xffff0000, v204
    v_fmac_f32_e64 v217, v168, v214
    buffer_load_dwordx4 v150, s[16:19], s62 offen offset:2048 lds
    v_fmac_f32_e64 v217, v169, v215
    v_pk_mul_f32 v[214:215], v[160:161], v[214:215]
    v_cvt_pk_bf16_f32 v204, v214, v215
    v_dot2_f32_bf16 v216, v204, s3, v216
    v_lshlrev_b32_e64 v214, 16, v205
    buffer_load_dwordx4 v151, s[16:19], s62 offen offset:3072 lds
    v_and_b32 v215, 0xffff0000, v205
    v_fmac_f32 v217, v170, v214
    v_fmac_f32 v217, v171, v215
    v_pk_mul_f32 v[214:215], v[162:163], v[214:215]
    v_cvt_pk_bf16_f32 v205, v214, v215
    v_dot2_f32_bf16 v216, v205, s3, v216
    s_add_u32 m0, m0, 4096
    v_lshlrev_b32_e64 v214, 16, v206
    v_and_b32 v215, 0xffff0000, v206
    v_fmac_f32 v217, v172, v214
    v_fmac_f32 v217, v173, v215
    v_pk_mul_f32 v[214:215], v[164:165], v[214:215]
    buffer_load_dwordx4 v152, s[16:19], s62 offen lds
    v_cvt_pk_bf16_f32 v206, v214, v215
    v_dot2_f32_bf16 v216, v206, s3, v216
    v_lshlrev_b32_e64 v214, 16, v207
    v_and_b32 v215, 0xffff0000, v207
    v_fmac_f32 v217, v174, v214
    v_fmac_f32 v217, v175, v215
    s_cmp_gt_u32 s57, 6
    s_cselect_b32 s62, 6, 7
    v_pk_mul_f32 v[214:215], v[166:167], v[214:215]
    v_cvt_pk_bf16_f32 v207, v214, v215
    v_dot2_f32_bf16 v216, v207, s3, v216
    v_lshlrev_b32_e64 v214, 16, v208
    v_and_b32 v215, 0xffff0000, v208
    s_mul_i32 s62, s62, 163840
    v_fmac_f32 v217, v184, v214
    v_fmac_f32 v217, v185, v215
    v_pk_mul_f32 v[214:215], v[176:177], v[214:215]
    v_cvt_pk_bf16_f32 v208, v214, v215
    v_dot2_f32_bf16 v216, v208, s3, v216
    v_lshlrev_b32 v214, 16, v209
    s_add_u32 s62, s62, s49
    v_and_b32 v215, 0xffff0000, v209
    v_fmac_f32 v217, v186, v214
    v_fmac_f32 v217, v187, v215
    v_pk_mul_f32 v[214:215], v[178:179], v[214:215]
    v_cvt_pk_bf16_f32 v209, v214, v215
    v_dot2_f32_bf16 v216, v209, s3, v216
    s_add_u32 m0, s51, 81920
    s_cmp_eq_u32 s60, 3
    s_cselect_b32 m0, 20480, m0
    v_lshlrev_b32 v214, 16, v210
    v_and_b32 v215, 0xffff0000, v210
    v_fmac_f32 v217, v188, v214
    v_fmac_f32 v217, v189, v215
    v_pk_mul_f32 v[214:215], v[180:181], v[214:215]
    buffer_load_dwordx4 v148, s[16:19], s62 offen offset:0 lds
    v_cvt_pk_bf16_f32 v210, v214, v215
    v_dot2_f32_bf16 v216, v210, s3, v216
    v_lshlrev_b32_e64 v214, 16, v211
    v_and_b32 v215, 0xffff0000, v211
    v_fmac_f32 v217, v190, v214
    v_fmac_f32 v217, v191, v215
    buffer_load_dwordx4 v149, s[16:19], s62 offen offset:1024 lds
    v_pk_mul_f32 v[214:215], v[182:183], v[214:215]
    v_cvt_pk_bf16_f32 v211, v214, v215
    v_dot2_f32_bf16 v216, v211, s3, v216
    v_mov_b32 v215, v217
    s_nop 1
    v_mov_b32_e64 v214, v216
    buffer_load_dwordx4 v150, s[16:19], s62 offen offset:2048 lds
    v_permlane32_swap_b32 v217, v215
    v_permlane32_swap_b32 v216, v214
    v_add_f32 v216, v216, v214
    v_add_f32 v217, v217, v215
    v_cvt_pk_bf16_f32 v212, v216, v217
    v_lshrrev_b32 v213, 2, v253
    buffer_load_dwordx4 v151, s[16:19], s62 offen offset:3072 lds
    s_add_u32 s52, s90, 10485760
    s_addc_u32 s53, s91, 0
    s_mov_b32 s54, 4534272
    s_mov_b32 s55, 0x00020000
    s_cmp_lt_u32 s2, 216
    s_cselect_b32 s54, s54, 0
    s_add_u32 s61, s50, 1
    s_add_u32 m0, m0, 4096
    s_and_b32 s61, s61, 3
    s_mul_i32 s13, s61, 7680
    s_add_u32 s13, s13, 0
    s_add_u32 s61, s50, 2
    s_and_b32 s61, s61, 3
    s_mul_i32 s14, s61, 7680
    buffer_load_dwordx4 v152, s[16:19], s62 offen lds
    s_add_u32 s14, s14, 2560
    s_add_u32 s61, s50, 3
    s_and_b32 s61, s61, 3
    s_mul_i32 s15, s61, 7680
    s_addk_i32 s15, 5120
    s_mov_b32 s94, 0
L_poll3:
    global_load_dword v92, v91, s[90:91] sc1
    s_add_u32 s94, s94, 1
    s_waitcnt vmcnt(0)
    v_cmp_gt_u32 vcc, 8, v92
    s_cmp_gt_u32 s94, 65536
    s_cbranch_scc1 L_pdone3
    s_nop 2
    s_cbranch_vccz L_pdone3
    s_sleep 4
    s_branch L_poll3
L_pdone3:
    buffer_load_dwordx4 a[48:51], v253, s[8:11], s12 offen offset:1024 sc1
    buffer_load_dwordx4 a[52:55], v253, s[8:11], s12 offen offset:2048 sc1
    buffer_load_dwordx4 a[56:59], v253, s[8:11], s12 offen offset:3072 sc1
    s_add_u32 s12, s12, 4096
    buffer_load_dwordx4 a[60:63], v253, s[8:11], s12 offen offset:1024 sc1
    buffer_load_dwordx4 a[64:67], v253, s[8:11], s12 offen offset:2048 sc1
    buffer_load_dwordx4 a[68:71], v253, s[8:11], s12 offen offset:3072 sc1
    s_add_u32 s12, s12, 4096
    buffer_load_dwordx4 a[0:3], v253, s[8:11], s12 offen offset:1024 sc1
    buffer_load_dwordx4 a[4:7], v253, s[8:11], s12 offen offset:2048 sc1
    buffer_load_dwordx4 a[8:11], v253, s[8:11], s12 offen offset:3072 sc1
    s_addk_i32 s12, 4096
    buffer_load_dwordx4 a[12:15], v253, s[8:11], s12 offen offset:1024 sc1
    buffer_load_dwordx4 a[16:19], v253, s[8:11], s12 offen offset:2048 sc1
    buffer_load_dwordx4 a[20:23], v253, s[8:11], s12 offen offset:3072 sc1
    s_cmp_gt_u32 s57, 1
    s_cselect_b32 s12, 1, 2
    s_lshl_b32 s12, s12, 14
    s_and_b32 s35, s2, 1
    s_lshl_b32 s35, s35, 3
    s_lshr_b32 s61, s2, 5
    s_add_u32 s35, s35, s61
    s_lshl_b32 s35, s35, 2
    s_add_u32 s35, s35, s60
    s_bfe_u32 s32, s2, 0x20001
    s_lshl_b32 s32, s32, 2
    s_bfe_u32 s61, s2, 0x20003
    s_add_u32 s32, s32, s61
    s_mul_i32 s32, s32, 27
    s_lshr_b32 s32, s32, 2
    s_mul_i32 s33, s60, 110592
    s_mul_i32 s34, s60, 7168
    s_mov_b32 s36, 0
    s_lshl_b32 s61, s32, 10
    s_add_u32 s61, s61, 10485760
    s_mul_i32 s62, s35, 40960
    s_add_u32 s62, s62, 4194304
    s_add_u32 s20, s90, s61
    s_addc_u32 s21, s91, 0
    s_mov_b32 s22, 4430848
    s_mov_b32 s23, 0x00020000
    s_add_u32 s24, s90, s62
    s_addc_u32 s25, s91, 0
    s_mov_b32 s26, 40960
    s_mov_b32 s27, 0x00020000
    s_lshr_b32 s61, s35, 1
    s_mul_i32 s61, s61, 221184
    s_and_b32 s62, s35, 1
    s_lshl_b32 s62, s62, 11
    s_add_u32 s61, s61, s62
    s_add_u32 s61, s61, 16777216
    s_add_u32 s28, s90, s61
    s_addc_u32 s29, s91, 0
    s_mov_b32 s30, 219136
    s_mov_b32 s31, 0x00020000
    s_mul_i32 s63, s60, 14
    s_lshl_b32 s62, s63, 3
    s_add_u32 s62, s62, s57
    s_mul_i32 s62, s62, 5120
    s_add_u32 s62, s62, 31457280
    s_sub_u32 s63, 54, s63
    s_min_u32 s63, s63, 14
    s_mul_i32 s63, s63, 40960
    s_sub_u32 s63, s63, 35840
    s_add_u32 s40, s90, s62
    s_addc_u32 s41, s91, 0
    s_mov_b32 s42, s63
    s_mov_b32 s43, 0x00020000
    s_mov_b32 s44, 0
    s_waitcnt vmcnt(9) lgkmcnt(0)
    v_mfma_f32_16x16x32_bf16 v[20:23], a[160:163], a[48:51], v[20:23]
    buffer_load_dwordx4 a[24:27], v253, s[8:11], s12 offen offset:1024 sc1
    v_mfma_f32_16x16x32_bf16 v[40:43], a[160:163], a[52:55], v[40:43]
    ds_read_b64_tr_b16 a[180:181], v85 offset:45056
    ds_read_b64_tr_b16 a[182:183], v85 offset:46336
    v_mfma_f32_16x16x32_bf16 v[60:63], a[160:163], a[56:59], v[60:63]
    ds_read_b64_tr_b16 a[184:185], v85 offset:45088
    v_mfma_f32_16x16x32_bf16 v[24:27], a[164:167], a[48:51], v[24:27]
    ds_read_b64_tr_b16 a[186:187], v85 offset:46368
    v_mfma_f32_16x16x32_bf16 v[44:47], a[164:167], a[52:55], v[44:47]
    buffer_load_dwordx4 a[28:31], v253, s[8:11], s12 offen offset:2048 sc1
    v_mfma_f32_16x16x32_bf16 v[64:67], a[164:167], a[56:59], v[64:67]
    ds_read_b64_tr_b16 a[188:189], v85 offset:45120
    ds_read_b64_tr_b16 a[190:191], v85 offset:46400
    v_mfma_f32_16x16x32_bf16 v[28:31], a[168:171], a[48:51], v[28:31]
    ds_read_b64_tr_b16 a[192:193], v85 offset:45152
    v_mfma_f32_16x16x32_bf16 v[48:51], a[168:171], a[52:55], v[48:51]
    ds_read_b64_tr_b16 a[194:195], v85 offset:46432
    v_mfma_f32_16x16x32_bf16 v[68:71], a[168:171], a[56:59], v[68:71]
    buffer_load_dwordx4 a[32:35], v253, s[8:11], s12 offen offset:3072 sc1
    s_add_u32 s12, s12, 4096
    v_mfma_f32_16x16x32_bf16 v[32:35], a[172:175], a[48:51], v[32:35]
    ds_read_b64_tr_b16 a[196:197], v85 offset:45184
    ds_read_b64_tr_b16 a[198:199], v85 offset:46464
    v_mfma_f32_16x16x32_bf16 v[52:55], a[172:175], a[52:55], v[52:55]
    buffer_load_dwordx4 a[36:39], v253, s[8:11], s12 offen offset:1024 sc1
    v_mfma_f32_16x16x32_bf16 v[72:75], a[172:175], a[56:59], v[72:75]
    buffer_load_dwordx4 a[40:43], v253, s[8:11], s12 offen offset:2048 sc1
    v_mfma_f32_16x16x32_bf16 v[36:39], a[176:179], a[48:51], v[36:39]
    buffer_load_dwordx4 a[44:47], v253, s[8:11], s12 offen offset:3072 sc1
    s_addk_i32 s12, 4096
    v_mfma_f32_16x16x32_bf16 v[56:59], a[176:179], a[52:55], v[56:59]
    buffer_store_dwordx4 v[192:195], v253, s[52:55], s5 offen sc1
    s_add_u32 s5, s5, 110592
    v_mfma_f32_16x16x32_bf16 v[76:79], a[176:179], a[56:59], v[76:79]
    s_waitcnt vmcnt(13) lgkmcnt(0)
    v_mfma_f32_16x16x32_bf16 v[20:23], a[180:183], a[60:63], v[20:23]
    v_mfma_f32_16x16x32_bf16 v[40:43], a[180:183], a[64:67], v[40:43]
    ds_read_b64_tr_b16 a[160:161], v85 offset:50176
    ds_read_b64_tr_b16 a[162:163], v85 offset:51456
    v_mfma_f32_16x16x32_bf16 v[60:63], a[180:183], a[68:71], v[60:63]
    ds_read_b64_tr_b16 a[164:165], v85 offset:50208
    v_mfma_f32_16x16x32_bf16 v[24:27], a[184:187], a[60:63], v[24:27]
    ds_read_b64_tr_b16 a[166:167], v85 offset:51488
    v_mfma_f32_16x16x32_bf16 v[44:47], a[184:187], a[64:67], v[44:47]
    buffer_load_dwordx4 a[48:51], v253, s[8:11], s12 offen offset:1024 sc1
    v_mfma_f32_16x16x32_bf16 v[64:67], a[184:187], a[68:71], v[64:67]
    ds_read_b64_tr_b16 a[168:169], v85 offset:50240
    ds_read_b64_tr_b16 a[170:171], v85 offset:51520
    v_mfma_f32_16x16x32_bf16 v[28:31], a[188:191], a[60:63], v[28:31]
    ds_read_b64_tr_b16 a[172:173], v85 offset:50272
    v_mfma_f32_16x16x32_bf16 v[48:51], a[188:191], a[64:67], v[48:51]
    ds_read_b64_tr_b16 a[174:175], v85 offset:51552
    v_mfma_f32_16x16x32_bf16 v[68:71], a[188:191], a[68:71], v[68:71]
    buffer_load_dwordx4 a[52:55], v253, s[8:11], s12 offen offset:2048 sc1
    v_mfma_f32_16x16x32_bf16 v[32:35], a[192:195], a[60:63], v[32:35]
    ds_read_b64_tr_b16 a[176:177], v85 offset:50304
    ds_read_b64_tr_b16 a[178:179], v85 offset:51584
    v_mfma_f32_16x16x32_bf16 v[52:55], a[192:195], a[64:67], v[52:55]
    v_mfma_f32_16x16x32_bf16 v[72:75], a[192:195], a[68:71], v[72:75]
    buffer_load_dwordx4 a[56:59], v253, s[8:11], s12 offen offset:3072 sc1
    s_addk_i32 s12, 4096
    v_mfma_f32_16x16x32_bf16 v[36:39], a[196:199], a[60:63], v[36:39]
    v_mfma_f32_16x16x32_bf16 v[56:59], a[196:199], a[64:67], v[56:59]
    buffer_store_dwordx4 v[196:199], v253, s[52:55], s5 offen sc1
    s_add_u32 s5, s5, 110592
    v_mfma_f32_16x16x32_bf16 v[76:79], a[196:199], a[68:71], v[76:79]
    s_waitcnt vmcnt(14) lgkmcnt(0)
    v_mfma_f32_16x16x32_bf16 v[20:23], a[160:163], a[0:3], v[20:23]
    v_mfma_f32_16x16x32_bf16 v[40:43], a[160:163], a[4:7], v[40:43]
    ds_read_b64_tr_b16 a[180:181], v85 offset:55296
    ds_read_b64_tr_b16 a[182:183], v85 offset:56576
    v_mfma_f32_16x16x32_bf16 v[60:63], a[160:163], a[8:11], v[60:63]
    ds_read_b64_tr_b16 a[184:185], v85 offset:55328
    v_mfma_f32_16x16x32_bf16 v[24:27], a[164:167], a[0:3], v[24:27]
    ds_read_b64_tr_b16 a[186:187], v85 offset:56608
    v_mfma_f32_16x16x32_bf16 v[44:47], a[164:167], a[4:7], v[44:47]
    buffer_load_dwordx4 a[60:63], v253, s[8:11], s12 offen offset:1024 sc1
    v_mfma_f32_16x16x32_bf16 v[64:67], a[164:167], a[8:11], v[64:67]
    ds_read_b64_tr_b16 a[188:189], v85 offset:55360
    ds_read_b64_tr_b16 a[190:191], v85 offset:56640
    v_mfma_f32_16x16x32_bf16 v[28:31], a[168:171], a[0:3], v[28:31]
    ds_read_b64_tr_b16 a[192:193], v85 offset:55392
    v_mfma_f32_16x16x32_bf16 v[48:51], a[168:171], a[4:7], v[48:51]
    ds_read_b64_tr_b16 a[194:195], v85 offset:56672
    v_mfma_f32_16x16x32_bf16 v[68:71], a[168:171], a[8:11], v[68:71]
    buffer_load_dwordx4 a[64:67], v253, s[8:11], s12 offen offset:2048 sc1
    v_mfma_f32_16x16x32_bf16 v[32:35], a[172:175], a[0:3], v[32:35]
    ds_read_b64_tr_b16 a[196:197], v85 offset:55424
    ds_read_b64_tr_b16 a[198:199], v85 offset:56704
    v_mfma_f32_16x16x32_bf16 v[52:55], a[172:175], a[4:7], v[52:55]
    v_mfma_f32_16x16x32_bf16 v[72:75], a[172:175], a[8:11], v[72:75]
    buffer_load_dwordx4 a[68:71], v253, s[8:11], s12 offen offset:3072 sc1
    s_cmp_gt_u32 s57, 2
    s_cselect_b32 s12, 2, 3
    s_lshl_b32 s12, s12, 14
    v_mfma_f32_16x16x32_bf16 v[36:39], a[176:179], a[0:3], v[36:39]
    v_mfma_f32_16x16x32_bf16 v[56:59], a[176:179], a[4:7], v[56:59]
    buffer_store_dwordx4 v[200:203], v253, s[52:55], s5 offen sc1
    s_add_u32 s5, s5, 110592
    v_mfma_f32_16x16x32_bf16 v[76:79], a[176:179], a[8:11], v[76:79]
    s_waitcnt vmcnt(15) lgkmcnt(0)
    v_mfma_f32_16x16x32_bf16 v[20:23], a[180:183], a[12:15], v[20:23]
    v_mfma_f32_16x16x32_bf16 v[40:43], a[180:183], a[16:19], v[40:43]
    ds_read_b64_tr_b16 a[160:161], v84 offset:46080
    ds_read_b64_tr_b16 a[162:163], v84 offset:47360
    v_mfma_f32_16x16x32_bf16 v[60:63], a[180:183], a[20:23], v[60:63]
    ds_read_b64_tr_b16 a[164:165], v84 offset:46112
    v_mfma_f32_16x16x32_bf16 v[24:27], a[184:187], a[12:15], v[24:27]
    ds_read_b64_tr_b16 a[166:167], v84 offset:47392
    v_mfma_f32_16x16x32_bf16 v[44:47], a[184:187], a[16:19], v[44:47]
    buffer_load_dwordx4 a[0:3], v253, s[8:11], s12 offen offset:1024 sc1
    v_mfma_f32_16x16x32_bf16 v[64:67], a[184:187], a[20:23], v[64:67]
    ds_read_b64_tr_b16 a[168:169], v84 offset:46144
    ds_read_b64_tr_b16 a[170:171], v84 offset:47424
    v_mfma_f32_16x16x32_bf16 v[28:31], a[188:191], a[12:15], v[28:31]
    ds_read_b64_tr_b16 a[172:173], v84 offset:46176
    v_mfma_f32_16x16x32_bf16 v[48:51], a[188:191], a[16:19], v[48:51]
    ds_read_b64_tr_b16 a[174:175], v84 offset:47456
    v_mfma_f32_16x16x32_bf16 v[68:71], a[188:191], a[20:23], v[68:71]
    buffer_load_dwordx4 a[4:7], v253, s[8:11], s12 offen offset:2048 sc1
    v_mfma_f32_16x16x32_bf16 v[32:35], a[192:195], a[12:15], v[32:35]
    ds_read_b64_tr_b16 a[176:177], v84 offset:46208
    ds_read_b64_tr_b16 a[178:179], v84 offset:47488
    v_mfma_f32_16x16x32_bf16 v[52:55], a[192:195], a[16:19], v[52:55]
    v_mfma_f32_16x16x32_bf16 v[72:75], a[192:195], a[20:23], v[72:75]
    buffer_load_dwordx4 a[8:11], v253, s[8:11], s12 offen offset:3072 sc1
    s_addk_i32 s12, 4096
    v_mfma_f32_16x16x32_bf16 v[36:39], a[196:199], a[12:15], v[36:39]
    v_mfma_f32_16x16x32_bf16 v[56:59], a[196:199], a[16:19], v[56:59]
    buffer_store_dwordx4 v[204:207], v253, s[52:55], s5 offen sc1
    s_add_u32 s5, s5, 110592
    v_mfma_f32_16x16x32_bf16 v[76:79], a[196:199], a[20:23], v[76:79]
    s_waitcnt vmcnt(16) lgkmcnt(0)
    v_mfma_f32_16x16x32_bf16 v[20:23], a[160:163], a[24:27], v[20:23]
    v_mfma_f32_16x16x32_bf16 v[40:43], a[160:163], a[28:31], v[40:43]
    ds_read_b64_tr_b16 a[180:181], v84 offset:51200
    ds_read_b64_tr_b16 a[182:183], v84 offset:52480
    v_mfma_f32_16x16x32_bf16 v[60:63], a[160:163], a[32:35], v[60:63]
    ds_read_b64_tr_b16 a[184:185], v84 offset:51232
    v_mfma_f32_16x16x32_bf16 v[24:27], a[164:167], a[24:27], v[24:27]
    ds_read_b64_tr_b16 a[186:187], v84 offset:52512
    v_mfma_f32_16x16x32_bf16 v[44:47], a[164:167], a[28:31], v[44:47]
    buffer_load_dwordx4 a[12:15], v253, s[8:11], s12 offen offset:1024 sc1
    v_mfma_f32_16x16x32_bf16 v[64:67], a[164:167], a[32:35], v[64:67]
    ds_read_b64_tr_b16 a[188:189], v84 offset:51264
    ds_read_b64_tr_b16 a[190:191], v84 offset:52544
    v_mfma_f32_16x16x32_bf16 v[28:31], a[168:171], a[24:27], v[28:31]
    ds_read_b64_tr_b16 a[192:193], v84 offset:51296
    v_mfma_f32_16x16x32_bf16 v[48:51], a[168:171], a[28:31], v[48:51]
    ds_read_b64_tr_b16 a[194:195], v84 offset:52576
    v_mfma_f32_16x16x32_bf16 v[68:71], a[168:171], a[32:35], v[68:71]
    buffer_load_dwordx4 a[16:19], v253, s[8:11], s12 offen offset:2048 sc1
    v_mfma_f32_16x16x32_bf16 v[32:35], a[172:175], a[24:27], v[32:35]
    ds_read_b64_tr_b16 a[196:197], v84 offset:51328
    ds_read_b64_tr_b16 a[198:199], v84 offset:52608
    v_mfma_f32_16x16x32_bf16 v[52:55], a[172:175], a[28:31], v[52:55]
    v_mfma_f32_16x16x32_bf16 v[72:75], a[172:175], a[32:35], v[72:75]
    buffer_load_dwordx4 a[20:23], v253, s[8:11], s12 offen offset:3072 sc1
    s_addk_i32 s12, 4096
    v_mfma_f32_16x16x32_bf16 v[36:39], a[176:179], a[24:27], v[36:39]
    v_mfma_f32_16x16x32_bf16 v[56:59], a[176:179], a[28:31], v[56:59]
    buffer_store_dwordx4 v[208:211], v253, s[52:55], s5 offen sc1
    v_mfma_f32_16x16x32_bf16 v[76:79], a[176:179], a[32:35], v[76:79]
    s_waitcnt vmcnt(17) lgkmcnt(0)
    v_mfma_f32_16x16x32_bf16 v[20:23], a[180:183], a[36:39], v[20:23]
    v_mfma_f32_16x16x32_bf16 v[40:43], a[180:183], a[40:43], v[40:43]
    ds_read_b64_tr_b16 a[160:161], v84 offset:56320
    ds_read_b64_tr_b16 a[162:163], v84 offset:57600
    v_mfma_f32_16x16x32_bf16 v[60:63], a[180:183], a[44:47], v[60:63]
    ds_read_b64_tr_b16 a[164:165], v84 offset:56352
    v_mfma_f32_16x16x32_bf16 v[24:27], a[184:187], a[36:39], v[24:27]
    ds_read_b64_tr_b16 a[166:167], v84 offset:57632
    v_mfma_f32_16x16x32_bf16 v[44:47], a[184:187], a[40:43], v[44:47]
    buffer_load_dwordx4 a[24:27], v253, s[8:11], s12 offen offset:1024 sc1
    v_mfma_f32_16x16x32_bf16 v[64:67], a[184:187], a[44:47], v[64:67]
    ds_read_b64_tr_b16 a[168:169], v84 offset:56384
    ds_read_b64_tr_b16 a[170:171], v84 offset:57664
    v_mfma_f32_16x16x32_bf16 v[28:31], a[188:191], a[36:39], v[28:31]
    ds_read_b64_tr_b16 a[172:173], v84 offset:56416
    v_mfma_f32_16x16x32_bf16 v[48:51], a[188:191], a[40:43], v[48:51]
    ds_read_b64_tr_b16 a[174:175], v84 offset:57696
    v_mfma_f32_16x16x32_bf16 v[68:71], a[188:191], a[44:47], v[68:71]
    buffer_load_dwordx4 a[28:31], v253, s[8:11], s12 offen offset:2048 sc1
    v_mfma_f32_16x16x32_bf16 v[32:35], a[192:195], a[36:39], v[32:35]
    ds_read_b64_tr_b16 a[176:177], v84 offset:56448
    ds_read_b64_tr_b16 a[178:179], v84 offset:57728
    v_mfma_f32_16x16x32_bf16 v[52:55], a[192:195], a[40:43], v[52:55]
    v_mfma_f32_16x16x32_bf16 v[72:75], a[192:195], a[44:47], v[72:75]
    buffer_load_dwordx4 a[32:35], v253, s[8:11], s12 offen offset:3072 sc1
    s_addk_i32 s12, 4096
    v_mfma_f32_16x16x32_bf16 v[36:39], a[196:199], a[36:39], v[36:39]
    v_mfma_f32_16x16x32_bf16 v[56:59], a[196:199], a[40:43], v[56:59]
    s_mov_b32 exec_hi, 0
    buffer_store_dword v212, v213, s[52:55], s7 offen sc1
    s_mov_b32 exec_hi, -1
    v_mfma_f32_16x16x32_bf16 v[76:79], a[196:199], a[44:47], v[76:79]
    s_waitcnt vmcnt(17) lgkmcnt(0)
    v_mfma_f32_16x16x32_bf16 v[20:23], a[160:163], a[48:51], v[20:23]
    v_mfma_f32_16x16x32_bf16 v[40:43], a[160:163], a[52:55], v[40:43]
    ds_read_b64_tr_b16 a[180:181], v86 offset:3072
    ds_read_b64_tr_b16 a[182:183], v86 offset:4352
    v_mfma_f32_16x16x32_bf16 v[60:63], a[160:163], a[56:59], v[60:63]
    ds_read_b64_tr_b16 a[184:185], v86 offset:3104
    v_mfma_f32_16x16x32_bf16 v[24:27], a[164:167], a[48:51], v[24:27]
    ds_read_b64_tr_b16 a[186:187], v86 offset:4384
    v_mfma_f32_16x16x32_bf16 v[44:47], a[164:167], a[52:55], v[44:47]
    buffer_load_dwordx4 a[36:39], v253, s[8:11], s12 offen offset:1024 sc1
    v_mfma_f32_16x16x32_bf16 v[64:67], a[164:167], a[56:59], v[64:67]
    ds_read_b64_tr_b16 a[188:189], v86 offset:3136
    ds_read_b64_tr_b16 a[190:191], v86 offset:4416
    v_mfma_f32_16x16x32_bf16 v[28:31], a[168:171], a[48:51], v[28:31]
    ds_read_b64_tr_b16 a[192:193], v86 offset:3168
    v_mfma_f32_16x16x32_bf16 v[48:51], a[168:171], a[52:55], v[48:51]
    ds_read_b64_tr_b16 a[194:195], v86 offset:4448
    v_mfma_f32_16x16x32_bf16 v[68:71], a[168:171], a[56:59], v[68:71]
    buffer_load_dwordx4 a[40:43], v253, s[8:11], s12 offen offset:2048 sc1
    v_mfma_f32_16x16x32_bf16 v[32:35], a[172:175], a[48:51], v[32:35]
    ds_read_b64_tr_b16 a[196:197], v86 offset:3200
    ds_read_b64_tr_b16 a[198:199], v86 offset:4480
    v_mfma_f32_16x16x32_bf16 v[52:55], a[172:175], a[52:55], v[52:55]
    v_mfma_f32_16x16x32_bf16 v[72:75], a[172:175], a[56:59], v[72:75]
    buffer_load_dwordx4 a[44:47], v253, s[8:11], s12 offen offset:3072 sc1
    s_cmp_gt_u32 s57, 3
    s_cselect_b32 s12, 3, 4
    s_lshl_b32 s12, s12, 14
    v_mfma_f32_16x16x32_bf16 v[36:39], a[176:179], a[48:51], v[36:39]
    v_mfma_f32_16x16x32_bf16 v[56:59], a[176:179], a[52:55], v[56:59]
    v_mfma_f32_16x16x32_bf16 v[76:79], a[176:179], a[56:59], v[76:79]
    s_waitcnt vmcnt(16) lgkmcnt(0)
    v_mfma_f32_16x16x32_bf16 v[20:23], a[180:183], a[60:63], v[20:23]
    v_mfma_f32_16x16x32_bf16 v[40:43], a[180:183], a[64:67], v[40:43]
    ds_read_b64_tr_b16 a[160:161], v86 offset:8192
    ds_read_b64_tr_b16 a[162:163], v86 offset:9472
    v_mfma_f32_16x16x32_bf16 v[60:63], a[180:183], a[68:71], v[60:63]
    ds_read_b64_tr_b16 a[164:165], v86 offset:8224
    v_mfma_f32_16x16x32_bf16 v[24:27], a[184:187], a[60:63], v[24:27]
    ds_read_b64_tr_b16 a[166:167], v86 offset:9504
    v_mfma_f32_16x16x32_bf16 v[44:47], a[184:187], a[64:67], v[44:47]
    buffer_load_dwordx4 a[48:51], v253, s[8:11], s12 offen offset:1024 sc1
    v_mfma_f32_16x16x32_bf16 v[64:67], a[184:187], a[68:71], v[64:67]
    ds_read_b64_tr_b16 a[168:169], v86 offset:8256
    ds_read_b64_tr_b16 a[170:171], v86 offset:9536
    v_mfma_f32_16x16x32_bf16 v[28:31], a[188:191], a[60:63], v[28:31]
    ds_read_b64_tr_b16 a[172:173], v86 offset:8288
    v_mfma_f32_16x16x32_bf16 v[48:51], a[188:191], a[64:67], v[48:51]
    ds_read_b64_tr_b16 a[174:175], v86 offset:9568
    v_mfma_f32_16x16x32_bf16 v[68:71], a[188:191], a[68:71], v[68:71]
    buffer_load_dwordx4 a[52:55], v253, s[8:11], s12 offen offset:2048 sc1
    v_mfma_f32_16x16x32_bf16 v[32:35], a[192:195], a[60:63], v[32:35]
    ds_read_b64_tr_b16 a[176:177], v86 offset:8320
    ds_read_b64_tr_b16 a[178:179], v86 offset:9600
    v_mfma_f32_16x16x32_bf16 v[52:55], a[192:195], a[64:67], v[52:55]
    v_mfma_f32_16x16x32_bf16 v[72:75], a[192:195], a[68:71], v[72:75]
    buffer_load_dwordx4 a[56:59], v253, s[8:11], s12 offen offset:3072 sc1
    s_addk_i32 s12, 4096
    v_mfma_f32_16x16x32_bf16 v[36:39], a[196:199], a[60:63], v[36:39]
    v_mfma_f32_16x16x32_bf16 v[56:59], a[196:199], a[64:67], v[56:59]
    v_mfma_f32_16x16x32_bf16 v[76:79], a[196:199], a[68:71], v[76:79]
    s_waitcnt vmcnt(15) lgkmcnt(0)
    v_mfma_f32_16x16x32_bf16 v[20:23], a[160:163], a[0:3], v[20:23]
    v_mfma_f32_16x16x32_bf16 v[40:43], a[160:163], a[4:7], v[40:43]
    ds_read_b64_tr_b16 a[180:181], v86 offset:13312
    ds_read_b64_tr_b16 a[182:183], v86 offset:14592
    v_mfma_f32_16x16x32_bf16 v[60:63], a[160:163], a[8:11], v[60:63]
    ds_read_b64_tr_b16 a[184:185], v86 offset:13344
    v_mfma_f32_16x16x32_bf16 v[24:27], a[164:167], a[0:3], v[24:27]
    ds_read_b64_tr_b16 a[186:187], v86 offset:14624
    v_mfma_f32_16x16x32_bf16 v[44:47], a[164:167], a[4:7], v[44:47]
    buffer_load_dwordx4 a[60:63], v253, s[8:11], s12 offen offset:1024 sc1
    v_mfma_f32_16x16x32_bf16 v[64:67], a[164:167], a[8:11], v[64:67]
    ds_read_b64_tr_b16 a[188:189], v86 offset:13376
    ds_read_b64_tr_b16 a[190:191], v86 offset:14656
    v_mfma_f32_16x16x32_bf16 v[28:31], a[168:171], a[0:3], v[28:31]
    ds_read_b64_tr_b16 a[192:193], v86 offset:13408
    v_mfma_f32_16x16x32_bf16 v[48:51], a[168:171], a[4:7], v[48:51]
    ds_read_b64_tr_b16 a[194:195], v86 offset:14688
    v_mfma_f32_16x16x32_bf16 v[68:71], a[168:171], a[8:11], v[68:71]
    buffer_load_dwordx4 a[64:67], v253, s[8:11], s12 offen offset:2048 sc1
    v_mfma_f32_16x16x32_bf16 v[32:35], a[172:175], a[0:3], v[32:35]
    ds_read_b64_tr_b16 a[196:197], v86 offset:13440
    ds_read_b64_tr_b16 a[198:199], v86 offset:14720
    v_mfma_f32_16x16x32_bf16 v[52:55], a[172:175], a[4:7], v[52:55]
    v_mfma_f32_16x16x32_bf16 v[72:75], a[172:175], a[8:11], v[72:75]
    buffer_load_dwordx4 a[68:71], v253, s[8:11], s12 offen offset:3072 sc1
    s_addk_i32 s12, 4096
    v_mfma_f32_16x16x32_bf16 v[36:39], a[176:179], a[0:3], v[36:39]
    v_mfma_f32_16x16x32_bf16 v[56:59], a[176:179], a[4:7], v[56:59]
    v_mfma_f32_16x16x32_bf16 v[76:79], a[176:179], a[8:11], v[76:79]
    s_waitcnt vmcnt(14) lgkmcnt(0)
    v_mfma_f32_16x16x32_bf16 v[20:23], a[180:183], a[12:15], v[20:23]
    v_mfma_f32_16x16x32_bf16 v[40:43], a[180:183], a[16:19], v[40:43]
    ds_read_b64_tr_b16 a[160:161], v86 offset:18432
    ds_read_b64_tr_b16 a[162:163], v86 offset:19712
    v_mfma_f32_16x16x32_bf16 v[60:63], a[180:183], a[20:23], v[60:63]
    ds_read_b64_tr_b16 a[164:165], v86 offset:18464
    v_mfma_f32_16x16x32_bf16 v[24:27], a[184:187], a[12:15], v[24:27]
    ds_read_b64_tr_b16 a[166:167], v86 offset:19744
    v_mfma_f32_16x16x32_bf16 v[44:47], a[184:187], a[16:19], v[44:47]
    buffer_load_dwordx4 a[0:3], v253, s[8:11], s12 offen offset:1024 sc1
    v_mfma_f32_16x16x32_bf16 v[64:67], a[184:187], a[20:23], v[64:67]
    ds_read_b64_tr_b16 a[168:169], v86 offset:18496
    ds_read_b64_tr_b16 a[170:171], v86 offset:19776
    v_mfma_f32_16x16x32_bf16 v[28:31], a[188:191], a[12:15], v[28:31]
    ds_read_b64_tr_b16 a[172:173], v86 offset:18528
    v_mfma_f32_16x16x32_bf16 v[48:51], a[188:191], a[16:19], v[48:51]
    ds_read_b64_tr_b16 a[174:175], v86 offset:19808
    v_mfma_f32_16x16x32_bf16 v[68:71], a[188:191], a[20:23], v[68:71]
    buffer_load_dwordx4 a[4:7], v253, s[8:11], s12 offen offset:2048 sc1
    v_mfma_f32_16x16x32_bf16 v[32:35], a[192:195], a[12:15], v[32:35]
    ds_read_b64_tr_b16 a[176:177], v86 offset:18560
    ds_read_b64_tr_b16 a[178:179], v86 offset:19840
    v_mfma_f32_16x16x32_bf16 v[52:55], a[192:195], a[16:19], v[52:55]
    v_mfma_f32_16x16x32_bf16 v[72:75], a[192:195], a[20:23], v[72:75]
    buffer_load_dwordx4 a[8:11], v253, s[8:11], s12 offen offset:3072 sc1
    s_addk_i32 s12, 4096
    v_mfma_f32_16x16x32_bf16 v[36:39], a[196:199], a[12:15], v[36:39]
    v_mfma_f32_16x16x32_bf16 v[56:59], a[196:199], a[16:19], v[56:59]
    v_mfma_f32_16x16x32_bf16 v[76:79], a[196:199], a[20:23], v[76:79]
    s_waitcnt vmcnt(13) lgkmcnt(0)
    v_mfma_f32_16x16x32_bf16 v[20:23], a[160:163], a[24:27], v[20:23]
    v_mfma_f32_16x16x32_bf16 v[40:43], a[160:163], a[28:31], v[40:43]
    ds_read_b64_tr_b16 a[180:181], v86 offset:23552
    ds_read_b64_tr_b16 a[182:183], v86 offset:24832
    v_mfma_f32_16x16x32_bf16 v[60:63], a[160:163], a[32:35], v[60:63]
    ds_read_b64_tr_b16 a[184:185], v86 offset:23584
    v_mfma_f32_16x16x32_bf16 v[24:27], a[164:167], a[24:27], v[24:27]
    ds_read_b64_tr_b16 a[186:187], v86 offset:24864
    v_mfma_f32_16x16x32_bf16 v[44:47], a[164:167], a[28:31], v[44:47]
    buffer_load_dwordx4 a[12:15], v253, s[8:11], s12 offen offset:1024 sc1
    v_mfma_f32_16x16x32_bf16 v[64:67], a[164:167], a[32:35], v[64:67]
    ds_read_b64_tr_b16 a[188:189], v86 offset:23616
    ds_read_b64_tr_b16 a[190:191], v86 offset:24896
    v_mfma_f32_16x16x32_bf16 v[28:31], a[168:171], a[24:27], v[28:31]
    ds_read_b64_tr_b16 a[192:193], v86 offset:23648
    v_mfma_f32_16x16x32_bf16 v[48:51], a[168:171], a[28:31], v[48:51]
    ds_read_b64_tr_b16 a[194:195], v86 offset:24928
    v_mfma_f32_16x16x32_bf16 v[68:71], a[168:171], a[32:35], v[68:71]
    buffer_load_dwordx4 a[16:19], v253, s[8:11], s12 offen offset:2048 sc1
    v_mfma_f32_16x16x32_bf16 v[32:35], a[172:175], a[24:27], v[32:35]
    ds_read_b64_tr_b16 a[196:197], v86 offset:23680
    ds_read_b64_tr_b16 a[198:199], v86 offset:24960
    v_mfma_f32_16x16x32_bf16 v[52:55], a[172:175], a[28:31], v[52:55]
    v_mfma_f32_16x16x32_bf16 v[72:75], a[172:175], a[32:35], v[72:75]
    buffer_load_dwordx4 a[20:23], v253, s[8:11], s12 offen offset:3072 sc1
    s_cmp_gt_u32 s57, 4
    s_cselect_b32 s12, 4, 5
    s_lshl_b32 s12, s12, 14
    v_mfma_f32_16x16x32_bf16 v[36:39], a[176:179], a[24:27], v[36:39]
    v_mfma_f32_16x16x32_bf16 v[56:59], a[176:179], a[28:31], v[56:59]
    v_mfma_f32_16x16x32_bf16 v[76:79], a[176:179], a[32:35], v[76:79]
    s_waitcnt vmcnt(12) lgkmcnt(0)
    v_mfma_f32_16x16x32_bf16 v[20:23], a[180:183], a[36:39], v[20:23]
    v_mfma_f32_16x16x32_bf16 v[40:43], a[180:183], a[40:43], v[40:43]
    ds_read_b64_tr_b16 a[160:161], v86 offset:28672
    ds_read_b64_tr_b16 a[162:163], v86 offset:29952
    v_mfma_f32_16x16x32_bf16 v[60:63], a[180:183], a[44:47], v[60:63]
    ds_read_b64_tr_b16 a[164:165], v86 offset:28704
    v_mfma_f32_16x16x32_bf16 v[24:27], a[184:187], a[36:39], v[24:27]
    ds_read_b64_tr_b16 a[166:167], v86 offset:29984
    v_mfma_f32_16x16x32_bf16 v[44:47], a[184:187], a[40:43], v[44:47]
    buffer_load_dwordx4 a[24:27], v253, s[8:11], s12 offen offset:1024 sc1
    v_mfma_f32_16x16x32_bf16 v[64:67], a[184:187], a[44:47], v[64:67]
    ds_read_b64_tr_b16 a[168:169], v86 offset:28736
    ds_read_b64_tr_b16 a[170:171], v86 offset:30016
    v_mfma_f32_16x16x32_bf16 v[28:31], a[188:191], a[36:39], v[28:31]
    ds_read_b64_tr_b16 a[172:173], v86 offset:28768
    v_mfma_f32_16x16x32_bf16 v[48:51], a[188:191], a[40:43], v[48:51]
    ds_read_b64_tr_b16 a[174:175], v86 offset:30048
    v_mfma_f32_16x16x32_bf16 v[68:71], a[188:191], a[44:47], v[68:71]
    buffer_load_dwordx4 a[28:31], v253, s[8:11], s12 offen offset:2048 sc1
    v_mfma_f32_16x16x32_bf16 v[32:35], a[192:195], a[36:39], v[32:35]
    ds_read_b64_tr_b16 a[176:177], v86 offset:28800
    ds_read_b64_tr_b16 a[178:179], v86 offset:30080
    v_mfma_f32_16x16x32_bf16 v[52:55], a[192:195], a[40:43], v[52:55]
    v_mfma_f32_16x16x32_bf16 v[72:75], a[192:195], a[44:47], v[72:75]
    buffer_load_dwordx4 a[32:35], v253, s[8:11], s12 offen offset:3072 sc1
    s_addk_i32 s12, 4096
    v_mfma_f32_16x16x32_bf16 v[36:39], a[196:199], a[36:39], v[36:39]
    v_mfma_f32_16x16x32_bf16 v[56:59], a[196:199], a[40:43], v[56:59]
    v_mfma_f32_16x16x32_bf16 v[76:79], a[196:199], a[44:47], v[76:79]
    s_waitcnt vmcnt(12) lgkmcnt(0)
    v_mfma_f32_16x16x32_bf16 v[20:23], a[160:163], a[48:51], v[20:23]
    v_mfma_f32_16x16x32_bf16 v[40:43], a[160:163], a[52:55], v[40:43]
    ds_read_b64_tr_b16 a[180:181], v86 offset:33792
    ds_read_b64_tr_b16 a[182:183], v86 offset:35072
    v_mfma_f32_16x16x32_bf16 v[60:63], a[160:163], a[56:59], v[60:63]
    ds_read_b64_tr_b16 a[184:185], v86 offset:33824
    v_mfma_f32_16x16x32_bf16 v[24:27], a[164:167], a[48:51], v[24:27]
    ds_read_b64_tr_b16 a[186:187], v86 offset:35104
    v_mfma_f32_16x16x32_bf16 v[44:47], a[164:167], a[52:55], v[44:47]
    buffer_load_dwordx4 a[36:39], v253, s[8:11], s12 offen offset:1024 sc1
    v_mfma_f32_16x16x32_bf16 v[64:67], a[164:167], a[56:59], v[64:67]
    ds_read_b64_tr_b16 a[188:189], v86 offset:33856
    ds_read_b64_tr_b16 a[190:191], v86 offset:35136
    v_mfma_f32_16x16x32_bf16 v[28:31], a[168:171], a[48:51], v[28:31]
    ds_read_b64_tr_b16 a[192:193], v86 offset:33888
    v_mfma_f32_16x16x32_bf16 v[48:51], a[168:171], a[52:55], v[48:51]
    ds_read_b64_tr_b16 a[194:195], v86 offset:35168
    v_mfma_f32_16x16x32_bf16 v[68:71], a[168:171], a[56:59], v[68:71]
    buffer_load_dwordx4 a[40:43], v253, s[8:11], s12 offen offset:2048 sc1
    v_mfma_f32_16x16x32_bf16 v[32:35], a[172:175], a[48:51], v[32:35]
    ds_read_b64_tr_b16 a[196:197], v86 offset:33920
    ds_read_b64_tr_b16 a[198:199], v86 offset:35200
    v_mfma_f32_16x16x32_bf16 v[52:55], a[172:175], a[52:55], v[52:55]
    s_and_b32 s3, s2, 7
    s_lshl_b32 s3, s3, 2
    v_mfma_f32_16x16x32_bf16 v[72:75], a[172:175], a[56:59], v[72:75]
    buffer_load_dwordx4 a[44:47], v253, s[8:11], s12 offen offset:3072 sc1
    s_add_u32 s12, s12, 4096
    v_mfma_f32_16x16x32_bf16 v[36:39], a[176:179], a[48:51], v[36:39]
    s_add_u32 s3, s3, s60
    s_add_u32 s3, s3, 0
    v_mfma_f32_16x16x32_bf16 v[56:59], a[176:179], a[52:55], v[56:59]
    s_lshl_b32 s63, s3, 8
    s_add_u32 s63, s63, 262144
    v_mov_b32 v88, s63
    v_mfma_f32_16x16x32_bf16 v[76:79], a[176:179], a[56:59], v[76:79]
    s_waitcnt vmcnt(12) lgkmcnt(0)
    v_mov_b32 v89, 1
    s_mov_b64 exec, 1
    global_atomic_add v88, v89, s[90:91] sc1
    s_mov_b64 exec, -1
    v_mfma_f32_16x16x32_bf16 v[20:23], a[180:183], a[60:63], v[20:23]
    v_mfma_f32_16x16x32_bf16 v[40:43], a[180:183], a[64:67], v[40:43]
    ds_read_b64_tr_b16 a[160:161], v86 offset:38912
    ds_read_b64_tr_b16 a[162:163], v86 offset:40192
    v_mfma_f32_16x16x32_bf16 v[60:63], a[180:183], a[68:71], v[60:63]
    ds_read_b64_tr_b16 a[164:165], v86 offset:38944
    v_mfma_f32_16x16x32_bf16 v[24:27], a[184:187], a[60:63], v[24:27]
    ds_read_b64_tr_b16 a[166:167], v86 offset:40224
    v_mfma_f32_16x16x32_bf16 v[44:47], a[184:187], a[64:67], v[44:47]
    buffer_load_dwordx4 a[48:51], v253, s[8:11], s12 offen offset:1024 sc1
    v_mfma_f32_16x16x32_bf16 v[64:67], a[184:187], a[68:71], v[64:67]
    ds_read_b64_tr_b16 a[168:169], v86 offset:38976
    ds_read_b64_tr_b16 a[170:171], v86 offset:40256
    v_mfma_f32_16x16x32_bf16 v[28:31], a[188:191], a[60:63], v[28:31]
    ds_read_b64_tr_b16 a[172:173], v86 offset:39008
    v_mfma_f32_16x16x32_bf16 v[48:51], a[188:191], a[64:67], v[48:51]
    ds_read_b64_tr_b16 a[174:175], v86 offset:40288
    v_mfma_f32_16x16x32_bf16 v[68:71], a[188:191], a[68:71], v[68:71]
    buffer_load_dwordx4 a[52:55], v253, s[8:11], s12 offen offset:2048 sc1
    v_mfma_f32_16x16x32_bf16 v[32:35], a[192:195], a[60:63], v[32:35]
    ds_read_b64_tr_b16 a[176:177], v86 offset:39040
    ds_read_b64_tr_b16 a[178:179], v86 offset:40320
    v_mfma_f32_16x16x32_bf16 v[52:55], a[192:195], a[64:67], v[52:55]
    v_mfma_f32_16x16x32_bf16 v[72:75], a[192:195], a[68:71], v[72:75]
    buffer_load_dwordx4 a[56:59], v253, s[8:11], s12 offen offset:3072 sc1
    s_add_u32 s12, s12, 4096
    v_mfma_f32_16x16x32_bf16 v[36:39], a[196:199], a[60:63], v[36:39]
    v_mfma_f32_16x16x32_bf16 v[56:59], a[196:199], a[64:67], v[56:59]
    v_mfma_f32_16x16x32_bf16 v[76:79], a[196:199], a[68:71], v[76:79]
    s_waitcnt vmcnt(13) lgkmcnt(0)
    v_mfma_f32_16x16x32_bf16 v[20:23], a[160:163], a[0:3], v[20:23]
    v_mfma_f32_16x16x32_bf16 v[40:43], a[160:163], a[4:7], v[40:43]
    ds_read_b64_tr_b16 a[180:181], v86 offset:44032
    ds_read_b64_tr_b16 a[182:183], v86 offset:45312
    v_mfma_f32_16x16x32_bf16 v[60:63], a[160:163], a[8:11], v[60:63]
    ds_read_b64_tr_b16 a[184:185], v86 offset:44064
    v_mfma_f32_16x16x32_bf16 v[24:27], a[164:167], a[0:3], v[24:27]
    ds_read_b64_tr_b16 a[186:187], v86 offset:45344
    v_mfma_f32_16x16x32_bf16 v[44:47], a[164:167], a[4:7], v[44:47]
    buffer_load_dwordx4 a[60:63], v253, s[8:11], s12 offen offset:1024 sc1
    v_mfma_f32_16x16x32_bf16 v[64:67], a[164:167], a[8:11], v[64:67]
    ds_read_b64_tr_b16 a[188:189], v86 offset:44096
    ds_read_b64_tr_b16 a[190:191], v86 offset:45376
    v_mfma_f32_16x16x32_bf16 v[28:31], a[168:171], a[0:3], v[28:31]
    ds_read_b64_tr_b16 a[192:193], v86 offset:44128
    v_mfma_f32_16x16x32_bf16 v[48:51], a[168:171], a[4:7], v[48:51]
    ds_read_b64_tr_b16 a[194:195], v86 offset:45408
    v_mfma_f32_16x16x32_bf16 v[68:71], a[168:171], a[8:11], v[68:71]
    buffer_load_dwordx4 a[64:67], v253, s[8:11], s12 offen offset:2048 sc1
    v_mfma_f32_16x16x32_bf16 v[32:35], a[172:175], a[0:3], v[32:35]
    ds_read_b64_tr_b16 a[196:197], v86 offset:44160
    ds_read_b64_tr_b16 a[198:199], v86 offset:45440
    v_mfma_f32_16x16x32_bf16 v[52:55], a[172:175], a[4:7], v[52:55]
    v_mfma_f32_16x16x32_bf16 v[72:75], a[172:175], a[8:11], v[72:75]
    buffer_load_dwordx4 a[68:71], v253, s[8:11], s12 offen offset:3072 sc1
    s_cmp_gt_u32 s57, 5
    s_cselect_b32 s12, 5, 6
    s_lshl_b32 s12, s12, 14
    v_mfma_f32_16x16x32_bf16 v[36:39], a[176:179], a[0:3], v[36:39]
    v_mfma_f32_16x16x32_bf16 v[56:59], a[176:179], a[4:7], v[56:59]
    v_mfma_f32_16x16x32_bf16 v[76:79], a[176:179], a[8:11], v[76:79]
    s_waitcnt vmcnt(13) lgkmcnt(0)
    v_mfma_f32_16x16x32_bf16 v[20:23], a[180:183], a[12:15], v[20:23]
    s_barrier
    v_mfma_f32_16x16x32_bf16 v[40:43], a[180:183], a[16:19], v[40:43]
    ds_read_b64_tr_b16 a[160:161], v84 offset:0
    ds_read_b64_tr_b16 a[162:163], v84 offset:1280
    v_mfma_f32_16x16x32_bf16 v[60:63], a[180:183], a[20:23], v[60:63]
    ds_read_b64_tr_b16 a[164:165], v84 offset:32
    v_mfma_f32_16x16x32_bf16 v[24:27], a[184:187], a[12:15], v[24:27]
    ds_read_b64_tr_b16 a[166:167], v84 offset:1312
    v_mfma_f32_16x16x32_bf16 v[44:47], a[184:187], a[16:19], v[44:47]
    buffer_load_dwordx4 a[0:3], v253, s[8:11], s12 offen offset:1024 sc1
    v_mfma_f32_16x16x32_bf16 v[64:67], a[184:187], a[20:23], v[64:67]
    ds_read_b64_tr_b16 a[168:169], v84 offset:64
    ds_read_b64_tr_b16 a[170:171], v84 offset:1344
    v_mfma_f32_16x16x32_bf16 v[28:31], a[188:191], a[12:15], v[28:31]
    ds_read_b64_tr_b16 a[172:173], v84 offset:96
    v_mfma_f32_16x16x32_bf16 v[48:51], a[188:191], a[16:19], v[48:51]
    ds_read_b64_tr_b16 a[174:175], v84 offset:1376
    v_mfma_f32_16x16x32_bf16 v[68:71], a[188:191], a[20:23], v[68:71]
    buffer_load_dwordx4 a[4:7], v253, s[8:11], s12 offen offset:2048 sc1
    v_mfma_f32_16x16x32_bf16 v[32:35], a[192:195], a[12:15], v[32:35]
    ds_read_b64_tr_b16 a[176:177], v84 offset:128
    ds_read_b64_tr_b16 a[178:179], v84 offset:1408
    v_mfma_f32_16x16x32_bf16 v[52:55], a[192:195], a[16:19], v[52:55]
    v_mfma_f32_16x16x32_bf16 v[72:75], a[192:195], a[20:23], v[72:75]
    buffer_load_dwordx4 a[8:11], v253, s[8:11], s12 offen offset:3072 sc1
    s_addk_i32 s12, 4096
    v_mfma_f32_16x16x32_bf16 v[36:39], a[196:199], a[12:15], v[36:39]
    v_mfma_f32_16x16x32_bf16 v[56:59], a[196:199], a[16:19], v[56:59]
    v_mfma_f32_16x16x32_bf16 v[76:79], a[196:199], a[20:23], v[76:79]
    s_waitcnt vmcnt(13) lgkmcnt(0)
    v_mfma_f32_16x16x32_bf16 v[20:23], a[160:163], a[24:27], v[20:23]
    v_mfma_f32_16x16x32_bf16 v[40:43], a[160:163], a[28:31], v[40:43]
    ds_read_b64_tr_b16 a[180:181], v84 offset:5120
    ds_read_b64_tr_b16 a[182:183], v84 offset:6400
    v_mfma_f32_16x16x32_bf16 v[60:63], a[160:163], a[32:35], v[60:63]
    ds_read_b64_tr_b16 a[184:185], v84 offset:5152
    v_mfma_f32_16x16x32_bf16 v[24:27], a[164:167], a[24:27], v[24:27]
    ds_read_b64_tr_b16 a[186:187], v84 offset:6432
    v_mfma_f32_16x16x32_bf16 v[44:47], a[164:167], a[28:31], v[44:47]
    buffer_load_dwordx4 a[12:15], v253, s[8:11], s12 offen offset:1024 sc1
    v_mfma_f32_16x16x32_bf16 v[64:67], a[164:167], a[32:35], v[64:67]
    ds_read_b64_tr_b16 a[188:189], v84 offset:5184
    ds_read_b64_tr_b16 a[190:191], v84 offset:6464
    v_mfma_f32_16x16x32_bf16 v[28:31], a[168:171], a[24:27], v[28:31]
    ds_read_b64_tr_b16 a[192:193], v84 offset:5216
    v_mfma_f32_16x16x32_bf16 v[48:51], a[168:171], a[28:31], v[48:51]
    ds_read_b64_tr_b16 a[194:195], v84 offset:6496
    v_mfma_f32_16x16x32_bf16 v[68:71], a[168:171], a[32:35], v[68:71]
    buffer_load_dwordx4 a[16:19], v253, s[8:11], s12 offen offset:2048 sc1
    v_mfma_f32_16x16x32_bf16 v[32:35], a[172:175], a[24:27], v[32:35]
    ds_read_b64_tr_b16 a[196:197], v84 offset:5248
    ds_read_b64_tr_b16 a[198:199], v84 offset:6528
    v_mfma_f32_16x16x32_bf16 v[52:55], a[172:175], a[28:31], v[52:55]
    v_mfma_f32_16x16x32_bf16 v[72:75], a[172:175], a[32:35], v[72:75]
    buffer_load_dwordx4 a[20:23], v253, s[8:11], s12 offen offset:3072 sc1
    s_addk_i32 s12, 4096
    v_mfma_f32_16x16x32_bf16 v[36:39], a[176:179], a[24:27], v[36:39]
    v_mfma_f32_16x16x32_bf16 v[56:59], a[176:179], a[28:31], v[56:59]
    v_mfma_f32_16x16x32_bf16 v[76:79], a[176:179], a[32:35], v[76:79]
    s_waitcnt vmcnt(13) lgkmcnt(0)
    v_mfma_f32_16x16x32_bf16 v[20:23], a[180:183], a[36:39], v[20:23]
    v_mfma_f32_16x16x32_bf16 v[40:43], a[180:183], a[40:43], v[40:43]
    ds_read_b64_tr_b16 a[160:161], v84 offset:10240
    ds_read_b64_tr_b16 a[162:163], v84 offset:11520
    v_mfma_f32_16x16x32_bf16 v[60:63], a[180:183], a[44:47], v[60:63]
    ds_read_b64_tr_b16 a[164:165], v84 offset:10272
    v_mfma_f32_16x16x32_bf16 v[24:27], a[184:187], a[36:39], v[24:27]
    ds_read_b64_tr_b16 a[166:167], v84 offset:11552
    v_mfma_f32_16x16x32_bf16 v[44:47], a[184:187], a[40:43], v[44:47]
    buffer_load_dwordx4 a[24:27], v253, s[8:11], s12 offen offset:1024 sc1
    v_mfma_f32_16x16x32_bf16 v[64:67], a[184:187], a[44:47], v[64:67]
    ds_read_b64_tr_b16 a[168:169], v84 offset:10304
    ds_read_b64_tr_b16 a[170:171], v84 offset:11584
    v_mfma_f32_16x16x32_bf16 v[28:31], a[188:191], a[36:39], v[28:31]
    ds_read_b64_tr_b16 a[172:173], v84 offset:10336
    v_mfma_f32_16x16x32_bf16 v[48:51], a[188:191], a[40:43], v[48:51]
    ds_read_b64_tr_b16 a[174:175], v84 offset:11616
    v_mfma_f32_16x16x32_bf16 v[68:71], a[188:191], a[44:47], v[68:71]
    buffer_load_dwordx4 a[28:31], v253, s[8:11], s12 offen offset:2048 sc1
    v_mfma_f32_16x16x32_bf16 v[32:35], a[192:195], a[36:39], v[32:35]
    ds_read_b64_tr_b16 a[176:177], v84 offset:10368
    ds_read_b64_tr_b16 a[178:179], v84 offset:11648
    v_mfma_f32_16x16x32_bf16 v[52:55], a[192:195], a[40:43], v[52:55]
    v_mfma_f32_16x16x32_bf16 v[72:75], a[192:195], a[44:47], v[72:75]
    buffer_load_dwordx4 a[32:35], v253, s[8:11], s12 offen offset:3072 sc1
    s_addk_i32 s12, 4096
    v_mfma_f32_16x16x32_bf16 v[36:39], a[196:199], a[36:39], v[36:39]
    v_mfma_f32_16x16x32_bf16 v[56:59], a[196:199], a[40:43], v[56:59]
    v_mfma_f32_16x16x32_bf16 v[76:79], a[196:199], a[44:47], v[76:79]
    s_waitcnt vmcnt(12) lgkmcnt(0)
    v_mfma_f32_16x16x32_bf16 v[20:23], a[160:163], a[48:51], v[20:23]
    v_mfma_f32_16x16x32_bf16 v[40:43], a[160:163], a[52:55], v[40:43]
    ds_read_b64_tr_b16 a[180:181], v84 offset:15360
    ds_read_b64_tr_b16 a[182:183], v84 offset:16640
    v_mfma_f32_16x16x32_bf16 v[60:63], a[160:163], a[56:59], v[60:63]
    ds_read_b64_tr_b16 a[184:185], v84 offset:15392
    v_mfma_f32_16x16x32_bf16 v[24:27], a[164:167], a[48:51], v[24:27]
    ds_read_b64_tr_b16 a[186:187], v84 offset:16672
    v_mfma_f32_16x16x32_bf16 v[44:47], a[164:167], a[52:55], v[44:47]
    buffer_load_dwordx4 a[36:39], v253, s[8:11], s12 offen offset:1024 sc1
    v_mfma_f32_16x16x32_bf16 v[64:67], a[164:167], a[56:59], v[64:67]
    ds_read_b64_tr_b16 a[188:189], v84 offset:15424
    ds_read_b64_tr_b16 a[190:191], v84 offset:16704
    v_mfma_f32_16x16x32_bf16 v[28:31], a[168:171], a[48:51], v[28:31]
    ds_read_b64_tr_b16 a[192:193], v84 offset:15456
    v_mfma_f32_16x16x32_bf16 v[48:51], a[168:171], a[52:55], v[48:51]
    ds_read_b64_tr_b16 a[194:195], v84 offset:16736
    v_mfma_f32_16x16x32_bf16 v[68:71], a[168:171], a[56:59], v[68:71]
    buffer_load_dwordx4 a[40:43], v253, s[8:11], s12 offen offset:2048 sc1
    v_mfma_f32_16x16x32_bf16 v[32:35], a[172:175], a[48:51], v[32:35]
    ds_read_b64_tr_b16 a[196:197], v84 offset:15488
    ds_read_b64_tr_b16 a[198:199], v84 offset:16768
    v_mfma_f32_16x16x32_bf16 v[52:55], a[172:175], a[52:55], v[52:55]
    v_mfma_f32_16x16x32_bf16 v[72:75], a[172:175], a[56:59], v[72:75]
    buffer_load_dwordx4 a[44:47], v253, s[8:11], s12 offen offset:3072 sc1
    s_cmp_gt_u32 s57, 6
    s_cselect_b32 s12, 6, 7
    s_lshl_b32 s12, s12, 14
    v_mfma_f32_16x16x32_bf16 v[36:39], a[176:179], a[48:51], v[36:39]
    v_mfma_f32_16x16x32_bf16 v[56:59], a[176:179], a[52:55], v[56:59]
    v_mfma_f32_16x16x32_bf16 v[76:79], a[176:179], a[56:59], v[76:79]
    s_waitcnt vmcnt(12) lgkmcnt(0)
    v_mfma_f32_16x16x32_bf16 v[20:23], a[180:183], a[60:63], v[20:23]
    v_mfma_f32_16x16x32_bf16 v[40:43], a[180:183], a[64:67], v[40:43]
    ds_read_b64_tr_b16 a[160:161], v85 offset:4096
    ds_read_b64_tr_b16 a[162:163], v85 offset:5376
    v_mfma_f32_16x16x32_bf16 v[60:63], a[180:183], a[68:71], v[60:63]
    ds_read_b64_tr_b16 a[164:165], v85 offset:4128
    v_mfma_f32_16x16x32_bf16 v[24:27], a[184:187], a[60:63], v[24:27]
    ds_read_b64_tr_b16 a[166:167], v85 offset:5408
    v_mfma_f32_16x16x32_bf16 v[44:47], a[184:187], a[64:67], v[44:47]
    buffer_load_dwordx4 a[48:51], v253, s[8:11], s12 offen offset:1024 sc1
    v_mfma_f32_16x16x32_bf16 v[64:67], a[184:187], a[68:71], v[64:67]
    ds_read_b64_tr_b16 a[168:169], v85 offset:4160
    ds_read_b64_tr_b16 a[170:171], v85 offset:5440
    v_mfma_f32_16x16x32_bf16 v[28:31], a[188:191], a[60:63], v[28:31]
    ds_read_b64_tr_b16 a[172:173], v85 offset:4192
    v_mfma_f32_16x16x32_bf16 v[48:51], a[188:191], a[64:67], v[48:51]
    ds_read_b64_tr_b16 a[174:175], v85 offset:5472
    v_mfma_f32_16x16x32_bf16 v[68:71], a[188:191], a[68:71], v[68:71]
    buffer_load_dwordx4 a[52:55], v253, s[8:11], s12 offen offset:2048 sc1
    v_mfma_f32_16x16x32_bf16 v[32:35], a[192:195], a[60:63], v[32:35]
    ds_read_b64_tr_b16 a[176:177], v85 offset:4224
    ds_read_b64_tr_b16 a[178:179], v85 offset:5504
    v_mfma_f32_16x16x32_bf16 v[52:55], a[192:195], a[64:67], v[52:55]
    v_mfma_f32_16x16x32_bf16 v[72:75], a[192:195], a[68:71], v[72:75]
    buffer_load_dwordx4 a[56:59], v253, s[8:11], s12 offen offset:3072 sc1
    s_addk_i32 s12, 4096
    v_mfma_f32_16x16x32_bf16 v[36:39], a[196:199], a[60:63], v[36:39]
    v_mfma_f32_16x16x32_bf16 v[56:59], a[196:199], a[64:67], v[56:59]
    v_mfma_f32_16x16x32_bf16 v[76:79], a[196:199], a[68:71], v[76:79]
    s_waitcnt vmcnt(12) lgkmcnt(0)
    v_mfma_f32_16x16x32_bf16 v[20:23], a[160:163], a[0:3], v[20:23]
    v_mfma_f32_16x16x32_bf16 v[40:43], a[160:163], a[4:7], v[40:43]
    ds_read_b64_tr_b16 a[180:181], v85 offset:9216
    ds_read_b64_tr_b16 a[182:183], v85 offset:10496
    v_mfma_f32_16x16x32_bf16 v[60:63], a[160:163], a[8:11], v[60:63]
    ds_read_b64_tr_b16 a[184:185], v85 offset:9248
    v_mfma_f32_16x16x32_bf16 v[24:27], a[164:167], a[0:3], v[24:27]
    ds_read_b64_tr_b16 a[186:187], v85 offset:10528
    v_mfma_f32_16x16x32_bf16 v[44:47], a[164:167], a[4:7], v[44:47]
    buffer_load_dwordx4 a[60:63], v253, s[8:11], s12 offen offset:1024 sc1
    v_mfma_f32_16x16x32_bf16 v[64:67], a[164:167], a[8:11], v[64:67]
    ds_read_b64_tr_b16 a[188:189], v85 offset:9280
    ds_read_b64_tr_b16 a[190:191], v85 offset:10560
    v_mfma_f32_16x16x32_bf16 v[28:31], a[168:171], a[0:3], v[28:31]
    ds_read_b64_tr_b16 a[192:193], v85 offset:9312
    v_mfma_f32_16x16x32_bf16 v[48:51], a[168:171], a[4:7], v[48:51]
    ds_read_b64_tr_b16 a[194:195], v85 offset:10592
    v_mfma_f32_16x16x32_bf16 v[68:71], a[168:171], a[8:11], v[68:71]
    buffer_load_dwordx4 a[64:67], v253, s[8:11], s12 offen offset:2048 sc1
    v_mfma_f32_16x16x32_bf16 v[32:35], a[172:175], a[0:3], v[32:35]
    ds_read_b64_tr_b16 a[196:197], v85 offset:9344
    ds_read_b64_tr_b16 a[198:199], v85 offset:10624
    v_mfma_f32_16x16x32_bf16 v[52:55], a[172:175], a[4:7], v[52:55]
    v_and_b32 v153, 0x1f0, v253
    v_mfma_f32_16x16x32_bf16 v[72:75], a[172:175], a[8:11], v[72:75]
    buffer_load_dwordx4 a[68:71], v253, s[8:11], s12 offen offset:3072 sc1
    s_add_u32 s12, s12, 4096
    v_mfma_f32_16x16x32_bf16 v[36:39], a[176:179], a[0:3], v[36:39]
    v_lshlrev_b32_e64 v153, 4, v153
    v_mfma_f32_16x16x32_bf16 v[56:59], a[176:179], a[4:7], v[56:59]
    v_add_u32 v153, 262144, v153
    v_mfma_f32_16x16x32_bf16 v[76:79], a[176:179], a[8:11], v[76:79]
    s_waitcnt vmcnt(12) lgkmcnt(0)
    v_lshrrev_b32 v92, 1, v253
    v_mfma_f32_16x16x32_bf16 v[20:23], a[180:183], a[12:15], v[20:23]
    v_mfma_f32_16x16x32_bf16 v[40:43], a[180:183], a[16:19], v[40:43]
    ds_read_b64_tr_b16 a[160:161], v85 offset:14336
    ds_read_b64_tr_b16 a[162:163], v85 offset:15616
    v_mfma_f32_16x16x32_bf16 v[60:63], a[180:183], a[20:23], v[60:63]
    ds_read_b64_tr_b16 a[164:165], v85 offset:14368
    v_mfma_f32_16x16x32_bf16 v[24:27], a[184:187], a[12:15], v[24:27]
    ds_read_b64_tr_b16 a[166:167], v85 offset:15648
    v_mfma_f32_16x16x32_bf16 v[44:47], a[184:187], a[16:19], v[44:47]
    buffer_load_dwordx4 a[0:3], v253, s[8:11], s12 offen offset:1024 sc1
    v_mfma_f32_16x16x32_bf16 v[64:67], a[184:187], a[20:23], v[64:67]
    ds_read_b64_tr_b16 a[168:169], v85 offset:14400
    ds_read_b64_tr_b16 a[170:171], v85 offset:15680
    v_mfma_f32_16x16x32_bf16 v[28:31], a[188:191], a[12:15], v[28:31]
    ds_read_b64_tr_b16 a[172:173], v85 offset:14432
    v_mfma_f32_16x16x32_bf16 v[48:51], a[188:191], a[16:19], v[48:51]
    ds_read_b64_tr_b16 a[174:175], v85 offset:15712
    v_mfma_f32_16x16x32_bf16 v[68:71], a[188:191], a[20:23], v[68:71]
    buffer_load_dwordx4 a[4:7], v253, s[8:11], s12 offen offset:2048 sc1
    v_mfma_f32_16x16x32_bf16 v[32:35], a[192:195], a[12:15], v[32:35]
    ds_read_b64_tr_b16 a[176:177], v85 offset:14464
    ds_read_b64_tr_b16 a[178:179], v85 offset:15744
    v_mfma_f32_16x16x32_bf16 v[52:55], a[192:195], a[16:19], v[52:55]
    s_mul_i32 s3, s47, 30720
    v_mfma_f32_16x16x32_bf16 v[72:75], a[192:195], a[20:23], v[72:75]
    buffer_load_dwordx4 a[8:11], v253, s[8:11], s12 offen offset:3072 sc1
    s_addk_i32 s12, 4096
    v_mfma_f32_16x16x32_bf16 v[36:39], a[196:199], a[12:15], v[36:39]
    s_add_u32 s3, s3, 54525952
    v_mfma_f32_16x16x32_bf16 v[56:59], a[196:199], a[16:19], v[56:59]
    s_add_u32 s52, s90, s3
    s_addc_u32 s53, s91, 0
    s_mov_b32 s54, 30720
    v_mfma_f32_16x16x32_bf16 v[76:79], a[196:199], a[20:23], v[76:79]
    s_waitcnt vmcnt(12) lgkmcnt(0)
    s_mov_b32 s55, 0x00020000
    v_mfma_f32_16x16x32_bf16 v[20:23], a[160:163], a[24:27], v[20:23]
    v_mfma_f32_16x16x32_bf16 v[40:43], a[160:163], a[28:31], v[40:43]
    ds_read_b64_tr_b16 a[180:181], v85 offset:19456
    ds_read_b64_tr_b16 a[182:183], v85 offset:20736
    v_mfma_f32_16x16x32_bf16 v[60:63], a[160:163], a[32:35], v[60:63]
    ds_read_b64_tr_b16 a[184:185], v85 offset:19488
    v_mfma_f32_16x16x32_bf16 v[24:27], a[164:167], a[24:27], v[24:27]
    ds_read_b64_tr_b16 a[186:187], v85 offset:20768
    v_mfma_f32_16x16x32_bf16 v[44:47], a[164:167], a[28:31], v[44:47]
    buffer_load_dwordx4 a[12:15], v253, s[8:11], s12 offen offset:1024 sc1
    v_mfma_f32_16x16x32_bf16 v[64:67], a[164:167], a[32:35], v[64:67]
    ds_read_b64_tr_b16 a[188:189], v85 offset:19520
    ds_read_b64_tr_b16 a[190:191], v85 offset:20800
    v_mfma_f32_16x16x32_bf16 v[28:31], a[168:171], a[24:27], v[28:31]
    ds_read_b64_tr_b16 a[192:193], v85 offset:19552
    v_mfma_f32_16x16x32_bf16 v[48:51], a[168:171], a[28:31], v[48:51]
    ds_read_b64_tr_b16 a[194:195], v85 offset:20832
    v_mfma_f32_16x16x32_bf16 v[68:71], a[168:171], a[32:35], v[68:71]
    buffer_load_dwordx4 a[16:19], v253, s[8:11], s12 offen offset:2048 sc1
    v_mfma_f32_16x16x32_bf16 v[32:35], a[172:175], a[24:27], v[32:35]
    ds_read_b64_tr_b16 a[196:197], v85 offset:19584
    ds_read_b64_tr_b16 a[198:199], v85 offset:20864
    v_mfma_f32_16x16x32_bf16 v[52:55], a[172:175], a[28:31], v[52:55]
    v_mfma_f32_16x16x32_bf16 v[72:75], a[172:175], a[32:35], v[72:75]
    buffer_load_dwordx4 a[20:23], v253, s[8:11], s12 offen offset:3072 sc1
    s_cmp_gt_u32 s57, 7
    s_cselect_b32 s12, 7, 8
    s_lshl_b32 s12, s12, 14
    v_mfma_f32_16x16x32_bf16 v[36:39], a[176:179], a[24:27], v[36:39]
    v_mfma_f32_16x16x32_bf16 v[56:59], a[176:179], a[28:31], v[56:59]
    v_mfma_f32_16x16x32_bf16 v[76:79], a[176:179], a[32:35], v[76:79]
    s_waitcnt vmcnt(12) lgkmcnt(0)
    v_mfma_f32_16x16x32_bf16 v[20:23], a[180:183], a[36:39], v[20:23]
    buffer_load_dwordx4 a[72:75], v253, s[8:11], s98 offen sc1
    s_add_u32 s98, s98, 4096
    v_mfma_f32_16x16x32_bf16 v[40:43], a[180:183], a[40:43], v[40:43]
    ds_read_b64_tr_b16 a[160:161], v85 offset:24576
    ds_read_b64_tr_b16 a[162:163], v85 offset:25856
    v_mfma_f32_16x16x32_bf16 v[60:63], a[180:183], a[44:47], v[60:63]
    ds_read_b64_tr_b16 a[164:165], v85 offset:24608
    v_mfma_f32_16x16x32_bf16 v[24:27], a[184:187], a[36:39], v[24:27]
    ds_read_b64_tr_b16 a[166:167], v85 offset:25888
    v_mfma_f32_16x16x32_bf16 v[44:47], a[184:187], a[40:43], v[44:47]
    buffer_load_dwordx4 a[76:79], v253, s[8:11], s98 offen sc1
    s_add_u32 s98, s98, 4096
    v_mfma_f32_16x16x32_bf16 v[64:67], a[184:187], a[44:47], v[64:67]
    ds_read_b64_tr_b16 a[168:169], v85 offset:24640
    ds_read_b64_tr_b16 a[170:171], v85 offset:25920
    v_mfma_f32_16x16x32_bf16 v[28:31], a[188:191], a[36:39], v[28:31]
    ds_read_b64_tr_b16 a[172:173], v85 offset:24672
    v_mfma_f32_16x16x32_bf16 v[48:51], a[188:191], a[40:43], v[48:51]
    ds_read_b64_tr_b16 a[174:175], v85 offset:25952
    v_mfma_f32_16x16x32_bf16 v[68:71], a[188:191], a[44:47], v[68:71]
    buffer_load_dwordx4 a[80:83], v253, s[8:11], s98 offen sc1
    s_add_u32 s98, s98, 4096
    v_mfma_f32_16x16x32_bf16 v[32:35], a[192:195], a[36:39], v[32:35]
    ds_read_b64_tr_b16 a[176:177], v85 offset:24704
    ds_read_b64_tr_b16 a[178:179], v85 offset:25984
    v_mfma_f32_16x16x32_bf16 v[52:55], a[192:195], a[40:43], v[52:55]
    v_mfma_f32_16x16x32_bf16 v[72:75], a[192:195], a[44:47], v[72:75]
    buffer_load_dwordx4 a[84:87], v253, s[8:11], s98 offen sc1
    s_cmp_gt_u32 s57, 1
    s_cselect_b32 s98, 1, 2
    s_lshl_b32 s98, s98, 14
    v_mfma_f32_16x16x32_bf16 v[36:39], a[196:199], a[36:39], v[36:39]
    v_mfma_f32_16x16x32_bf16 v[56:59], a[196:199], a[40:43], v[56:59]
    v_mfma_f32_16x16x32_bf16 v[76:79], a[196:199], a[44:47], v[76:79]
    s_waitcnt vmcnt(13) lgkmcnt(0)
    v_mfma_f32_16x16x32_bf16 v[20:23], a[160:163], a[48:51], v[20:23]
    buffer_load_dwordx4 a[88:91], v253, s[8:11], s98 offen sc1
    s_add_u32 s98, s98, 4096
    v_mfma_f32_16x16x32_bf16 v[40:43], a[160:163], a[52:55], v[40:43]
    ds_read_b64_tr_b16 a[180:181], v85 offset:29696
    ds_read_b64_tr_b16 a[182:183], v85 offset:30976
    v_mfma_f32_16x16x32_bf16 v[60:63], a[160:163], a[56:59], v[60:63]
    ds_read_b64_tr_b16 a[184:185], v85 offset:29728
    v_mfma_f32_16x16x32_bf16 v[24:27], a[164:167], a[48:51], v[24:27]
    ds_read_b64_tr_b16 a[186:187], v85 offset:31008
    v_mfma_f32_16x16x32_bf16 v[44:47], a[164:167], a[52:55], v[44:47]
    buffer_load_dwordx4 a[92:95], v253, s[8:11], s98 offen sc1
    s_add_u32 s98, s98, 4096
    v_mfma_f32_16x16x32_bf16 v[64:67], a[164:167], a[56:59], v[64:67]
    ds_read_b64_tr_b16 a[188:189], v85 offset:29760
    ds_read_b64_tr_b16 a[190:191], v85 offset:31040
    v_mfma_f32_16x16x32_bf16 v[28:31], a[168:171], a[48:51], v[28:31]
    ds_read_b64_tr_b16 a[192:193], v85 offset:29792
    v_mfma_f32_16x16x32_bf16 v[48:51], a[168:171], a[52:55], v[48:51]
    ds_read_b64_tr_b16 a[194:195], v85 offset:31072
    v_mfma_f32_16x16x32_bf16 v[68:71], a[168:171], a[56:59], v[68:71]
    buffer_load_dwordx4 a[96:99], v253, s[8:11], s98 offen sc1
    s_add_u32 s98, s98, 4096
    v_mfma_f32_16x16x32_bf16 v[32:35], a[172:175], a[48:51], v[32:35]
    ds_read_b64_tr_b16 a[196:197], v85 offset:29824
    ds_read_b64_tr_b16 a[198:199], v85 offset:31104
    v_mfma_f32_16x16x32_bf16 v[52:55], a[172:175], a[52:55], v[52:55]
    v_mfma_f32_16x16x32_bf16 v[72:75], a[172:175], a[56:59], v[72:75]
    buffer_load_dwordx4 a[100:103], v253, s[8:11], s98 offen sc1
    s_cmp_gt_u32 s57, 2
    s_cselect_b32 s98, 2, 3
    s_lshl_b32 s98, s98, 14
    v_mfma_f32_16x16x32_bf16 v[36:39], a[176:179], a[48:51], v[36:39]
    v_mfma_f32_16x16x32_bf16 v[56:59], a[176:179], a[52:55], v[56:59]
    v_mfma_f32_16x16x32_bf16 v[76:79], a[176:179], a[56:59], v[76:79]
    s_waitcnt vmcnt(14) lgkmcnt(0)
    v_mfma_f32_16x16x32_bf16 v[20:23], a[180:183], a[60:63], v[20:23]
    v_mfma_f32_16x16x32_bf16 v[40:43], a[180:183], a[64:67], v[40:43]
    ds_read_b64_tr_b16 a[160:161], v85 offset:34816
    ds_read_b64_tr_b16 a[162:163], v85 offset:36096
    v_mfma_f32_16x16x32_bf16 v[60:63], a[180:183], a[68:71], v[60:63]
    ds_read_b64_tr_b16 a[164:165], v85 offset:34848
    v_mfma_f32_16x16x32_bf16 v[24:27], a[184:187], a[60:63], v[24:27]
    ds_read_b64_tr_b16 a[166:167], v85 offset:36128
    v_mfma_f32_16x16x32_bf16 v[44:47], a[184:187], a[64:67], v[44:47]
    v_mfma_f32_16x16x32_bf16 v[64:67], a[184:187], a[68:71], v[64:67]
    ds_read_b64_tr_b16 a[168:169], v85 offset:34880
    ds_read_b64_tr_b16 a[170:171], v85 offset:36160
    v_mfma_f32_16x16x32_bf16 v[28:31], a[188:191], a[60:63], v[28:31]
    ds_read_b64_tr_b16 a[172:173], v85 offset:34912
    v_mfma_f32_16x16x32_bf16 v[48:51], a[188:191], a[64:67], v[48:51]
    ds_read_b64_tr_b16 a[174:175], v85 offset:36192
    v_mfma_f32_16x16x32_bf16 v[68:71], a[188:191], a[68:71], v[68:71]
    v_mfma_f32_16x16x32_bf16 v[32:35], a[192:195], a[60:63], v[32:35]
    ds_read_b64_tr_b16 a[176:177], v85 offset:34944
    ds_read_b64_tr_b16 a[178:179], v85 offset:36224
    v_mfma_f32_16x16x32_bf16 v[52:55], a[192:195], a[64:67], v[52:55]
    v_mfma_f32_16x16x32_bf16 v[72:75], a[192:195], a[68:71], v[72:75]
    v_mfma_f32_16x16x32_bf16 v[36:39], a[196:199], a[60:63], v[36:39]
    v_mfma_f32_16x16x32_bf16 v[56:59], a[196:199], a[64:67], v[56:59]
    v_mfma_f32_16x16x32_bf16 v[76:79], a[196:199], a[68:71], v[76:79]
    s_waitcnt vmcnt(11) lgkmcnt(0)
    v_mfma_f32_16x16x32_bf16 v[20:23], a[160:163], a[0:3], v[20:23]
    global_load_dwordx2 v[240:241], v250, s[64:65] offset:0
    v_mfma_f32_16x16x32_bf16 v[40:43], a[160:163], a[4:7], v[40:43]
    ds_read_b64_tr_b16 a[180:181], v84 offset:20480
    ds_read_b64_tr_b16 a[182:183], v84 offset:21760
    v_mfma_f32_16x16x32_bf16 v[60:63], a[160:163], a[8:11], v[60:63]
    ds_read_b64_tr_b16 a[184:185], v84 offset:20512
    v_mfma_f32_16x16x32_bf16 v[24:27], a[164:167], a[0:3], v[24:27]
    ds_read_b64_tr_b16 a[186:187], v84 offset:21792
    v_mfma_f32_16x16x32_bf16 v[44:47], a[164:167], a[4:7], v[44:47]
    global_load_dwordx2 v[242:243], v250, s[64:65] offset:32
    v_mfma_f32_16x16x32_bf16 v[64:67], a[164:167], a[8:11], v[64:67]
    ds_read_b64_tr_b16 a[188:189], v84 offset:20544
    ds_read_b64_tr_b16 a[190:191], v84 offset:21824
    v_mfma_f32_16x16x32_bf16 v[28:31], a[168:171], a[0:3], v[28:31]
    ds_read_b64_tr_b16 a[192:193], v84 offset:20576
    v_mfma_f32_16x16x32_bf16 v[48:51], a[168:171], a[4:7], v[48:51]
    ds_read_b64_tr_b16 a[194:195], v84 offset:21856
    v_mfma_f32_16x16x32_bf16 v[68:71], a[168:171], a[8:11], v[68:71]
    global_load_dwordx2 v[244:245], v250, s[64:65] offset:64
    v_mfma_f32_16x16x32_bf16 v[32:35], a[172:175], a[0:3], v[32:35]
    ds_read_b64_tr_b16 a[196:197], v84 offset:20608
    ds_read_b64_tr_b16 a[198:199], v84 offset:21888
    v_mfma_f32_16x16x32_bf16 v[52:55], a[172:175], a[4:7], v[52:55]
    global_load_dwordx2 v[246:247], v250, s[64:65] offset:96
    v_mfma_f32_16x16x32_bf16 v[72:75], a[172:175], a[8:11], v[72:75]
    global_load_dwordx2 v[248:249], v250, s[64:65] offset:128
    v_mfma_f32_16x16x32_bf16 v[36:39], a[176:179], a[0:3], v[36:39]
    v_mfma_f32_16x16x32_bf16 v[56:59], a[176:179], a[4:7], v[56:59]
    v_mfma_f32_16x16x32_bf16 v[76:79], a[176:179], a[8:11], v[76:79]
    s_waitcnt vmcnt(13) lgkmcnt(0)
    v_mfma_f32_16x16x32_bf16 v[20:23], a[180:183], a[12:15], v[20:23]
    ds_read_b64_tr_b16 v[116:117], v85 offset:39936
    ds_read_b64_tr_b16 v[118:119], v85 offset:41216
    v_mfma_f32_16x16x32_bf16 v[24:27], a[184:187], a[12:15], v[24:27]
    ds_read_b64_tr_b16 v[120:121], v85 offset:39968
    ds_read_b64_tr_b16 v[122:123], v85 offset:41248
    v_mfma_f32_16x16x32_bf16 v[28:31], a[188:191], a[12:15], v[28:31]
    ds_read_b64_tr_b16 v[124:125], v85 offset:40000
    ds_read_b64_tr_b16 v[126:127], v85 offset:41280
    v_mfma_f32_16x16x32_bf16 v[32:35], a[192:195], a[12:15], v[32:35]
    ds_read_b64_tr_b16 v[128:129], v85 offset:40032
    ds_read_b64_tr_b16 v[130:131], v85 offset:41312
    v_mfma_f32_16x16x32_bf16 v[36:39], a[196:199], a[12:15], v[36:39]
    ds_read_b64_tr_b16 v[132:133], v85 offset:40064
    ds_read_b64_tr_b16 v[134:135], v85 offset:41344
    v_mfma_f32_16x16x32_bf16 v[40:43], a[180:183], a[16:19], v[40:43]
    v_mfma_f32_16x16x32_bf16 v[44:47], a[184:187], a[16:19], v[44:47]
    v_mfma_f32_16x16x32_bf16 v[48:51], a[188:191], a[16:19], v[48:51]
    v_mfma_f32_16x16x32_bf16 v[52:55], a[192:195], a[16:19], v[52:55]
    v_mfma_f32_16x16x32_bf16 v[56:59], a[196:199], a[16:19], v[56:59]
    v_cvt_pk_bf16_f32 v20, v20, v21
    v_cvt_pk_bf16_f32 v21, v22, v23
    v_cvt_pk_bf16_f32 v22, v24, v25
    v_mfma_f32_16x16x32_bf16 v[60:63], a[180:183], a[20:23], v[60:63]
    v_cvt_pk_bf16_f32 v23, v26, v27
    v_cvt_pk_bf16_f32 v24, v28, v29
    v_cvt_pk_bf16_f32 v25, v30, v31
    v_mfma_f32_16x16x32_bf16 v[64:67], a[184:187], a[20:23], v[64:67]
    v_cvt_pk_bf16_f32 v26, v32, v33
    v_cvt_pk_bf16_f32 v27, v34, v35
    v_cvt_pk_bf16_f32 v28, v36, v37
    v_mfma_f32_16x16x32_bf16 v[68:71], a[188:191], a[20:23], v[68:71]
    v_cvt_pk_bf16_f32 v29, v38, v39
    buffer_store_dwordx4 v[20:23], v253, s[52:55], s13 offen sc1
    v_mfma_f32_16x16x32_bf16 v[72:75], a[192:195], a[20:23], v[72:75]
    buffer_store_dwordx4 v[24:27], v253, s[52:55], s13 offen offset:1024 sc1
    v_mfma_f32_16x16x32_bf16 v[76:79], a[196:199], a[20:23], v[76:79]
    buffer_store_dwordx2 v[28:29], v92, s[52:55], s13 offen offset:2048 sc1
    v_cvt_pk_bf16_f32 v40, v40, v41
    v_cvt_pk_bf16_f32 v41, v42, v43
    v_cvt_pk_bf16_f32 v42, v44, v45
    v_cvt_pk_bf16_f32 v43, v46, v47
    v_cvt_pk_bf16_f32 v44, v48, v49
    v_cvt_pk_bf16_f32 v45, v50, v51
    v_cvt_pk_bf16_f32 v46, v52, v53
    v_cvt_pk_bf16_f32 v47, v54, v55
    v_cvt_pk_bf16_f32 v48, v56, v57
    v_cvt_pk_bf16_f32 v49, v58, v59
    buffer_store_dwordx4 v[40:43], v253, s[52:55], s14 offen sc1
    buffer_store_dwordx4 v[44:47], v253, s[52:55], s14 offen offset:1024 sc1
    buffer_store_dwordx2 v[48:49], v92, s[52:55], s14 offen offset:2048 sc1
    v_cvt_pk_bf16_f32 v60, v60, v61
    v_cvt_pk_bf16_f32 v61, v62, v63
    v_cvt_pk_bf16_f32 v62, v64, v65
    v_cvt_pk_bf16_f32 v63, v66, v67
    v_cvt_pk_bf16_f32 v64, v68, v69
    v_cvt_pk_bf16_f32 v65, v70, v71
    v_cvt_pk_bf16_f32 v66, v72, v73
    v_cvt_pk_bf16_f32 v67, v74, v75
    v_cvt_pk_bf16_f32 v68, v76, v77
    v_cvt_pk_bf16_f32 v69, v78, v79
    buffer_store_dwordx4 v[60:63], v253, s[52:55], s15 offen sc1
    buffer_store_dwordx4 v[64:67], v253, s[52:55], s15 offen offset:1024 sc1
    buffer_store_dwordx2 v[68:69], v92, s[52:55], s15 offen offset:2048 sc1
    ds_read_b64_tr_b16 v[160:161], v85 offset:45056
    ds_read_b64_tr_b16 v[162:163], v85 offset:46336
    ds_read_b64_tr_b16 v[164:165], v85 offset:45088
    ds_read_b64_tr_b16 v[166:167], v85 offset:46368
    ds_read_b64_tr_b16 v[168:169], v85 offset:45120
    ds_read_b64_tr_b16 v[170:171], v85 offset:46400
    ds_read_b64_tr_b16 v[172:173], v85 offset:45152
    ds_read_b64_tr_b16 v[174:175], v85 offset:46432
    ds_read_b64_tr_b16 v[176:177], v85 offset:45184
    ds_read_b64_tr_b16 v[178:179], v85 offset:46464
    s_waitcnt vmcnt(21) lgkmcnt(10)
    v_mfma_f32_16x16x32_bf16 v[0:3], v[116:119], a[72:75], v[0:3]
    ds_read_b64_tr_b16 v[96:97], v85 offset:50176
    ds_read_b64_tr_b16 v[98:99], v85 offset:51456
    v_mfma_f32_16x16x32_bf16 v[4:7], v[120:123], a[72:75], v[4:7]
    ds_read_b64_tr_b16 v[100:101], v85 offset:50208
    ds_read_b64_tr_b16 v[102:103], v85 offset:51488
    v_mfma_f32_16x16x32_bf16 v[8:11], v[124:127], a[72:75], v[8:11]
    ds_read_b64_tr_b16 v[104:105], v85 offset:50240
    ds_read_b64_tr_b16 v[106:107], v85 offset:51520
    buffer_load_dwordx4 a[104:107], v253, s[8:11], s98 offen sc1
    s_add_u32 s98, s98, 4096
    v_mfma_f32_16x16x32_bf16 v[12:15], v[128:131], a[72:75], v[12:15]
    ds_read_b64_tr_b16 v[108:109], v85 offset:50272
    ds_read_b64_tr_b16 v[110:111], v85 offset:51552
    v_mfma_f32_16x16x32_bf16 v[16:19], v[132:135], a[72:75], v[16:19]
    ds_read_b64_tr_b16 v[112:113], v85 offset:50304
    ds_read_b64_tr_b16 v[114:115], v85 offset:51584
    s_waitcnt vmcnt(21) lgkmcnt(10)
    v_mfma_f32_16x16x32_bf16 v[0:3], v[160:163], a[76:79], v[0:3]
    ds_read_b64_tr_b16 v[116:117], v85 offset:55296
    ds_read_b64_tr_b16 v[118:119], v85 offset:56576
    v_mfma_f32_16x16x32_bf16 v[4:7], v[164:167], a[76:79], v[4:7]
    ds_read_b64_tr_b16 v[120:121], v85 offset:55328
    ds_read_b64_tr_b16 v[122:123], v85 offset:56608
    v_mfma_f32_16x16x32_bf16 v[8:11], v[168:171], a[76:79], v[8:11]
    ds_read_b64_tr_b16 v[124:125], v85 offset:55360
    ds_read_b64_tr_b16 v[126:127], v85 offset:56640
    buffer_load_dwordx4 a[108:111], v253, s[8:11], s98 offen sc1
    s_addk_i32 s98, 4096
    v_mfma_f32_16x16x32_bf16 v[12:15], v[172:175], a[76:79], v[12:15]
    ds_read_b64_tr_b16 v[128:129], v85 offset:55392
    ds_read_b64_tr_b16 v[130:131], v85 offset:56672
    v_mfma_f32_16x16x32_bf16 v[16:19], v[176:179], a[76:79], v[16:19]
    ds_read_b64_tr_b16 v[132:133], v85 offset:55424
    ds_read_b64_tr_b16 v[134:135], v85 offset:56704
    s_waitcnt vmcnt(21) lgkmcnt(10)
    v_mfma_f32_16x16x32_bf16 v[0:3], v[96:99], a[80:83], v[0:3]
    ds_read_b64_tr_b16 v[160:161], v84 offset:46080
    ds_read_b64_tr_b16 v[162:163], v84 offset:47360
    v_mfma_f32_16x16x32_bf16 v[4:7], v[100:103], a[80:83], v[4:7]
    ds_read_b64_tr_b16 v[164:165], v84 offset:46112
    ds_read_b64_tr_b16 v[166:167], v84 offset:47392
    v_mfma_f32_16x16x32_bf16 v[8:11], v[104:107], a[80:83], v[8:11]
    ds_read_b64_tr_b16 v[168:169], v84 offset:46144
    ds_read_b64_tr_b16 v[170:171], v84 offset:47424
    buffer_load_dwordx4 a[112:115], v253, s[8:11], s98 offen sc1
    s_addk_i32 s98, 4096
    v_mfma_f32_16x16x32_bf16 v[12:15], v[108:111], a[80:83], v[12:15]
    ds_read_b64_tr_b16 v[172:173], v84 offset:46176
    ds_read_b64_tr_b16 v[174:175], v84 offset:47456
    v_mfma_f32_16x16x32_bf16 v[16:19], v[112:115], a[80:83], v[16:19]
    ds_read_b64_tr_b16 v[176:177], v84 offset:46208
    ds_read_b64_tr_b16 v[178:179], v84 offset:47488
    s_waitcnt vmcnt(21) lgkmcnt(10)
    v_mfma_f32_16x16x32_bf16 v[0:3], v[116:119], a[84:87], v[0:3]
    ds_read_b64_tr_b16 v[96:97], v84 offset:51200
    ds_read_b64_tr_b16 v[98:99], v84 offset:52480
    v_mfma_f32_16x16x32_bf16 v[4:7], v[120:123], a[84:87], v[4:7]
    ds_read_b64_tr_b16 v[100:101], v84 offset:51232
    ds_read_b64_tr_b16 v[102:103], v84 offset:52512
    v_mfma_f32_16x16x32_bf16 v[8:11], v[124:127], a[84:87], v[8:11]
    ds_read_b64_tr_b16 v[104:105], v84 offset:51264
    ds_read_b64_tr_b16 v[106:107], v84 offset:52544
    buffer_load_dwordx4 a[116:119], v253, s[8:11], s98 offen sc1
    s_cmp_gt_u32 s57, 3
    s_cselect_b32 s98, 3, 4
    s_lshl_b32 s98, s98, 14
    v_mfma_f32_16x16x32_bf16 v[12:15], v[128:131], a[84:87], v[12:15]
    ds_read_b64_tr_b16 v[108:109], v84 offset:51296
    ds_read_b64_tr_b16 v[110:111], v84 offset:52576
    v_mfma_f32_16x16x32_bf16 v[16:19], v[132:135], a[84:87], v[16:19]
    ds_read_b64_tr_b16 v[112:113], v84 offset:51328
    ds_read_b64_tr_b16 v[114:115], v84 offset:52608
    s_waitcnt vmcnt(21) lgkmcnt(10)
    v_mfma_f32_16x16x32_bf16 v[0:3], v[160:163], a[88:91], v[0:3]
    ds_read_b64_tr_b16 v[116:117], v84 offset:56320
    ds_read_b64_tr_b16 v[118:119], v84 offset:57600
    v_mfma_f32_16x16x32_bf16 v[4:7], v[164:167], a[88:91], v[4:7]
    ds_read_b64_tr_b16 v[120:121], v84 offset:56352
    ds_read_b64_tr_b16 v[122:123], v84 offset:57632
    v_mfma_f32_16x16x32_bf16 v[8:11], v[168:171], a[88:91], v[8:11]
    ds_read_b64_tr_b16 v[124:125], v84 offset:56384
    ds_read_b64_tr_b16 v[126:127], v84 offset:57664
    buffer_load_dwordx4 a[120:123], v253, s[8:11], s98 offen sc1
    s_addk_i32 s98, 4096
    v_mfma_f32_16x16x32_bf16 v[12:15], v[172:175], a[88:91], v[12:15]
    ds_read_b64_tr_b16 v[128:129], v84 offset:56416
    ds_read_b64_tr_b16 v[130:131], v84 offset:57696
    v_mfma_f32_16x16x32_bf16 v[16:19], v[176:179], a[88:91], v[16:19]
    ds_read_b64_tr_b16 v[132:133], v84 offset:56448
    ds_read_b64_tr_b16 v[134:135], v84 offset:57728
    s_waitcnt vmcnt(21) lgkmcnt(10)
    v_mfma_f32_16x16x32_bf16 v[0:3], v[96:99], a[92:95], v[0:3]
    ds_read_b64_tr_b16 v[160:161], v86 offset:3072
    ds_read_b64_tr_b16 v[162:163], v86 offset:4352
    v_mfma_f32_16x16x32_bf16 v[4:7], v[100:103], a[92:95], v[4:7]
    ds_read_b64_tr_b16 v[164:165], v86 offset:3104
    ds_read_b64_tr_b16 v[166:167], v86 offset:4384
    v_mfma_f32_16x16x32_bf16 v[8:11], v[104:107], a[92:95], v[8:11]
    ds_read_b64_tr_b16 v[168:169], v86 offset:3136
    ds_read_b64_tr_b16 v[170:171], v86 offset:4416
    buffer_load_dwordx4 a[124:127], v253, s[8:11], s98 offen sc1
    s_addk_i32 s98, 4096
    v_mfma_f32_16x16x32_bf16 v[12:15], v[108:111], a[92:95], v[12:15]
    ds_read_b64_tr_b16 v[172:173], v86 offset:3168
    ds_read_b64_tr_b16 v[174:175], v86 offset:4448
    v_mfma_f32_16x16x32_bf16 v[16:19], v[112:115], a[92:95], v[16:19]
    ds_read_b64_tr_b16 v[176:177], v86 offset:3200
    ds_read_b64_tr_b16 v[178:179], v86 offset:4480
    s_waitcnt vmcnt(21) lgkmcnt(10)
    v_mfma_f32_16x16x32_bf16 v[0:3], v[116:119], a[96:99], v[0:3]
    ds_read_b64_tr_b16 v[96:97], v86 offset:8192
    ds_read_b64_tr_b16 v[98:99], v86 offset:9472
    v_mfma_f32_16x16x32_bf16 v[4:7], v[120:123], a[96:99], v[4:7]
    ds_read_b64_tr_b16 v[100:101], v86 offset:8224
    ds_read_b64_tr_b16 v[102:103], v86 offset:9504
    v_mfma_f32_16x16x32_bf16 v[8:11], v[124:127], a[96:99], v[8:11]
    ds_read_b64_tr_b16 v[104:105], v86 offset:8256
    ds_read_b64_tr_b16 v[106:107], v86 offset:9536
    buffer_load_dwordx4 a[128:131], v253, s[8:11], s98 offen sc1
    s_add_u32 s98, s98, 4096
    v_mfma_f32_16x16x32_bf16 v[12:15], v[128:131], a[96:99], v[12:15]
    ds_read_b64_tr_b16 v[108:109], v86 offset:8288
    ds_read_b64_tr_b16 v[110:111], v86 offset:9568
    v_mfma_f32_16x16x32_bf16 v[16:19], v[132:135], a[96:99], v[16:19]
    ds_read_b64_tr_b16 v[112:113], v86 offset:8320
    ds_read_b64_tr_b16 v[114:115], v86 offset:9600
    s_waitcnt vmcnt(21) lgkmcnt(10)
    v_mfma_f32_16x16x32_bf16 v[0:3], v[160:163], a[100:103], v[0:3]
    ds_read_b64_tr_b16 v[116:117], v86 offset:13312
    ds_read_b64_tr_b16 v[118:119], v86 offset:14592
    v_mfma_f32_16x16x32_bf16 v[4:7], v[164:167], a[100:103], v[4:7]
    ds_read_b64_tr_b16 v[120:121], v86 offset:13344
    ds_read_b64_tr_b16 v[122:123], v86 offset:14624
    v_mfma_f32_16x16x32_bf16 v[8:11], v[168:171], a[100:103], v[8:11]
    ds_read_b64_tr_b16 v[124:125], v86 offset:13376
    ds_read_b64_tr_b16 v[126:127], v86 offset:14656
    buffer_load_dwordx4 a[132:135], v253, s[8:11], s98 offen sc1
    s_cmp_gt_u32 s57, 4
    s_cselect_b32 s98, 4, 5
    s_lshl_b32 s98, s98, 14
    v_mfma_f32_16x16x32_bf16 v[12:15], v[172:175], a[100:103], v[12:15]
    ds_read_b64_tr_b16 v[128:129], v86 offset:13408
    ds_read_b64_tr_b16 v[130:131], v86 offset:14688
    v_mfma_f32_16x16x32_bf16 v[16:19], v[176:179], a[100:103], v[16:19]
    ds_read_b64_tr_b16 v[132:133], v86 offset:13440
    ds_read_b64_tr_b16 v[134:135], v86 offset:14720
    s_waitcnt vmcnt(7)
    s_add_u32 s3, s47, 288
    s_lshl_b32 s63, s3, 8
    s_add_u32 s63, s63, 262144
    v_mov_b32_e64 v155, s63
    v_mov_b32 v156, 1
    s_mov_b64 exec, 1
    global_atomic_add v155, v156, s[90:91] sc1
    s_mov_b64 exec, -1
    global_load_dword v154, v153, s[90:91] sc1
    s_waitcnt lgkmcnt(10)
    v_mfma_f32_16x16x32_bf16 v[0:3], v[96:99], a[104:107], v[0:3]
    ds_read_b64_tr_b16 v[160:161], v86 offset:18432
    ds_read_b64_tr_b16 v[162:163], v86 offset:19712
    v_mfma_f32_16x16x32_bf16 v[4:7], v[100:103], a[104:107], v[4:7]
    ds_read_b64_tr_b16 v[164:165], v86 offset:18464
    ds_read_b64_tr_b16 v[166:167], v86 offset:19744
    v_mfma_f32_16x16x32_bf16 v[8:11], v[104:107], a[104:107], v[8:11]
    ds_read_b64_tr_b16 v[168:169], v86 offset:18496
    ds_read_b64_tr_b16 v[170:171], v86 offset:19776
    buffer_load_dwordx4 a[136:139], v253, s[8:11], s98 offen sc1
    s_addk_i32 s98, 4096
    v_mfma_f32_16x16x32_bf16 v[12:15], v[108:111], a[104:107], v[12:15]
    ds_read_b64_tr_b16 v[172:173], v86 offset:18528
    ds_read_b64_tr_b16 v[174:175], v86 offset:19808
    v_mfma_f32_16x16x32_bf16 v[16:19], v[112:115], a[104:107], v[16:19]
    ds_read_b64_tr_b16 v[176:177], v86 offset:18560
    ds_read_b64_tr_b16 v[178:179], v86 offset:19840
    s_waitcnt vmcnt(9) lgkmcnt(10)
    v_mfma_f32_16x16x32_bf16 v[0:3], v[116:119], a[108:111], v[0:3]
    ds_read_b64_tr_b16 v[96:97], v86 offset:23552
    ds_read_b64_tr_b16 v[98:99], v86 offset:24832
    v_mfma_f32_16x16x32_bf16 v[4:7], v[120:123], a[108:111], v[4:7]
    ds_read_b64_tr_b16 v[100:101], v86 offset:23584
    ds_read_b64_tr_b16 v[102:103], v86 offset:24864
    v_mfma_f32_16x16x32_bf16 v[8:11], v[124:127], a[108:111], v[8:11]
    ds_read_b64_tr_b16 v[104:105], v86 offset:23616
    ds_read_b64_tr_b16 v[106:107], v86 offset:24896
    buffer_load_dwordx4 a[140:143], v253, s[8:11], s98 offen sc1
    s_addk_i32 s98, 4096
    v_mfma_f32_16x16x32_bf16 v[12:15], v[128:131], a[108:111], v[12:15]
    ds_read_b64_tr_b16 v[108:109], v86 offset:23648
    ds_read_b64_tr_b16 v[110:111], v86 offset:24928
    v_mfma_f32_16x16x32_bf16 v[16:19], v[132:135], a[108:111], v[16:19]
    ds_read_b64_tr_b16 v[112:113], v86 offset:23680
    ds_read_b64_tr_b16 v[114:115], v86 offset:24960
    s_waitcnt vmcnt(9) lgkmcnt(10)
    v_mfma_f32_16x16x32_bf16 v[0:3], v[160:163], a[112:115], v[0:3]
    ds_read_b64_tr_b16 v[116:117], v86 offset:28672
    ds_read_b64_tr_b16 v[118:119], v86 offset:29952
    v_mfma_f32_16x16x32_bf16 v[4:7], v[164:167], a[112:115], v[4:7]
    ds_read_b64_tr_b16 v[120:121], v86 offset:28704
    ds_read_b64_tr_b16 v[122:123], v86 offset:29984
    v_mfma_f32_16x16x32_bf16 v[8:11], v[168:171], a[112:115], v[8:11]
    ds_read_b64_tr_b16 v[124:125], v86 offset:28736
    ds_read_b64_tr_b16 v[126:127], v86 offset:30016
    buffer_load_dwordx4 a[144:147], v253, s[8:11], s98 offen sc1
    s_addk_i32 s98, 4096
    v_mfma_f32_16x16x32_bf16 v[12:15], v[172:175], a[112:115], v[12:15]
    ds_read_b64_tr_b16 v[128:129], v86 offset:28768
    ds_read_b64_tr_b16 v[130:131], v86 offset:30048
    v_mfma_f32_16x16x32_bf16 v[16:19], v[176:179], a[112:115], v[16:19]
    ds_read_b64_tr_b16 v[132:133], v86 offset:28800
    ds_read_b64_tr_b16 v[134:135], v86 offset:30080
    s_waitcnt vmcnt(9) lgkmcnt(10)
    v_mfma_f32_16x16x32_bf16 v[0:3], v[96:99], a[116:119], v[0:3]
    ds_read_b64_tr_b16 v[160:161], v86 offset:33792
    ds_read_b64_tr_b16 v[162:163], v86 offset:35072
    v_mfma_f32_16x16x32_bf16 v[4:7], v[100:103], a[116:119], v[4:7]
    ds_read_b64_tr_b16 v[164:165], v86 offset:33824
    ds_read_b64_tr_b16 v[166:167], v86 offset:35104
    v_mfma_f32_16x16x32_bf16 v[8:11], v[104:107], a[116:119], v[8:11]
    ds_read_b64_tr_b16 v[168:169], v86 offset:33856
    ds_read_b64_tr_b16 v[170:171], v86 offset:35136
    buffer_load_dwordx4 a[148:151], v253, s[8:11], s98 offen sc1
    s_cmp_gt_u32 s57, 5
    s_cselect_b32 s98, 5, 6
    s_lshl_b32 s98, s98, 14
    v_mfma_f32_16x16x32_bf16 v[12:15], v[108:111], a[116:119], v[12:15]
    ds_read_b64_tr_b16 v[172:173], v86 offset:33888
    ds_read_b64_tr_b16 v[174:175], v86 offset:35168
    v_mfma_f32_16x16x32_bf16 v[16:19], v[112:115], a[116:119], v[16:19]
    ds_read_b64_tr_b16 v[176:177], v86 offset:33920
    ds_read_b64_tr_b16 v[178:179], v86 offset:35200
    s_waitcnt vmcnt(9) lgkmcnt(10)
    v_mfma_f32_16x16x32_bf16 v[0:3], v[116:119], a[120:123], v[0:3]
    ds_read_b64_tr_b16 v[96:97], v86 offset:38912
    ds_read_b64_tr_b16 v[98:99], v86 offset:40192
    v_mfma_f32_16x16x32_bf16 v[4:7], v[120:123], a[120:123], v[4:7]
    ds_read_b64_tr_b16 v[100:101], v86 offset:38944
    ds_read_b64_tr_b16 v[102:103], v86 offset:40224
    v_mfma_f32_16x16x32_bf16 v[8:11], v[124:127], a[120:123], v[8:11]
    ds_read_b64_tr_b16 v[104:105], v86 offset:38976
    ds_read_b64_tr_b16 v[106:107], v86 offset:40256
    buffer_load_dwordx4 a[152:155], v253, s[8:11], s98 offen sc1
    s_addk_i32 s98, 4096
    v_mfma_f32_16x16x32_bf16 v[12:15], v[128:131], a[120:123], v[12:15]
    ds_read_b64_tr_b16 v[108:109], v86 offset:39008
    ds_read_b64_tr_b16 v[110:111], v86 offset:40288
    v_mfma_f32_16x16x32_bf16 v[16:19], v[132:135], a[120:123], v[16:19]
    ds_read_b64_tr_b16 v[112:113], v86 offset:39040
    ds_read_b64_tr_b16 v[114:115], v86 offset:40320
    s_waitcnt vmcnt(9) lgkmcnt(10)
    v_mfma_f32_16x16x32_bf16 v[0:3], v[160:163], a[124:127], v[0:3]
    ds_read_b64_tr_b16 v[116:117], v86 offset:44032
    ds_read_b64_tr_b16 v[118:119], v86 offset:45312
    v_mfma_f32_16x16x32_bf16 v[4:7], v[164:167], a[124:127], v[4:7]
    ds_read_b64_tr_b16 v[120:121], v86 offset:44064
    ds_read_b64_tr_b16 v[122:123], v86 offset:45344
    v_mfma_f32_16x16x32_bf16 v[8:11], v[168:171], a[124:127], v[8:11]
    ds_read_b64_tr_b16 v[124:125], v86 offset:44096
    ds_read_b64_tr_b16 v[126:127], v86 offset:45376
    buffer_load_dwordx4 a[156:159], v253, s[8:11], s98 offen sc1
    s_addk_i32 s98, 4096
    v_mfma_f32_16x16x32_bf16 v[12:15], v[172:175], a[124:127], v[12:15]
    ds_read_b64_tr_b16 v[128:129], v86 offset:44128
    ds_read_b64_tr_b16 v[130:131], v86 offset:45408
    v_mfma_f32_16x16x32_bf16 v[16:19], v[176:179], a[124:127], v[16:19]
    ds_read_b64_tr_b16 v[132:133], v86 offset:44160
    ds_read_b64_tr_b16 v[134:135], v86 offset:45440
    s_waitcnt vmcnt(9) lgkmcnt(10)
    v_mfma_f32_16x16x32_bf16 v[0:3], v[96:99], a[128:131], v[0:3]
    ds_read_b64_tr_b16 v[160:161], v84 offset:0
    ds_read_b64_tr_b16 v[162:163], v84 offset:1280
    v_mfma_f32_16x16x32_bf16 v[4:7], v[100:103], a[128:131], v[4:7]
    ds_read_b64_tr_b16 v[164:165], v84 offset:32
    ds_read_b64_tr_b16 v[166:167], v84 offset:1312
    v_mfma_f32_16x16x32_bf16 v[8:11], v[104:107], a[128:131], v[8:11]
    ds_read_b64_tr_b16 v[168:169], v84 offset:64
    ds_read_b64_tr_b16 v[170:171], v84 offset:1344
    buffer_load_dwordx4 a[0:3], v253, s[8:11], s98 offen sc1
    s_addk_i32 s98, 4096
    v_mfma_f32_16x16x32_bf16 v[12:15], v[108:111], a[128:131], v[12:15]
    ds_read_b64_tr_b16 v[172:173], v84 offset:96
    ds_read_b64_tr_b16 v[174:175], v84 offset:1376
    v_mfma_f32_16x16x32_bf16 v[16:19], v[112:115], a[128:131], v[16:19]
    ds_read_b64_tr_b16 v[176:177], v84 offset:128
    ds_read_b64_tr_b16 v[178:179], v84 offset:1408
    s_waitcnt vmcnt(9) lgkmcnt(10)
    v_mfma_f32_16x16x32_bf16 v[0:3], v[116:119], a[132:135], v[0:3]
    ds_read_b64_tr_b16 v[96:97], v84 offset:5120
    ds_read_b64_tr_b16 v[98:99], v84 offset:6400
    v_mfma_f32_16x16x32_bf16 v[4:7], v[120:123], a[132:135], v[4:7]
    ds_read_b64_tr_b16 v[100:101], v84 offset:5152
    ds_read_b64_tr_b16 v[102:103], v84 offset:6432
    v_mfma_f32_16x16x32_bf16 v[8:11], v[124:127], a[132:135], v[8:11]
    ds_read_b64_tr_b16 v[104:105], v84 offset:5184
    ds_read_b64_tr_b16 v[106:107], v84 offset:6464
    buffer_load_dwordx4 a[4:7], v253, s[8:11], s98 offen sc1
    s_cmp_gt_u32 s57, 6
    s_cselect_b32 s98, 6, 7
    s_lshl_b32 s98, s98, 14
    v_mfma_f32_16x16x32_bf16 v[12:15], v[128:131], a[132:135], v[12:15]
    ds_read_b64_tr_b16 v[108:109], v84 offset:5216
    ds_read_b64_tr_b16 v[110:111], v84 offset:6496
    v_mfma_f32_16x16x32_bf16 v[16:19], v[132:135], a[132:135], v[16:19]
    ds_read_b64_tr_b16 v[112:113], v84 offset:5248
    ds_read_b64_tr_b16 v[114:115], v84 offset:6528
    s_waitcnt vmcnt(7) lgkmcnt(10)
    v_mfma_f32_16x16x32_bf16 v[0:3], v[160:163], a[136:139], v[0:3]
    ds_read_b64_tr_b16 v[116:117], v84 offset:10240
    ds_read_b64_tr_b16 v[118:119], v84 offset:11520
    v_mfma_f32_16x16x32_bf16 v[4:7], v[164:167], a[136:139], v[4:7]
    ds_read_b64_tr_b16 v[120:121], v84 offset:10272
    ds_read_b64_tr_b16 v[122:123], v84 offset:11552
    v_mfma_f32_16x16x32_bf16 v[8:11], v[168:171], a[136:139], v[8:11]
    ds_read_b64_tr_b16 v[124:125], v84 offset:10304
    ds_read_b64_tr_b16 v[126:127], v84 offset:11584
    buffer_load_dwordx4 a[8:11], v253, s[8:11], s98 offen sc1
    s_addk_i32 s98, 4096
    v_mfma_f32_16x16x32_bf16 v[12:15], v[172:175], a[136:139], v[12:15]
    ds_read_b64_tr_b16 v[128:129], v84 offset:10336
    ds_read_b64_tr_b16 v[130:131], v84 offset:11616
    v_mfma_f32_16x16x32_bf16 v[16:19], v[176:179], a[136:139], v[16:19]
    ds_read_b64_tr_b16 v[132:133], v84 offset:10368
    ds_read_b64_tr_b16 v[134:135], v84 offset:11648
    s_waitcnt vmcnt(7) lgkmcnt(10)
    v_mfma_f32_16x16x32_bf16 v[0:3], v[96:99], a[140:143], v[0:3]
    ds_read_b64_tr_b16 v[160:161], v84 offset:15360
    ds_read_b64_tr_b16 v[162:163], v84 offset:16640
    v_mfma_f32_16x16x32_bf16 v[4:7], v[100:103], a[140:143], v[4:7]
    ds_read_b64_tr_b16 v[164:165], v84 offset:15392
    ds_read_b64_tr_b16 v[166:167], v84 offset:16672
    v_mfma_f32_16x16x32_bf16 v[8:11], v[104:107], a[140:143], v[8:11]
    ds_read_b64_tr_b16 v[168:169], v84 offset:15424
    ds_read_b64_tr_b16 v[170:171], v84 offset:16704
    buffer_load_dwordx4 a[12:15], v253, s[8:11], s98 offen sc1
    s_addk_i32 s98, 4096
    v_mfma_f32_16x16x32_bf16 v[12:15], v[108:111], a[140:143], v[12:15]
    ds_read_b64_tr_b16 v[172:173], v84 offset:15456
    ds_read_b64_tr_b16 v[174:175], v84 offset:16736
    v_mfma_f32_16x16x32_bf16 v[16:19], v[112:115], a[140:143], v[16:19]
    ds_read_b64_tr_b16 v[176:177], v84 offset:15488
    ds_read_b64_tr_b16 v[178:179], v84 offset:16768
    s_waitcnt vmcnt(7) lgkmcnt(10)
    v_mfma_f32_16x16x32_bf16 v[0:3], v[116:119], a[144:147], v[0:3]
    ds_read_b64_tr_b16 v[96:97], v85 offset:4096
    ds_read_b64_tr_b16 v[98:99], v85 offset:5376
    v_mfma_f32_16x16x32_bf16 v[4:7], v[120:123], a[144:147], v[4:7]
    ds_read_b64_tr_b16 v[100:101], v85 offset:4128
    ds_read_b64_tr_b16 v[102:103], v85 offset:5408
    v_mfma_f32_16x16x32_bf16 v[8:11], v[124:127], a[144:147], v[8:11]
    ds_read_b64_tr_b16 v[104:105], v85 offset:4160
    ds_read_b64_tr_b16 v[106:107], v85 offset:5440
    buffer_load_dwordx4 a[16:19], v253, s[8:11], s98 offen sc1
    s_add_u32 s98, s98, 4096
    v_mfma_f32_16x16x32_bf16 v[12:15], v[128:131], a[144:147], v[12:15]
    ds_read_b64_tr_b16 v[108:109], v85 offset:4192
    ds_read_b64_tr_b16 v[110:111], v85 offset:5472
    v_mfma_f32_16x16x32_bf16 v[16:19], v[132:135], a[144:147], v[16:19]
    ds_read_b64_tr_b16 v[112:113], v85 offset:4224
    ds_read_b64_tr_b16 v[114:115], v85 offset:5504
    s_waitcnt vmcnt(7) lgkmcnt(10)
    v_mfma_f32_16x16x32_bf16 v[0:3], v[160:163], a[148:151], v[0:3]
    ds_read_b64_tr_b16 v[116:117], v85 offset:9216
    ds_read_b64_tr_b16 v[118:119], v85 offset:10496
    v_mfma_f32_16x16x32_bf16 v[4:7], v[164:167], a[148:151], v[4:7]
    ds_read_b64_tr_b16 v[120:121], v85 offset:9248
    ds_read_b64_tr_b16 v[122:123], v85 offset:10528
    v_mfma_f32_16x16x32_bf16 v[8:11], v[168:171], a[148:151], v[8:11]
    ds_read_b64_tr_b16 v[124:125], v85 offset:9280
    ds_read_b64_tr_b16 v[126:127], v85 offset:10560
    buffer_load_dwordx4 a[20:23], v253, s[8:11], s98 offen sc1
    s_cmp_gt_u32 s57, 7
    s_cselect_b32 s98, 7, 8
    s_lshl_b32 s98, s98, 14
    v_mfma_f32_16x16x32_bf16 v[12:15], v[172:175], a[148:151], v[12:15]
    ds_read_b64_tr_b16 v[128:129], v85 offset:9312
    ds_read_b64_tr_b16 v[130:131], v85 offset:10592
    v_mfma_f32_16x16x32_bf16 v[16:19], v[176:179], a[148:151], v[16:19]
    ds_read_b64_tr_b16 v[132:133], v85 offset:9344
    ds_read_b64_tr_b16 v[134:135], v85 offset:10624
    global_load_dword v156, v155, s[90:91] sc1
    s_waitcnt vmcnt(8) lgkmcnt(10)
    v_mfma_f32_16x16x32_bf16 v[0:3], v[96:99], a[152:155], v[0:3]
    ds_read_b64_tr_b16 v[160:161], v85 offset:14336
    ds_read_b64_tr_b16 v[162:163], v85 offset:15616
    v_mfma_f32_16x16x32_bf16 v[4:7], v[100:103], a[152:155], v[4:7]
    ds_read_b64_tr_b16 v[164:165], v85 offset:14368
    ds_read_b64_tr_b16 v[166:167], v85 offset:15648
    v_mfma_f32_16x16x32_bf16 v[8:11], v[104:107], a[152:155], v[8:11]
    ds_read_b64_tr_b16 v[168:169], v85 offset:14400
    ds_read_b64_tr_b16 v[170:171], v85 offset:15680
    v_mfma_f32_16x16x32_bf16 v[12:15], v[108:111], a[152:155], v[12:15]
    ds_read_b64_tr_b16 v[172:173], v85 offset:14432
    ds_read_b64_tr_b16 v[174:175], v85 offset:15712
    v_mfma_f32_16x16x32_bf16 v[16:19], v[112:115], a[152:155], v[16:19]
    ds_read_b64_tr_b16 v[176:177], v85 offset:14464
    ds_read_b64_tr_b16 v[178:179], v85 offset:15744
    s_waitcnt vmcnt(7) lgkmcnt(10)
    v_mfma_f32_16x16x32_bf16 v[0:3], v[116:119], a[156:159], v[0:3]
    ds_read_b64_tr_b16 v[96:97], v85 offset:19456
    ds_read_b64_tr_b16 v[98:99], v85 offset:20736
    v_mfma_f32_16x16x32_bf16 v[4:7], v[120:123], a[156:159], v[4:7]
    ds_read_b64_tr_b16 v[100:101], v85 offset:19488
    ds_read_b64_tr_b16 v[102:103], v85 offset:20768
    v_mfma_f32_16x16x32_bf16 v[8:11], v[124:127], a[156:159], v[8:11]
    ds_read_b64_tr_b16 v[104:105], v85 offset:19520
    ds_read_b64_tr_b16 v[106:107], v85 offset:20800
    v_mfma_f32_16x16x32_bf16 v[12:15], v[128:131], a[156:159], v[12:15]
    ds_read_b64_tr_b16 v[108:109], v85 offset:19552
    ds_read_b64_tr_b16 v[110:111], v85 offset:20832
    v_mfma_f32_16x16x32_bf16 v[16:19], v[132:135], a[156:159], v[16:19]
    ds_read_b64_tr_b16 v[112:113], v85 offset:19584
    ds_read_b64_tr_b16 v[114:115], v85 offset:20864
    s_waitcnt vmcnt(6) lgkmcnt(10)
    v_mfma_f32_16x16x32_bf16 v[0:3], v[160:163], a[0:3], v[0:3]
    ds_read_b64_tr_b16 v[116:117], v85 offset:24576
    ds_read_b64_tr_b16 v[118:119], v85 offset:25856
    v_mfma_f32_16x16x32_bf16 v[4:7], v[164:167], a[0:3], v[4:7]
    ds_read_b64_tr_b16 v[120:121], v85 offset:24608
    ds_read_b64_tr_b16 v[122:123], v85 offset:25888
    v_mfma_f32_16x16x32_bf16 v[8:11], v[168:171], a[0:3], v[8:11]
    ds_read_b64_tr_b16 v[124:125], v85 offset:24640
    ds_read_b64_tr_b16 v[126:127], v85 offset:25920
    v_mfma_f32_16x16x32_bf16 v[12:15], v[172:175], a[0:3], v[12:15]
    ds_read_b64_tr_b16 v[128:129], v85 offset:24672
    ds_read_b64_tr_b16 v[130:131], v85 offset:25952
    v_mfma_f32_16x16x32_bf16 v[16:19], v[176:179], a[0:3], v[16:19]
    ds_read_b64_tr_b16 v[132:133], v85 offset:24704
    ds_read_b64_tr_b16 v[134:135], v85 offset:25984
    s_waitcnt vmcnt(5) lgkmcnt(10)
    v_mfma_f32_16x16x32_bf16 v[0:3], v[96:99], a[4:7], v[0:3]
    ds_read_b64_tr_b16 v[160:161], v85 offset:29696
    ds_read_b64_tr_b16 v[162:163], v85 offset:30976
    v_mfma_f32_16x16x32_bf16 v[4:7], v[100:103], a[4:7], v[4:7]
    ds_read_b64_tr_b16 v[164:165], v85 offset:29728
    ds_read_b64_tr_b16 v[166:167], v85 offset:31008
    v_mfma_f32_16x16x32_bf16 v[8:11], v[104:107], a[4:7], v[8:11]
    ds_read_b64_tr_b16 v[168:169], v85 offset:29760
    ds_read_b64_tr_b16 v[170:171], v85 offset:31040
    v_mfma_f32_16x16x32_bf16 v[12:15], v[108:111], a[4:7], v[12:15]
    ds_read_b64_tr_b16 v[172:173], v85 offset:29792
    ds_read_b64_tr_b16 v[174:175], v85 offset:31072
    v_mfma_f32_16x16x32_bf16 v[16:19], v[112:115], a[4:7], v[16:19]
    ds_read_b64_tr_b16 v[176:177], v85 offset:29824
    ds_read_b64_tr_b16 v[178:179], v85 offset:31104
    s_mul_i32 s13, s50, 7680
    s_add_u32 s14, s13, 2560
    s_add_u32 s15, s13, 5120
    s_waitcnt vmcnt(0)
    v_cmp_gt_u32_e64 vcc, 4, v156
    s_nop 4
    s_cbranch_vccz L_ck3
    s_mov_b32 s94, 0
L_poll4:
    global_load_dword v156, v155, s[90:91] sc1
    s_add_u32 s94, s94, 1
    s_waitcnt vmcnt(0)
    v_cmp_gt_u32 vcc, 4, v156
    s_cmp_gt_u32 s94, 65536
    s_cbranch_scc1 L_pdone4
    s_nop 2
    s_cbranch_vccz L_pdone4
    s_sleep 4
    s_branch L_poll4
L_pdone4:
L_ck3:
    buffer_load_dwordx4 v[42:45], v253, s[52:55], s13 offen sc1
    buffer_load_dwordx4 v[46:49], v253, s[52:55], s13 offen offset:1024 sc1
    buffer_load_dwordx2 v[50:51], v92, s[52:55], s13 offen offset:2048 sc1
    buffer_load_dwordx4 v[52:55], v253, s[52:55], s14 offen sc1
    buffer_load_dwordx4 v[56:59], v253, s[52:55], s14 offen offset:1024 sc1
    buffer_load_dwordx2 v[60:61], v92, s[52:55], s14 offen offset:2048 sc1
    buffer_load_dwordx4 v[62:65], v253, s[52:55], s15 offen sc1
    buffer_load_dwordx4 v[66:69], v253, s[52:55], s15 offen offset:1024 sc1
    buffer_load_dwordx2 v[70:71], v92, s[52:55], s15 offen offset:2048 sc1
    s_waitcnt lgkmcnt(10)
    v_mfma_f32_16x16x32_bf16 v[0:3], v[116:119], a[8:11], v[0:3]
    ds_read_b64_tr_b16 v[96:97], v85 offset:34816
    ds_read_b64_tr_b16 v[98:99], v85 offset:36096
    v_mfma_f32_16x16x32_bf16 v[4:7], v[120:123], a[8:11], v[4:7]
    ds_read_b64_tr_b16 v[100:101], v85 offset:34848
    ds_read_b64_tr_b16 v[102:103], v85 offset:36128
    v_mfma_f32_16x16x32_bf16 v[8:11], v[124:127], a[8:11], v[8:11]
    ds_read_b64_tr_b16 v[104:105], v85 offset:34880
    ds_read_b64_tr_b16 v[106:107], v85 offset:36160
    v_mfma_f32_16x16x32_bf16 v[12:15], v[128:131], a[8:11], v[12:15]
    ds_read_b64_tr_b16 v[108:109], v85 offset:34912
    ds_read_b64_tr_b16 v[110:111], v85 offset:36192
    v_mfma_f32_16x16x32_bf16 v[16:19], v[132:135], a[8:11], v[16:19]
    ds_read_b64_tr_b16 v[112:113], v85 offset:34944
    ds_read_b64_tr_b16 v[114:115], v85 offset:36224
    s_waitcnt lgkmcnt(10)
    v_mfma_f32_16x16x32_bf16 v[0:3], v[160:163], a[12:15], v[0:3]
    ds_read_b64_tr_b16 v[116:117], v84 offset:20480
    ds_read_b64_tr_b16 v[118:119], v84 offset:21760
    v_mfma_f32_16x16x32_bf16 v[4:7], v[164:167], a[12:15], v[4:7]
    ds_read_b64_tr_b16 v[120:121], v84 offset:20512
    ds_read_b64_tr_b16 v[122:123], v84 offset:21792
    v_mfma_f32_16x16x32_bf16 v[8:11], v[168:171], a[12:15], v[8:11]
    ds_read_b64_tr_b16 v[124:125], v84 offset:20544
    ds_read_b64_tr_b16 v[126:127], v84 offset:21824
    v_mfma_f32_16x16x32_bf16 v[12:15], v[172:175], a[12:15], v[12:15]
    ds_read_b64_tr_b16 v[128:129], v84 offset:20576
    ds_read_b64_tr_b16 v[130:131], v84 offset:21856
    v_mfma_f32_16x16x32_bf16 v[16:19], v[176:179], a[12:15], v[16:19]
    ds_read_b64_tr_b16 v[132:133], v84 offset:20608
    ds_read_b64_tr_b16 v[134:135], v84 offset:21888
    s_waitcnt lgkmcnt(10)
    v_mfma_f32_16x16x32_bf16 v[0:3], v[96:99], a[16:19], v[0:3]
    v_mfma_f32_16x16x32_bf16 v[4:7], v[100:103], a[16:19], v[4:7]
    v_mfma_f32_16x16x32_bf16 v[8:11], v[104:107], a[16:19], v[8:11]
    v_mfma_f32_16x16x32_bf16 v[12:15], v[108:111], a[16:19], v[12:15]
    v_mfma_f32_16x16x32_bf16 v[16:19], v[112:115], a[16:19], v[16:19]
    s_waitcnt lgkmcnt(0)
    v_mfma_f32_16x16x32_bf16 v[0:3], v[116:119], a[20:23], v[0:3]
    v_mfma_f32_16x16x32_bf16 v[4:7], v[120:123], a[20:23], v[4:7]
    v_mfma_f32_16x16x32_bf16 v[8:11], v[124:127], a[20:23], v[8:11]
    v_mfma_f32_16x16x32_bf16 v[12:15], v[128:131], a[20:23], v[12:15]
    v_mfma_f32_16x16x32_bf16 v[16:19], v[132:135], a[20:23], v[16:19]
    v_cmp_gt_u32 vcc, 32, v154
    s_nop 4
    s_cbranch_vccz L_ck4
    s_mov_b32 s94, 0
L_poll5:
    global_load_dword v154, v153, s[90:91] sc1
    s_add_u32 s94, s94, 1
    s_waitcnt vmcnt(0)
    v_cmp_gt_u32_e64 vcc, 32, v154
    s_cmp_gt_u32 s94, 65536
    s_cbranch_scc1 L_pdone5
    s_nop 2
    s_cbranch_vccz L_pdone5
    s_sleep 4
    s_branch L_poll5
L_pdone5:
L_ck4:
    s_barrier
    s_add_u32 s8, s90, 4194304
    s_addc_u32 s9, s91, 0
    s_mov_b32 s10, 2621440
    s_mov_b32 s11, 0x00020000
    s_add_u32 s16, s90, 65536
    s_addc_u32 s17, s91, 0
    s_mov_b32 s18, 131072
    s_mov_b32 s19, 0x00020000
    v_lshrrev_b32_e64 v88, 5, v251
    v_mul_u32_u24 v88, 40960, v88
    v_and_b32_e64 v89, 31, v251
    v_lshl_add_u32 v88, v89, 4, v88
    v_lshrrev_b32_e64 v89, 1, v252
    v_lshl_add_u32 v88, v89, 9, v88
    v_and_b32_e64 v89, 1, v252
    v_lshl_add_u32 v90, v89, 10, v88
    v_lshl_add_u32 v88, v89, 3, v88
    v_lshlrev_b32_e64 v91, 3, v251
    s_mul_i32 s12, s57, 5120
    s_add_u32 s98, s12, 4096
    s_lshl_b32 s99, s57, 14
    s_lshl_b32 s3, s56, 2
    s_add_u32 s3, s3, s60
    s_lshl_b32 s3, s3, 1
    s_lshr_b32 s61, s50, 1
    s_add_u32 s3, s3, s61
    s_add_u32 s4, s3, 160
    s_mov_b32 s100, 0x00003f80
    s_mov_b32 s101, 0x3f800000
    s_mov_b32 s3, 0x3f803f80
    s_add_u32 m0, s34, 0
    s_nop 0
    buffer_load_dwordx4 v253, s[20:23], s33 offen offset:0 sc1 lds
    buffer_load_dwordx4 v253, s[20:23], s33 offen offset:1024 sc1 lds
    buffer_load_dwordx4 v253, s[20:23], s33 offen offset:2048 sc1 lds
    buffer_load_dwordx4 v253, s[20:23], s33 offen offset:3072 sc1 lds
    s_add_u32 m0, s34, 4096
    s_nop 0
    buffer_load_dwordx4 v254, s[20:23], s33 offen offset:0 sc1 lds
    buffer_load_dwordx4 v254, s[20:23], s33 offen offset:1024 sc1 lds
    buffer_load_dwordx4 v254, s[20:23], s33 offen offset:2048 sc1 lds
    s_add_u32 s33, s33, 442368
    v_accvgpr_read_b32 v160, a200
    v_accvgpr_read_b32 v161, a201
    v_accvgpr_read_b32 v162, a202
    v_accvgpr_read_b32 v163, a203
    v_accvgpr_read_b32 v164, a204
    v_accvgpr_read_b32 v165, a205
    v_accvgpr_read_b32 v166, a206
    v_accvgpr_read_b32 v167, a207
    v_accvgpr_read_b32 v168, a208
    v_accvgpr_read_b32 v169, a209
    v_accvgpr_read_b32 v170, a210
    v_accvgpr_read_b32 v171, a211
    v_accvgpr_read_b32 v172, a212
    v_accvgpr_read_b32 v173, a213
    v_accvgpr_read_b32 v174, a214
    v_accvgpr_read_b32 v175, a215
    v_accvgpr_read_b32 v176, a216
    v_accvgpr_read_b32 v177, a217
    v_accvgpr_read_b32 v178, a218
    v_accvgpr_read_b32 v179, a219
    s_waitcnt vmcnt(13)
    v_dot2_f32_bf16 v0, v42, s100, v0
    v_dot2_f32_bf16 v1, v42, s101, v1
    v_dot2_f32_bf16 v2, v43, s100, v2
    v_dot2_f32_bf16 v3, v43, s101, v3
    v_dot2_f32_bf16 v4, v44, s100, v4
    v_dot2_f32_bf16 v5, v44, s101, v5
    v_dot2_f32_bf16 v6, v45, s100, v6
    v_dot2_f32_bf16 v7, v45, s101, v7
    v_dot2_f32_bf16 v8, v46, s100, v8
    v_dot2_f32_bf16 v9, v46, s101, v9
    v_dot2_f32_bf16 v10, v47, s100, v10
    v_dot2_f32_bf16 v11, v47, s101, v11
    v_dot2_f32_bf16 v12, v48, s100, v12
    v_dot2_f32_bf16 v13, v48, s101, v13
    v_dot2_f32_bf16 v14, v49, s100, v14
    v_dot2_f32_bf16 v15, v49, s101, v15
    v_dot2_f32_bf16 v16, v50, s100, v16
    v_dot2_f32_bf16 v17, v50, s101, v17
    v_dot2_f32_bf16 v18, v51, s100, v18
    v_dot2_f32_bf16 v19, v51, s101, v19
    s_waitcnt vmcnt(10)
    v_dot2_f32_bf16 v0, v52, s100, v0
    v_dot2_f32_bf16 v1, v52, s101, v1
    v_dot2_f32_bf16 v2, v53, s100, v2
    v_dot2_f32_bf16 v3, v53, s101, v3
    v_dot2_f32_bf16 v4, v54, s100, v4
    v_dot2_f32_bf16 v5, v54, s101, v5
    v_dot2_f32_bf16 v6, v55, s100, v6
    v_dot2_f32_bf16 v7, v55, s101, v7
    v_dot2_f32_bf16 v8, v56, s100, v8
    v_dot2_f32_bf16 v9, v56, s101, v9
    v_dot2_f32_bf16 v10, v57, s100, v10
    v_dot2_f32_bf16 v11, v57, s101, v11
    v_dot2_f32_bf16 v12, v58, s100, v12
    v_dot2_f32_bf16 v13, v58, s101, v13
    v_dot2_f32_bf16 v14, v59, s100, v14
    v_dot2_f32_bf16 v15, v59, s101, v15
    v_dot2_f32_bf16 v16, v60, s100, v16
    v_dot2_f32_bf16 v17, v60, s101, v17
    v_dot2_f32_bf16 v18, v61, s100, v18
    v_dot2_f32_bf16 v19, v61, s101, v19
    s_waitcnt vmcnt(7)
    v_dot2_f32_bf16 v0, v62, s100, v0
    v_dot2_f32_bf16 v1, v62, s101, v1
    v_dot2_f32_bf16 v2, v63, s100, v2
    v_dot2_f32_bf16 v3, v63, s101, v3
    v_dot2_f32_bf16 v4, v64, s100, v4
    v_dot2_f32_bf16 v5, v64, s101, v5
    v_dot2_f32_bf16 v6, v65, s100, v6
    v_dot2_f32_bf16 v7, v65, s101, v7
    v_dot2_f32_bf16 v8, v66, s100, v8
    v_dot2_f32_bf16 v9, v66, s101, v9
    v_dot2_f32_bf16 v10, v67, s100, v10
    v_dot2_f32_bf16 v11, v67, s101, v11
    v_dot2_f32_bf16 v12, v68, s100, v12
    v_dot2_f32_bf16 v13, v68, s101, v13
    v_dot2_f32_bf16 v14, v69, s100, v14
    v_dot2_f32_bf16 v15, v69, s101, v15
    v_dot2_f32_bf16 v16, v70, s100, v16
    v_dot2_f32_bf16 v17, v70, s101, v17
    v_dot2_f32_bf16 v18, v71, s100, v18
    v_dot2_f32_bf16 v19, v71, s101, v19
    v_lshlrev_b32 v40, 16, v240
    v_and_b32 v41, 0xffff0000, v240
    v_pk_fma_f32 v[40:41], v[160:161], v[0:1], v[40:41]
    v_cvt_pk_bf16_f32 v240, v40, v41
    v_lshlrev_b32_e64 v40, 16, v241
    v_and_b32 v41, 0xffff0000, v241
    v_pk_fma_f32 v[40:41], v[162:163], v[2:3], v[40:41]
    v_cvt_pk_bf16_f32 v241, v40, v41
    v_lshlrev_b32_e64 v40, 16, v242
    v_and_b32 v41, 0xffff0000, v242
    v_pk_fma_f32 v[40:41], v[164:165], v[4:5], v[40:41]
    v_cvt_pk_bf16_f32 v242, v40, v41
    v_lshlrev_b32_e64 v40, 16, v243
    v_and_b32 v41, 0xffff0000, v243
    v_pk_fma_f32 v[40:41], v[166:167], v[6:7], v[40:41]
    v_cvt_pk_bf16_f32 v243, v40, v41
    v_lshlrev_b32_e64 v40, 16, v244
    v_and_b32 v41, 0xffff0000, v244
    v_pk_fma_f32 v[40:41], v[168:169], v[8:9], v[40:41]
    v_cvt_pk_bf16_f32 v244, v40, v41
    v_lshlrev_b32_e64 v40, 16, v245
    v_and_b32 v41, 0xffff0000, v245
    v_pk_fma_f32 v[40:41], v[170:171], v[10:11], v[40:41]
    v_cvt_pk_bf16_f32 v245, v40, v41
    v_lshlrev_b32_e64 v40, 16, v246
    v_and_b32 v41, 0xffff0000, v246
    v_pk_fma_f32 v[40:41], v[172:173], v[12:13], v[40:41]
    v_cvt_pk_bf16_f32 v246, v40, v41
    v_lshlrev_b32_e64 v40, 16, v247
    v_and_b32 v41, 0xffff0000, v247
    v_pk_fma_f32 v[40:41], v[174:175], v[14:15], v[40:41]
    v_cvt_pk_bf16_f32 v247, v40, v41
    v_lshlrev_b32_e64 v40, 16, v248
    v_and_b32 v41, 0xffff0000, v248
    v_pk_fma_f32 v[40:41], v[176:177], v[16:17], v[40:41]
    v_cvt_pk_bf16_f32 v248, v40, v41
    v_lshlrev_b32_e64 v40, 16, v249
    v_and_b32 v41, 0xffff0000, v249
    v_pk_fma_f32 v[40:41], v[178:179], v[18:19], v[40:41]
    v_cvt_pk_bf16_f32 v249, v40, v41
    v_mov_b32 v20, v240
    v_mov_b32 v21, v241
    v_mov_b32 v22, v242
    v_mov_b32 v23, v243
    v_mov_b32 v24, v244
    v_mov_b32 v25, v245
    v_mov_b32 v26, v246
    v_mov_b32 v27, v247
    v_mov_b32 v28, v248
    v_mov_b32 v29, v249
    v_mov_b32 v46, 0
    v_mov_b32 v47, 0
    v_permlane16_swap_b32 v20, v22
    v_permlane16_swap_b32 v21, v23
    v_permlane16_swap_b32 v24, v26
    v_permlane16_swap_b32 v25, v27
    buffer_store_dwordx4 v[20:23], v90, s[8:11], s12 offen sc1
    buffer_store_dwordx4 v[24:27], v90, s[8:11], s12 offen offset:2048 sc1
    buffer_store_dwordx2 v[28:29], v88, s[8:11], s98 offen sc1
    v_dot2_f32_bf16 v46, v240, s3, v46
    v_dot2_f32_bf16 v47, v240, v240, v47
    v_dot2_f32_bf16 v46, v241, s3, v46
    v_dot2_f32_bf16 v47, v241, v241, v47
    v_dot2_f32_bf16 v46, v242, s3, v46
    v_dot2_f32_bf16 v47, v242, v242, v47
    v_dot2_f32_bf16 v46, v243, s3, v46
    v_dot2_f32_bf16 v47, v243, v243, v47
    v_dot2_f32_bf16 v46, v244, s3, v46
    v_dot2_f32_bf16 v47, v244, v244, v47
    v_dot2_f32_bf16 v46, v245, s3, v46
    v_dot2_f32_bf16 v47, v245, v245, v47
    v_dot2_f32_bf16 v46, v246, s3, v46
    v_dot2_f32_bf16 v47, v246, v246, v47
    v_dot2_f32_bf16 v46, v247, s3, v46
    v_dot2_f32_bf16 v47, v247, v247, v47
    v_dot2_f32_bf16 v46, v248, s3, v46
    v_dot2_f32_bf16 v47, v248, v248, v47
    v_dot2_f32_bf16 v46, v249, s3, v46
    v_dot2_f32_bf16 v47, v249, v249, v47
    s_nop 1
    v_mov_b32 v48, v46
    v_mov_b32 v49, v47
    s_nop 0
    v_permlane16_swap_b32 v46, v48
    v_permlane16_swap_b32 v47, v49
    v_add_f32 v46, v46, v48
    v_add_f32 v47, v47, v49
    v_mov_b32 v48, v46
    v_mov_b32 v49, v47
    s_nop 0
    v_permlane32_swap_b32 v46, v48
    v_permlane32_swap_b32 v47, v49
    v_add_f32 v46, v46, v48
    v_add_f32_e64 v47, v47, v49
    s_mov_b64 exec, 0xffff
    buffer_store_dwordx2 v[46:47], v91, s[16:19], s99 offen sc1
    s_mov_b64 exec, -1
    s_waitcnt vmcnt(0)
    s_lshl_b32 s63, s4, 8
    s_add_u32 s63, s63, 262144
    v_mov_b32 v0, s63
    v_mov_b32 v1, 1
    s_mov_b64 exec, 1
    global_atomic_add v0, v1, s[90:91] sc1
    s_mov_b64 exec, -1
    s_barrier
    s_add_u32 m0, s34, 28672
    s_nop 0
    buffer_load_dwordx4 v253, s[20:23], s33 offen offset:0 sc1 lds
    buffer_load_dwordx4 v253, s[20:23], s33 offen offset:1024 sc1 lds
    buffer_load_dwordx4 v253, s[20:23], s33 offen offset:2048 sc1 lds
    buffer_load_dwordx4 v253, s[20:23], s33 offen offset:3072 sc1 lds
    s_add_u32 m0, s34, 32768
    s_nop 0
    buffer_load_dwordx4 v254, s[20:23], s33 offen offset:0 sc1 lds
    buffer_load_dwordx4 v254, s[20:23], s33 offen offset:1024 sc1 lds
    buffer_load_dwordx4 v254, s[20:23], s33 offen offset:2048 sc1 lds
    s_add_u32 s33, s33, 442368
    s_add_u32 m0, s34, 57344
    s_nop 0
    buffer_load_dwordx4 v253, s[20:23], s33 offen offset:0 sc1 lds
    buffer_load_dwordx4 v253, s[20:23], s33 offen offset:1024 sc1 lds
    buffer_load_dwordx4 v253, s[20:23], s33 offen offset:2048 sc1 lds
    buffer_load_dwordx4 v253, s[20:23], s33 offen offset:3072 sc1 lds
    s_add_u32 m0, s34, 61440
    s_nop 0
    buffer_load_dwordx4 v254, s[20:23], s33 offen offset:0 sc1 lds
    buffer_load_dwordx4 v254, s[20:23], s33 offen offset:1024 sc1 lds
    buffer_load_dwordx4 v254, s[20:23], s33 offen offset:2048 sc1 lds
    s_add_u32 s33, s33, 442368
    s_add_u32 m0, s34, 86016
    s_nop 0
    buffer_load_dwordx4 v253, s[20:23], s33 offen offset:0 sc1 lds
    buffer_load_dwordx4 v253, s[20:23], s33 offen offset:1024 sc1 lds
    buffer_load_dwordx4 v253, s[20:23], s33 offen offset:2048 sc1 lds
    buffer_load_dwordx4 v253, s[20:23], s33 offen offset:3072 sc1 lds
    s_add_u32 m0, s34, 90112
    s_nop 0
    buffer_load_dwordx4 v254, s[20:23], s33 offen offset:0 sc1 lds
    buffer_load_dwordx4 v254, s[20:23], s33 offen offset:1024 sc1 lds
    buffer_load_dwordx4 v254, s[20:23], s33 offen offset:2048 sc1 lds
    s_add_u32 s33, s33, 442368
    s_add_u32 m0, s34, 114688
    s_nop 0
    buffer_load_dwordx4 v253, s[20:23], s33 offen offset:0 sc1 lds
    buffer_load_dwordx4 v253, s[20:23], s33 offen offset:1024 sc1 lds
    buffer_load_dwordx4 v253, s[20:23], s33 offen offset:2048 sc1 lds
    buffer_load_dwordx4 v253, s[20:23], s33 offen offset:3072 sc1 lds
    s_add_u32 m0, s34, 118784
    s_nop 0
    buffer_load_dwordx4 v254, s[20:23], s33 offen offset:0 sc1 lds
    buffer_load_dwordx4 v254, s[20:23], s33 offen offset:1024 sc1 lds
    buffer_load_dwordx4 v254, s[20:23], s33 offen offset:2048 sc1 lds
    s_add_u32 s33, s33, 442368
    v_mbcnt_lo_u32_b32 v115, -1, 0
    v_mbcnt_hi_u32_b32 v115, -1, v115
    v_mov_b32_e64 v112, v253
    v_add_u32 v113, 57344, v253
    v_add_u32 v114, 114688, v253
    s_add_u32 s8, s90, 65536
    s_addc_u32 s9, s91, 0
    s_mov_b32 s10, 131072
    s_mov_b32 s11, 0x00020000
    s_lshl_b32 s61, s35, 8
    s_add_u32 s62, s61, 303104
    v_mov_b32 v136, s62
    v_and_b32 v138, 31, v115
    v_lshlrev_b32 v138, 3, v138
    v_lshrrev_b32 v140, 2, v253
    ds_read_b128 a[40:43], v112 offset:0
    ds_read_b128 a[44:47], v112 offset:1024
    ds_read_b128 a[48:51], v112 offset:2048
    ds_read_b128 a[52:55], v112 offset:3072
    ds_read_b128 a[56:59], v112 offset:4096
    ds_read_b128 a[60:63], v112 offset:5120
    ds_read_b128 a[64:67], v112 offset:6144
    s_mov_b32 s94, 0
L_poll6:
    global_load_dword v137, v136, s[90:91] sc1
    s_add_u32 s94, s94, 1
    s_waitcnt vmcnt(0)
    v_cmp_gt_u32_e64 vcc, 16, v137
    s_cmp_gt_u32 s94, 65536
    s_cbranch_scc1 L_pdone6
    s_nop 2
    s_cbranch_vccz L_pdone6
    s_sleep 4
    s_branch L_poll6
L_pdone6:
    buffer_load_dwordx4 a[0:3], v253, s[24:27], s36 offen offset:0 sc1
    buffer_load_dwordx4 a[4:7], v253, s[24:27], s36 offen offset:1024 sc1
    buffer_load_dwordx4 a[8:11], v253, s[24:27], s36 offen offset:2048 sc1
    buffer_load_dwordx4 a[12:15], v253, s[24:27], s36 offen offset:3072 sc1
    s_add_u32 s36, s36, 4096
    buffer_load_dwordx4 a[16:19], v253, s[24:27], s36 offen offset:0 sc1
    buffer_load_dwordx4 a[20:23], v253, s[24:27], s36 offen offset:1024 sc1
    buffer_load_dwordx4 a[24:27], v253, s[24:27], s36 offen offset:2048 sc1
    buffer_load_dwordx4 a[28:31], v253, s[24:27], s36 offen offset:3072 sc1
    s_addk_i32 s36, 4096
    buffer_load_dwordx4 a[32:35], v253, s[24:27], s36 offen offset:0 sc1
    s_waitcnt vmcnt(8) lgkmcnt(0)
    v_mfma_f32_32x32x16_bf16 v[0:15], a[40:43], a[0:3], 0
    ds_read_b128 a[68:71], v112 offset:7168
    ds_read_b128 a[72:75], v112 offset:8192
    buffer_load_dwordx4 a[36:39], v253, s[24:27], s36 offen offset:1024 sc1
    v_mfma_f32_32x32x16_bf16 v[16:31], a[44:47], a[0:3], 0
    ds_read_b128 a[76:79], v112 offset:9216
    ds_read_b128 a[80:83], v112 offset:10240
    buffer_load_dwordx2 v[116:117], v138, s[8:11], s61 offen sc1
    s_add_u32 s61, s61, 16384
    v_mfma_f32_32x32x16_bf16 v[32:47], a[48:51], a[0:3], 0
    buffer_load_dwordx2 v[118:119], v138, s[8:11], s61 offen sc1
    s_add_u32 s61, s61, 16384
    v_mfma_f32_32x32x16_bf16 v[48:63], a[52:55], a[0:3], 0
    ds_read_b128 a[84:87], v112 offset:11264
    ds_read_b128 a[88:91], v112 offset:12288
    v_mfma_f32_32x32x16_bf16 v[64:79], a[56:59], a[0:3], 0
    ds_read_b128 a[92:95], v112 offset:13312
    buffer_load_dwordx2 v[120:121], v138, s[8:11], s61 offen sc1
    s_addk_i32 s61, 16384
    v_mfma_f32_32x32x16_bf16 v[80:95], a[60:63], a[0:3], 0
    buffer_load_dwordx2 v[122:123], v138, s[8:11], s61 offen sc1
    v_mfma_f32_32x32x16_bf16 v[96:111], a[64:67], a[0:3], 0
    s_waitcnt vmcnt(12) lgkmcnt(3)
    v_mfma_f32_32x32x16_bf16 v[0:15], a[68:71], a[4:7], v[0:15]
    ds_read_b128 a[40:43], v112 offset:14336
    ds_read_b128 a[44:47], v112 offset:15360
    buffer_load_dwordx4 a[0:3], v253, s[24:27], s36 offen offset:2048 sc1
    s_add_u32 s61, s61, 16384
    v_mfma_f32_32x32x16_bf16 v[16:31], a[72:75], a[4:7], v[16:31]
    ds_read_b128 a[48:51], v112 offset:16384
    ds_read_b128 a[52:55], v112 offset:17408
    buffer_load_dwordx2 v[124:125], v138, s[8:11], s61 offen sc1
    s_addk_i32 s61, 16384
    v_mfma_f32_32x32x16_bf16 v[32:47], a[76:79], a[4:7], v[32:47]
    s_waitcnt lgkmcnt(4)
    buffer_load_dwordx2 v[126:127], v138, s[8:11], s61 offen sc1
    s_add_u32 s61, s61, 16384
    v_mfma_f32_32x32x16_bf16 v[48:63], a[80:83], a[4:7], v[48:63]
    ds_read_b128 a[56:59], v112 offset:18432
    ds_read_b128 a[60:63], v112 offset:19456
    v_mfma_f32_32x32x16_bf16 v[64:79], a[84:87], a[4:7], v[64:79]
    ds_read_b128 a[64:67], v112 offset:20480
    buffer_load_dwordx2 v[128:129], v138, s[8:11], s61 offen sc1
    s_add_u32 s61, s61, 16384
    v_mfma_f32_32x32x16_bf16 v[80:95], a[88:91], a[4:7], v[80:95]
    buffer_load_dwordx2 v[130:131], v138, s[8:11], s61 offen sc1
    v_mfma_f32_32x32x16_bf16 v[96:111], a[92:95], a[4:7], v[96:111]
    s_waitcnt vmcnt(16) lgkmcnt(3)
    v_mfma_f32_32x32x16_bf16 v[0:15], a[40:43], a[8:11], v[0:15]
    ds_read_b128 a[68:71], v112 offset:21504
    ds_read_b128 a[72:75], v112 offset:22528
    v_mfma_f32_32x32x16_bf16 v[16:31], a[44:47], a[8:11], v[16:31]
    ds_read_b128 a[76:79], v112 offset:23552
    ds_read_b128 a[80:83], v112 offset:24576
    v_mfma_f32_32x32x16_bf16 v[32:47], a[48:51], a[8:11], v[32:47]
    s_waitcnt lgkmcnt(4)
    v_mfma_f32_32x32x16_bf16 v[48:63], a[52:55], a[8:11], v[48:63]
    ds_read_b128 a[84:87], v112 offset:25600
    ds_read_b128 a[88:91], v112 offset:26624
    v_mfma_f32_32x32x16_bf16 v[64:79], a[56:59], a[8:11], v[64:79]
    ds_read_b128 a[92:95], v112 offset:27648
    buffer_load_dwordx4 a[4:7], v253, s[24:27], s36 offen offset:3072 sc1
    s_add_u32 s36, s36, 4096
    v_mfma_f32_32x32x16_bf16 v[80:95], a[60:63], a[8:11], v[80:95]
    buffer_load_dwordx4 a[96:99], v253, s[40:43], s44 offen offset:0 sc1
    v_mfma_f32_32x32x16_bf16 v[96:111], a[64:67], a[8:11], v[96:111]
    buffer_load_dwordx4 a[100:103], v253, s[40:43], s44 offen offset:1024 sc1
    s_waitcnt vmcnt(18) lgkmcnt(3)
    v_mfma_f32_32x32x16_bf16 v[0:15], a[68:71], a[12:15], v[0:15]
    buffer_load_dwordx4 a[8:11], v253, s[24:27], s36 offen offset:0 sc1
    v_mfma_f32_32x32x16_bf16 v[16:31], a[72:75], a[12:15], v[16:31]
    s_waitcnt lgkmcnt(0)
    s_barrier
    v_mfma_f32_32x32x16_bf16 v[32:47], a[76:79], a[12:15], v[32:47]
    ds_read_b128 a[40:43], v112 offset:28672
    ds_read_b128 a[44:47], v112 offset:29696
    v_mfma_f32_32x32x16_bf16 v[48:63], a[80:83], a[12:15], v[48:63]
    ds_read_b128 a[48:51], v112 offset:30720
    ds_read_b128 a[52:55], v112 offset:31744
    v_mfma_f32_32x32x16_bf16 v[64:79], a[84:87], a[12:15], v[64:79]
    ds_read_b128 a[56:59], v112 offset:32768
    ds_read_b128 a[60:63], v112 offset:33792
    v_mfma_f32_32x32x16_bf16 v[80:95], a[88:91], a[12:15], v[80:95]
    ds_read_b128 a[64:67], v112 offset:34816
    buffer_load_dwordx4 a[104:107], v253, s[40:43], s44 offen offset:2048 sc1
    v_mfma_f32_32x32x16_bf16 v[96:111], a[92:95], a[12:15], v[96:111]
    s_waitcnt vmcnt(19) lgkmcnt(3)
    v_mfma_f32_32x32x16_bf16 v[0:15], a[40:43], a[16:19], v[0:15]
    ds_read_b128 a[68:71], v112 offset:35840
    ds_read_b128 a[72:75], v112 offset:36864
    v_mfma_f32_32x32x16_bf16 v[16:31], a[44:47], a[16:19], v[16:31]
    ds_read_b128 a[76:79], v112 offset:37888
    ds_read_b128 a[80:83], v112 offset:38912
    v_mfma_f32_32x32x16_bf16 v[32:47], a[48:51], a[16:19], v[32:47]
    s_waitcnt lgkmcnt(4)
    buffer_load_dwordx4 a[12:15], v253, s[24:27], s36 offen offset:1024 sc1
    s_add_u32 m0, s34, 0
    v_mfma_f32_32x32x16_bf16 v[48:63], a[52:55], a[16:19], v[48:63]
    ds_read_b128 a[84:87], v112 offset:39936
    ds_read_b128 a[88:91], v112 offset:40960
    v_mfma_f32_32x32x16_bf16 v[64:79], a[56:59], a[16:19], v[64:79]
    ds_read_b128 a[92:95], v112 offset:41984
    buffer_load_dwordx4 v253, s[20:23], s33 offen offset:0 sc1 lds
    v_mfma_f32_32x32x16_bf16 v[80:95], a[60:63], a[16:19], v[80:95]
    buffer_load_dwordx4 v253, s[20:23], s33 offen offset:1024 sc1 lds
    v_mfma_f32_32x32x16_bf16 v[96:111], a[64:67], a[16:19], v[96:111]
    buffer_load_dwordx4 v253, s[20:23], s33 offen offset:2048 sc1 lds
    s_waitcnt vmcnt(22) lgkmcnt(3)
    v_mfma_f32_32x32x16_bf16 v[0:15], a[68:71], a[20:23], v[0:15]
    ds_read_b128 a[40:43], v112 offset:43008
    ds_read_b128 a[44:47], v112 offset:44032
    v_mfma_f32_32x32x16_bf16 v[16:31], a[72:75], a[20:23], v[16:31]
    ds_read_b128 a[48:51], v112 offset:45056
    ds_read_b128 a[52:55], v112 offset:46080
    v_mfma_f32_32x32x16_bf16 v[32:47], a[76:79], a[20:23], v[32:47]
    s_waitcnt lgkmcnt(4)
    v_mfma_f32_32x32x16_bf16 v[48:63], a[80:83], a[20:23], v[48:63]
    ds_read_b128 a[56:59], v112 offset:47104
    ds_read_b128 a[60:63], v112 offset:48128
    v_mfma_f32_32x32x16_bf16 v[64:79], a[84:87], a[20:23], v[64:79]
    ds_read_b128 a[64:67], v112 offset:49152
    buffer_load_dwordx4 a[16:19], v253, s[24:27], s36 offen offset:2048 sc1
    v_mfma_f32_32x32x16_bf16 v[80:95], a[88:91], a[20:23], v[80:95]
    buffer_load_dwordx4 v253, s[20:23], s33 offen offset:3072 sc1 lds
    s_add_u32 m0, s34, 4096
    v_mfma_f32_32x32x16_bf16 v[96:111], a[92:95], a[20:23], v[96:111]
    buffer_load_dwordx4 v254, s[20:23], s33 offen offset:0 sc1 lds
    s_waitcnt vmcnt(24) lgkmcnt(3)
    v_mfma_f32_32x32x16_bf16 v[0:15], a[40:43], a[24:27], v[0:15]
    ds_read_b128 a[68:71], v112 offset:50176
    ds_read_b128 a[72:75], v112 offset:51200
    v_mfma_f32_32x32x16_bf16 v[16:31], a[44:47], a[24:27], v[16:31]
    ds_read_b128 a[76:79], v112 offset:52224
    ds_read_b128 a[80:83], v112 offset:53248
    v_mfma_f32_32x32x16_bf16 v[32:47], a[48:51], a[24:27], v[32:47]
    s_waitcnt lgkmcnt(4)
    v_mfma_f32_32x32x16_bf16 v[48:63], a[52:55], a[24:27], v[48:63]
    ds_read_b128 a[84:87], v112 offset:54272
    ds_read_b128 a[88:91], v112 offset:55296
    v_mfma_f32_32x32x16_bf16 v[64:79], a[56:59], a[24:27], v[64:79]
    ds_read_b128 a[92:95], v112 offset:56320
    buffer_load_dwordx4 a[20:23], v253, s[24:27], s36 offen offset:3072 sc1
    s_addk_i32 s36, 4096
    v_mfma_f32_32x32x16_bf16 v[80:95], a[60:63], a[24:27], v[80:95]
    buffer_load_dwordx4 v254, s[20:23], s33 offen offset:1024 sc1 lds
    v_mfma_f32_32x32x16_bf16 v[96:111], a[64:67], a[24:27], v[96:111]
    buffer_load_dwordx4 v254, s[20:23], s33 offen offset:2048 sc1 lds
    s_add_u32 s33, s33, 442368
    s_waitcnt vmcnt(26) lgkmcnt(3)
    v_mfma_f32_32x32x16_bf16 v[0:15], a[68:71], a[28:31], v[0:15]
    buffer_load_dwordx4 a[24:27], v253, s[24:27], s36 offen offset:0 sc1
    v_mfma_f32_32x32x16_bf16 v[16:31], a[72:75], a[28:31], v[16:31]
    s_waitcnt lgkmcnt(0)
    s_barrier
    v_mfma_f32_32x32x16_bf16 v[32:47], a[76:79], a[28:31], v[32:47]
    ds_read_b128 a[40:43], v113 offset:0
    ds_read_b128 a[44:47], v113 offset:1024
    v_mfma_f32_32x32x16_bf16 v[48:63], a[80:83], a[28:31], v[48:63]
    ds_read_b128 a[48:51], v113 offset:2048
    ds_read_b128 a[52:55], v113 offset:3072
    v_mfma_f32_32x32x16_bf16 v[64:79], a[84:87], a[28:31], v[64:79]
    ds_read_b128 a[56:59], v113 offset:4096
    ds_read_b128 a[60:63], v113 offset:5120
    v_mfma_f32_32x32x16_bf16 v[80:95], a[88:91], a[28:31], v[80:95]
    ds_read_b128 a[64:67], v113 offset:6144
    v_mfma_f32_32x32x16_bf16 v[96:111], a[92:95], a[28:31], v[96:111]
    s_waitcnt vmcnt(26) lgkmcnt(3)
    v_mfma_f32_32x32x16_bf16 v[0:15], a[40:43], a[32:35], v[0:15]
    ds_read_b128 a[68:71], v113 offset:7168
    ds_read_b128 a[72:75], v113 offset:8192
    v_mfma_f32_32x32x16_bf16 v[16:31], a[44:47], a[32:35], v[16:31]
    ds_read_b128 a[76:79], v113 offset:9216
    ds_read_b128 a[80:83], v113 offset:10240
    v_mfma_f32_32x32x16_bf16 v[32:47], a[48:51], a[32:35], v[32:47]
    s_waitcnt lgkmcnt(4)
    buffer_load_dwordx4 a[28:31], v253, s[24:27], s36 offen offset:1024 sc1
    s_add_u32 m0, s34, 28672
    v_mfma_f32_32x32x16_bf16 v[48:63], a[52:55], a[32:35], v[48:63]
    ds_read_b128 a[84:87], v113 offset:11264
    ds_read_b128 a[88:91], v113 offset:12288
    v_mfma_f32_32x32x16_bf16 v[64:79], a[56:59], a[32:35], v[64:79]
    ds_read_b128 a[92:95], v113 offset:13312
    buffer_load_dwordx4 v253, s[20:23], s33 offen offset:0 sc1 lds
    v_mfma_f32_32x32x16_bf16 v[80:95], a[60:63], a[32:35], v[80:95]
    buffer_load_dwordx4 v253, s[20:23], s33 offen offset:1024 sc1 lds
    v_mfma_f32_32x32x16_bf16 v[96:111], a[64:67], a[32:35], v[96:111]
    buffer_load_dwordx4 v253, s[20:23], s33 offen offset:2048 sc1 lds
    s_waitcnt vmcnt(29) lgkmcnt(3)
    v_mfma_f32_32x32x16_bf16 v[0:15], a[68:71], a[36:39], v[0:15]
    ds_read_b128 a[40:43], v113 offset:14336
    ds_read_b128 a[44:47], v113 offset:15360
    v_mfma_f32_32x32x16_bf16 v[16:31], a[72:75], a[36:39], v[16:31]
    ds_read_b128 a[48:51], v113 offset:16384
    ds_read_b128 a[52:55], v113 offset:17408
    v_mfma_f32_32x32x16_bf16 v[32:47], a[76:79], a[36:39], v[32:47]
    s_waitcnt lgkmcnt(4)
    v_mfma_f32_32x32x16_bf16 v[48:63], a[80:83], a[36:39], v[48:63]
    ds_read_b128 a[56:59], v113 offset:18432
    ds_read_b128 a[60:63], v113 offset:19456
    v_mfma_f32_32x32x16_bf16 v[64:79], a[84:87], a[36:39], v[64:79]
    ds_read_b128 a[64:67], v113 offset:20480
    buffer_load_dwordx4 a[32:35], v253, s[24:27], s36 offen offset:2048 sc1
    v_mfma_f32_32x32x16_bf16 v[80:95], a[88:91], a[36:39], v[80:95]
    buffer_load_dwordx4 v253, s[20:23], s33 offen offset:3072 sc1 lds
    s_add_u32 m0, s34, 32768
    v_mfma_f32_32x32x16_bf16 v[96:111], a[92:95], a[36:39], v[96:111]
    buffer_load_dwordx4 v254, s[20:23], s33 offen offset:0 sc1 lds
    s_waitcnt vmcnt(27) lgkmcnt(3)
    v_mfma_f32_32x32x16_bf16 v[0:15], a[40:43], a[0:3], v[0:15]
    ds_read_b128 a[68:71], v113 offset:21504
    ds_read_b128 a[72:75], v113 offset:22528
    v_mfma_f32_32x32x16_bf16 v[16:31], a[44:47], a[0:3], v[16:31]
    ds_read_b128 a[76:79], v113 offset:23552
    ds_read_b128 a[80:83], v113 offset:24576
    v_mfma_f32_32x32x16_bf16 v[32:47], a[48:51], a[0:3], v[32:47]
    s_waitcnt lgkmcnt(4)
    v_mfma_f32_32x32x16_bf16 v[48:63], a[52:55], a[0:3], v[48:63]
    ds_read_b128 a[84:87], v113 offset:25600
    ds_read_b128 a[88:91], v113 offset:26624
    v_mfma_f32_32x32x16_bf16 v[64:79], a[56:59], a[0:3], v[64:79]
    ds_read_b128 a[92:95], v113 offset:27648
    buffer_load_dwordx4 a[36:39], v253, s[24:27], s36 offen offset:3072 sc1
    s_addk_i32 s36, 4096
    v_mfma_f32_32x32x16_bf16 v[80:95], a[60:63], a[0:3], v[80:95]
    buffer_load_dwordx4 v254, s[20:23], s33 offen offset:1024 sc1 lds
    v_mfma_f32_32x32x16_bf16 v[96:111], a[64:67], a[0:3], v[96:111]
    buffer_load_dwordx4 v254, s[20:23], s33 offen offset:2048 sc1 lds
    s_add_u32 s33, s33, 442368
    s_waitcnt vmcnt(25) lgkmcnt(3)
    v_mfma_f32_32x32x16_bf16 v[0:15], a[68:71], a[4:7], v[0:15]
    buffer_load_dwordx4 a[0:3], v253, s[24:27], s36 offen offset:0 sc1
    v_mfma_f32_32x32x16_bf16 v[16:31], a[72:75], a[4:7], v[16:31]
    s_waitcnt lgkmcnt(0)
    s_barrier
    v_mfma_f32_32x32x16_bf16 v[32:47], a[76:79], a[4:7], v[32:47]
    ds_read_b128 a[40:43], v113 offset:28672
    ds_read_b128 a[44:47], v113 offset:29696
    v_mfma_f32_32x32x16_bf16 v[48:63], a[80:83], a[4:7], v[48:63]
    ds_read_b128 a[48:51], v113 offset:30720
    ds_read_b128 a[52:55], v113 offset:31744
    v_mfma_f32_32x32x16_bf16 v[64:79], a[84:87], a[4:7], v[64:79]
    ds_read_b128 a[56:59], v113 offset:32768
    ds_read_b128 a[60:63], v113 offset:33792
    v_mfma_f32_32x32x16_bf16 v[80:95], a[88:91], a[4:7], v[80:95]
    ds_read_b128 a[64:67], v113 offset:34816
    v_mfma_f32_32x32x16_bf16 v[96:111], a[92:95], a[4:7], v[96:111]
    s_waitcnt vmcnt(23) lgkmcnt(3)
    v_mfma_f32_32x32x16_bf16 v[0:15], a[40:43], a[8:11], v[0:15]
    ds_read_b128 a[68:71], v113 offset:35840
    ds_read_b128 a[72:75], v113 offset:36864
    v_add_f32 v136, v116, v118
    v_add_f32 v137, v117, v119
    v_add_f32 v136, v136, v120
    v_mfma_f32_32x32x16_bf16 v[16:31], a[44:47], a[8:11], v[16:31]
    ds_read_b128 a[76:79], v113 offset:37888
    ds_read_b128 a[80:83], v113 offset:38912
    v_add_f32 v137, v137, v121
    v_add_f32 v136, v136, v122
    v_add_f32 v137, v137, v123
    v_mfma_f32_32x32x16_bf16 v[32:47], a[48:51], a[8:11], v[32:47]
    s_waitcnt lgkmcnt(4)
    buffer_load_dwordx4 a[4:7], v253, s[24:27], s36 offen offset:1024 sc1
    s_add_u32 m0, s34, 57344
    v_add_f32 v136, v136, v124
    v_add_f32 v137, v137, v125
    v_mfma_f32_32x32x16_bf16 v[48:63], a[52:55], a[8:11], v[48:63]
    ds_read_b128 a[84:87], v113 offset:39936
    ds_read_b128 a[88:91], v113 offset:40960
    v_add_f32 v136, v136, v126
    v_add_f32 v137, v137, v127
    v_add_f32 v136, v136, v128
    v_add_f32 v137, v137, v129
    v_mfma_f32_32x32x16_bf16 v[64:79], a[56:59], a[8:11], v[64:79]
    ds_read_b128 a[92:95], v113 offset:41984
    buffer_load_dwordx4 v253, s[20:23], s33 offen offset:0 sc1 lds
    v_add_f32 v136, v136, v130
    v_add_f32 v137, v137, v131
    v_mul_f32 v136, 0x3acccccd, v136
    v_mfma_f32_32x32x16_bf16 v[80:95], a[60:63], a[8:11], v[80:95]
    buffer_load_dwordx4 v253, s[20:23], s33 offen offset:1024 sc1 lds
    v_mul_f32 v137, 0x3acccccd, v137
    v_fma_f32 v137, -v136, v136, v137
    v_max_f32 v137, 0, v137
    v_cvt_pk_bf16_f32 v137, v137, v137
    v_mfma_f32_32x32x16_bf16 v[96:111], a[64:67], a[8:11], v[96:111]
    buffer_load_dwordx4 v253, s[20:23], s33 offen offset:2048 sc1 lds
    s_waitcnt vmcnt(25) lgkmcnt(3)
    v_and_b32 v137, 0xffff0000, v137
    v_add_f32 v137, 0x3727c5ac, v137
    v_cvt_pk_bf16_f32 v137, v137, v137
    v_mfma_f32_32x32x16_bf16 v[0:15], a[68:71], a[12:15], v[0:15]
    ds_read_b128 a[40:43], v113 offset:43008
    ds_read_b128 a[44:47], v113 offset:44032
    v_and_b32 v137, 0xffff0000, v137
    v_sqrt_f32_e64 v137, v137
    v_mfma_f32_32x32x16_bf16 v[16:31], a[72:75], a[12:15], v[16:31]
    ds_read_b128 a[48:51], v113 offset:45056
    ds_read_b128 a[52:55], v113 offset:46080
    v_sub_f32_e64 v136, 0, v136
    v_cvt_pk_bf16_f32 v132, v136, v137
    v_mfma_f32_32x32x16_bf16 v[32:47], a[76:79], a[12:15], v[32:47]
    s_waitcnt lgkmcnt(4)
    v_mov_b32 v133, v132
    v_mov_b32 v134, v132
    v_mov_b32 v135, v132
    v_and_b32 v137, 0xffff0000, v132
    v_mfma_f32_32x32x16_bf16 v[48:63], a[80:83], a[12:15], v[48:63]
    ds_read_b128 a[56:59], v113 offset:47104
    ds_read_b128 a[60:63], v113 offset:48128
    v_rcp_f32 v137, v137
    v_and_b32 v138, 15, v115
    v_mfma_f32_32x32x16_bf16 v[64:79], a[84:87], a[12:15], v[64:79]
    ds_read_b128 a[64:67], v113 offset:49152
    buffer_load_dwordx4 a[8:11], v253, s[24:27], s36 offen offset:2048 sc1
    v_lshlrev_b32 v138, 4, v138
    v_mul_f32 v136, v137, v137
    v_mfma_f32_32x32x16_bf16 v[80:95], a[88:91], a[12:15], v[80:95]
    buffer_load_dwordx4 v253, s[20:23], s33 offen offset:3072 sc1 lds
    s_add_u32 m0, s34, 61440
    v_mul_f32_e64 v137, v137, v137
    v_bfe_u32 v139, v115, 4, 1
    v_mfma_f32_32x32x16_bf16 v[96:111], a[92:95], a[12:15], v[96:111]
    buffer_load_dwordx4 v254, s[20:23], s33 offen offset:0 sc1 lds
    s_waitcnt vmcnt(24) lgkmcnt(3)
    v_lshl_add_u32 v138, v139, 10, v138
    v_lshrrev_b32 v139, 5, v115
    v_lshl_add_u32 v138, v139, 8, v138
    v_mfma_f32_32x32x16_bf16 v[0:15], a[40:43], a[16:19], v[0:15]
    ds_read_b128 a[68:71], v113 offset:50176
    ds_read_b128 a[72:75], v113 offset:51200
    v_mfma_f32_32x32x16_bf16 v[16:31], a[44:47], a[16:19], v[16:31]
    ds_read_b128 a[76:79], v113 offset:52224
    ds_read_b128 a[80:83], v113 offset:53248
    v_mfma_f32_32x32x16_bf16 v[32:47], a[48:51], a[16:19], v[32:47]
    s_waitcnt lgkmcnt(4)
    v_mfma_f32_32x32x16_bf16 v[48:63], a[52:55], a[16:19], v[48:63]
    ds_read_b128 a[84:87], v113 offset:54272
    ds_read_b128 a[88:91], v113 offset:55296
    v_mfma_f32_32x32x16_bf16 v[64:79], a[56:59], a[16:19], v[64:79]
    ds_read_b128 a[92:95], v113 offset:56320
    buffer_load_dwordx4 a[12:15], v253, s[24:27], s36 offen offset:3072 sc1
    s_addk_i32 s36, 4096
    v_mfma_f32_32x32x16_bf16 v[80:95], a[60:63], a[16:19], v[80:95]
    buffer_load_dwordx4 v254, s[20:23], s33 offen offset:1024 sc1 lds
    v_mfma_f32_32x32x16_bf16 v[96:111], a[64:67], a[16:19], v[96:111]
    buffer_load_dwordx4 v254, s[20:23], s33 offen offset:2048 sc1 lds
    s_add_u32 s33, s33, 442368
    s_waitcnt vmcnt(24) lgkmcnt(3)
    v_mfma_f32_32x32x16_bf16 v[0:15], a[68:71], a[20:23], v[0:15]
    buffer_load_dwordx4 a[16:19], v253, s[24:27], s36 offen offset:0 sc1
    s_add_u32 s61, s32, 0
    s_lshr_b32 s62, s61, 1
    s_lshl_b32 s62, s62, 12
    v_mfma_f32_32x32x16_bf16 v[16:31], a[72:75], a[20:23], v[16:31]
    s_waitcnt lgkmcnt(0)
    s_barrier
    v_mfma_f32_32x32x16_bf16 v[32:47], a[76:79], a[20:23], v[32:47]
    ds_read_b128 a[40:43], v114 offset:0
    ds_read_b128 a[44:47], v114 offset:1024
    s_and_b32 s61, s61, 1
    s_lshl_b32 s61, s61, 9
    s_add_u32 s12, s61, s62
    v_mfma_f32_32x32x16_bf16 v[48:63], a[80:83], a[20:23], v[48:63]
    ds_read_b128 a[48:51], v114 offset:2048
    ds_read_b128 a[52:55], v114 offset:3072
    s_add_u32 s61, s32, 1
    s_lshr_b32 s62, s61, 1
    s_lshl_b32 s62, s62, 12
    v_mfma_f32_32x32x16_bf16 v[64:79], a[84:87], a[20:23], v[64:79]
    ds_read_b128 a[56:59], v114 offset:4096
    ds_read_b128 a[60:63], v114 offset:5120
    s_and_b32 s61, s61, 1
    s_lshl_b32 s61, s61, 9
    s_add_u32 s13, s61, s62
    v_mfma_f32_32x32x16_bf16 v[80:95], a[88:91], a[20:23], v[80:95]
    ds_read_b128 a[64:67], v114 offset:6144
    s_add_u32 s61, s32, 2
    s_lshr_b32 s62, s61, 1
    s_lshl_b32 s62, s62, 12
    s_and_b32 s61, s61, 1
    v_mfma_f32_32x32x16_bf16 v[96:111], a[92:95], a[20:23], v[96:111]
    s_waitcnt vmcnt(22) lgkmcnt(3)
    s_lshl_b32 s61, s61, 9
    s_add_u32 s14, s61, s62
    s_add_u32 s61, s32, 3
    s_lshr_b32 s62, s61, 1
    s_lshl_b32 s62, s62, 12
    v_mfma_f32_32x32x16_bf16 v[0:15], a[40:43], a[24:27], v[0:15]
    ds_read_b128 a[68:71], v114 offset:7168
    ds_read_b128 a[72:75], v114 offset:8192
    v_mfma_f32_32x32x16_bf16 v[16:31], a[44:47], a[24:27], v[16:31]
    ds_read_b128 a[76:79], v114 offset:9216
    ds_read_b128 a[80:83], v114 offset:10240
    v_mfma_f32_32x32x16_bf16 v[32:47], a[48:51], a[24:27], v[32:47]
    s_waitcnt lgkmcnt(4)
    buffer_load_dwordx4 a[20:23], v253, s[24:27], s36 offen offset:1024 sc1
    s_add_u32 m0, s34, 86016
    v_mfma_f32_32x32x16_bf16 v[48:63], a[52:55], a[24:27], v[48:63]
    ds_read_b128 a[84:87], v114 offset:11264
    ds_read_b128 a[88:91], v114 offset:12288
    v_mfma_f32_32x32x16_bf16 v[64:79], a[56:59], a[24:27], v[64:79]
    ds_read_b128 a[92:95], v114 offset:13312
    buffer_load_dwordx4 v253, s[20:23], s33 offen offset:0 sc1 lds
    v_mfma_f32_32x32x16_bf16 v[80:95], a[60:63], a[24:27], v[80:95]
    buffer_load_dwordx4 v253, s[20:23], s33 offen offset:1024 sc1 lds
    v_mfma_f32_32x32x16_bf16 v[96:111], a[64:67], a[24:27], v[96:111]
    buffer_load_dwordx4 v253, s[20:23], s33 offen offset:2048 sc1 lds
    s_waitcnt vmcnt(25) lgkmcnt(3)
    v_mfma_f32_32x32x16_bf16 v[0:15], a[68:71], a[28:31], v[0:15]
    ds_read_b128 a[40:43], v114 offset:14336
    ds_read_b128 a[44:47], v114 offset:15360
    v_mfma_f32_32x32x16_bf16 v[16:31], a[72:75], a[28:31], v[16:31]
    ds_read_b128 a[48:51], v114 offset:16384
    ds_read_b128 a[52:55], v114 offset:17408
    v_mfma_f32_32x32x16_bf16 v[32:47], a[76:79], a[28:31], v[32:47]
    s_waitcnt lgkmcnt(4)
    v_mfma_f32_32x32x16_bf16 v[48:63], a[80:83], a[28:31], v[48:63]
    ds_read_b128 a[56:59], v114 offset:18432
    ds_read_b128 a[60:63], v114 offset:19456
    v_mfma_f32_32x32x16_bf16 v[64:79], a[84:87], a[28:31], v[64:79]
    ds_read_b128 a[64:67], v114 offset:20480
    buffer_load_dwordx4 a[24:27], v253, s[24:27], s36 offen offset:2048 sc1
    v_mfma_f32_32x32x16_bf16 v[80:95], a[88:91], a[28:31], v[80:95]
    buffer_load_dwordx4 v253, s[20:23], s33 offen offset:3072 sc1 lds
    s_add_u32 m0, s34, 90112
    v_mfma_f32_32x32x16_bf16 v[96:111], a[92:95], a[28:31], v[96:111]
    buffer_load_dwordx4 v254, s[20:23], s33 offen offset:0 sc1 lds
    s_waitcnt vmcnt(24) lgkmcnt(3)
    v_mfma_f32_32x32x16_bf16 v[0:15], a[40:43], a[32:35], v[0:15]
    ds_read_b128 a[68:71], v114 offset:21504
    ds_read_b128 a[72:75], v114 offset:22528
    v_mfma_f32_32x32x16_bf16 v[16:31], a[44:47], a[32:35], v[16:31]
    ds_read_b128 a[76:79], v114 offset:23552
    ds_read_b128 a[80:83], v114 offset:24576
    v_mfma_f32_32x32x16_bf16 v[32:47], a[48:51], a[32:35], v[32:47]
    s_waitcnt lgkmcnt(4)
    v_mfma_f32_32x32x16_bf16 v[48:63], a[52:55], a[32:35], v[48:63]
    ds_read_b128 a[84:87], v114 offset:25600
    ds_read_b128 a[88:91], v114 offset:26624
    v_mfma_f32_32x32x16_bf16 v[64:79], a[56:59], a[32:35], v[64:79]
    ds_read_b128 a[92:95], v114 offset:27648
    buffer_load_dwordx4 a[28:31], v253, s[24:27], s36 offen offset:3072 sc1
    s_add_u32 s36, s36, 4096
    v_mfma_f32_32x32x16_bf16 v[80:95], a[60:63], a[32:35], v[80:95]
    buffer_load_dwordx4 v254, s[20:23], s33 offen offset:1024 sc1 lds
    v_mfma_f32_32x32x16_bf16 v[96:111], a[64:67], a[32:35], v[96:111]
    buffer_load_dwordx4 v254, s[20:23], s33 offen offset:2048 sc1 lds
    s_add_u32 s33, s33, 442368
    s_waitcnt vmcnt(24) lgkmcnt(3)
    v_mfma_f32_32x32x16_bf16 v[0:15], a[68:71], a[36:39], v[0:15]
    buffer_load_dwordx4 a[32:35], v253, s[24:27], s36 offen offset:0 sc1
    s_and_b32 s61, s61, 1
    s_lshl_b32 s61, s61, 9
    s_add_u32 s15, s61, s62
    v_mfma_f32_32x32x16_bf16 v[16:31], a[72:75], a[36:39], v[16:31]
    s_waitcnt lgkmcnt(0)
    s_barrier
    v_mfma_f32_32x32x16_bf16 v[32:47], a[76:79], a[36:39], v[32:47]
    ds_read_b128 a[40:43], v112 offset:0
    ds_read_b128 a[44:47], v112 offset:1024
    s_add_u32 s61, s32, 4
    s_lshr_b32 s62, s61, 1
    s_lshl_b32 s62, s62, 12
    v_mfma_f32_32x32x16_bf16 v[48:63], a[80:83], a[36:39], v[48:63]
    ds_read_b128 a[48:51], v112 offset:2048
    ds_read_b128 a[52:55], v112 offset:3072
    s_and_b32 s61, s61, 1
    s_lshl_b32 s61, s61, 9
    s_add_u32 s16, s61, s62
    v_mfma_f32_32x32x16_bf16 v[64:79], a[84:87], a[36:39], v[64:79]
    ds_read_b128 a[56:59], v112 offset:4096
    ds_read_b128 a[60:63], v112 offset:5120
    s_add_u32 s61, s32, 5
    s_lshr_b32 s62, s61, 1
    s_lshl_b32 s62, s62, 12
    v_mfma_f32_32x32x16_bf16 v[80:95], a[88:91], a[36:39], v[80:95]
    ds_read_b128 a[64:67], v112 offset:6144
    s_and_b32 s61, s61, 1
    s_lshl_b32 s61, s61, 9
    s_add_u32 s17, s61, s62
    s_add_u32 s61, s32, 6
    v_mfma_f32_32x32x16_bf16 v[96:111], a[92:95], a[36:39], v[96:111]
    s_waitcnt vmcnt(22) lgkmcnt(3)
    s_lshr_b32 s62, s61, 1
    s_lshl_b32 s62, s62, 12
    s_and_b32 s61, s61, 1
    s_lshl_b32 s61, s61, 9
    s_add_u32 s18, s61, s62
    v_mfma_f32_32x32x16_bf16 v[0:15], a[40:43], a[0:3], v[0:15]
    ds_read_b128 a[68:71], v112 offset:7168
    ds_read_b128 a[72:75], v112 offset:8192
    v_mfma_f32_32x32x16_bf16 v[16:31], a[44:47], a[0:3], v[16:31]
    ds_read_b128 a[76:79], v112 offset:9216
    ds_read_b128 a[80:83], v112 offset:10240
    v_mfma_f32_32x32x16_bf16 v[32:47], a[48:51], a[0:3], v[32:47]
    s_waitcnt lgkmcnt(4)
    buffer_load_dwordx4 a[36:39], v253, s[24:27], s36 offen offset:1024 sc1
    s_add_u32 m0, s34, 114688
    v_mfma_f32_32x32x16_bf16 v[48:63], a[52:55], a[0:3], v[48:63]
    ds_read_b128 a[84:87], v112 offset:11264
    ds_read_b128 a[88:91], v112 offset:12288
    v_mfma_f32_32x32x16_bf16 v[64:79], a[56:59], a[0:3], v[64:79]
    ds_read_b128 a[92:95], v112 offset:13312
    buffer_load_dwordx4 v253, s[20:23], s33 offen offset:0 sc1 lds
    v_mfma_f32_32x32x16_bf16 v[80:95], a[60:63], a[0:3], v[80:95]
    buffer_load_dwordx4 v253, s[20:23], s33 offen offset:1024 sc1 lds
    v_mfma_f32_32x32x16_bf16 v[96:111], a[64:67], a[0:3], v[96:111]
    buffer_load_dwordx4 v253, s[20:23], s33 offen offset:2048 sc1 lds
    s_waitcnt vmcnt(25) lgkmcnt(3)
    v_mfma_f32_32x32x16_bf16 v[0:15], a[68:71], a[4:7], v[0:15]
    ds_read_b128 a[40:43], v112 offset:14336
    ds_read_b128 a[44:47], v112 offset:15360
    v_mfma_f32_32x32x16_bf16 v[16:31], a[72:75], a[4:7], v[16:31]
    ds_read_b128 a[48:51], v112 offset:16384
    ds_read_b128 a[52:55], v112 offset:17408
    v_mfma_f32_32x32x16_bf16 v[32:47], a[76:79], a[4:7], v[32:47]
    s_waitcnt lgkmcnt(4)
    v_mfma_f32_32x32x16_bf16 v[48:63], a[80:83], a[4:7], v[48:63]
    ds_read_b128 a[56:59], v112 offset:18432
    ds_read_b128 a[60:63], v112 offset:19456
    v_mfma_f32_32x32x16_bf16 v[64:79], a[84:87], a[4:7], v[64:79]
    ds_read_b128 a[64:67], v112 offset:20480
    buffer_load_dwordx4 a[0:3], v253, s[24:27], s36 offen offset:2048 sc1
    v_mfma_f32_32x32x16_bf16 v[80:95], a[88:91], a[4:7], v[80:95]
    buffer_load_dwordx4 v253, s[20:23], s33 offen offset:3072 sc1 lds
    s_add_u32 m0, s34, 118784
    v_mfma_f32_32x32x16_bf16 v[96:111], a[92:95], a[4:7], v[96:111]
    buffer_load_dwordx4 v254, s[20:23], s33 offen offset:0 sc1 lds
    s_waitcnt vmcnt(24) lgkmcnt(3)
    v_mfma_f32_32x32x16_bf16 v[0:15], a[40:43], a[8:11], v[0:15]
    ds_read_b128 a[68:71], v112 offset:21504
    ds_read_b128 a[72:75], v112 offset:22528
    v_mfma_f32_32x32x16_bf16 v[16:31], a[44:47], a[8:11], v[16:31]
    ds_read_b128 a[76:79], v112 offset:23552
    ds_read_b128 a[80:83], v112 offset:24576
    v_mfma_f32_32x32x16_bf16 v[32:47], a[48:51], a[8:11], v[32:47]
    s_waitcnt lgkmcnt(4)
    v_mfma_f32_32x32x16_bf16 v[48:63], a[52:55], a[8:11], v[48:63]
    ds_read_b128 a[84:87], v112 offset:25600
    ds_read_b128 a[88:91], v112 offset:26624
    v_mfma_f32_32x32x16_bf16 v[64:79], a[56:59], a[8:11], v[64:79]
    ds_read_b128 a[92:95], v112 offset:27648
    buffer_load_dwordx4 a[4:7], v253, s[24:27], s36 offen offset:3072 sc1
    s_addk_i32 s36, 4096
    v_mfma_f32_32x32x16_bf16 v[80:95], a[60:63], a[8:11], v[80:95]
    buffer_load_dwordx4 v254, s[20:23], s33 offen offset:1024 sc1 lds
    v_mfma_f32_32x32x16_bf16 v[96:111], a[64:67], a[8:11], v[96:111]
    buffer_load_dwordx4 v254, s[20:23], s33 offen offset:2048 sc1 lds
    s_add_u32 s33, s33, 442368
    s_waitcnt vmcnt(24) lgkmcnt(3)
    v_mfma_f32_32x32x16_bf16 v[0:15], a[68:71], a[12:15], v[0:15]
    buffer_load_dwordx4 a[8:11], v253, s[24:27], s36 offen offset:0 sc1
    v_mfma_f32_32x32x16_bf16 v[16:31], a[72:75], a[12:15], v[16:31]
    s_waitcnt lgkmcnt(0)
    s_barrier
    v_mfma_f32_32x32x16_bf16 v[32:47], a[76:79], a[12:15], v[32:47]
    ds_read_b128 a[40:43], v112 offset:28672
    ds_read_b128 a[44:47], v112 offset:29696
    v_mfma_f32_32x32x16_bf16 v[48:63], a[80:83], a[12:15], v[48:63]
    ds_read_b128 a[48:51], v112 offset:30720
    ds_read_b128 a[52:55], v112 offset:31744
    v_mfma_f32_32x32x16_bf16 v[64:79], a[84:87], a[12:15], v[64:79]
    ds_read_b128 a[56:59], v112 offset:32768
    ds_read_b128 a[60:63], v112 offset:33792
    v_mfma_f32_32x32x16_bf16 v[80:95], a[88:91], a[12:15], v[80:95]
    ds_read_b128 a[64:67], v112 offset:34816
    v_mfma_f32_32x32x16_bf16 v[96:111], a[92:95], a[12:15], v[96:111]
    s_waitcnt vmcnt(22) lgkmcnt(3)
    v_mfma_f32_32x32x16_bf16 v[0:15], a[40:43], a[16:19], v[0:15]
    ds_read_b128 a[68:71], v112 offset:35840
    ds_read_b128 a[72:75], v112 offset:36864
    v_mfma_f32_32x32x16_bf16 v[16:31], a[44:47], a[16:19], v[16:31]
    ds_read_b128 a[76:79], v112 offset:37888
    ds_read_b128 a[80:83], v112 offset:38912
    v_mfma_f32_32x32x16_bf16 v[32:47], a[48:51], a[16:19], v[32:47]
    s_waitcnt lgkmcnt(4)
    v_mfma_f32_32x32x16_bf16 v[48:63], a[52:55], a[16:19], v[48:63]
    ds_read_b128 a[84:87], v112 offset:39936
    ds_read_b128 a[88:91], v112 offset:40960
    v_mfma_f32_32x32x16_bf16 v[64:79], a[56:59], a[16:19], v[64:79]
    ds_read_b128 a[92:95], v112 offset:41984
    buffer_load_dwordx4 a[12:15], v253, s[24:27], s36 offen offset:1024 sc1
    s_lshl_b32 s34, s60, 11
    s_add_u32 s33, s34, 4423680
    s_add_u32 m0, s34, 0
    v_mfma_f32_32x32x16_bf16 v[80:95], a[60:63], a[16:19], v[80:95]
    buffer_load_dwordx4 v253, s[20:23], s33 offen offset:0 sc1 lds
    v_mfma_f32_32x32x16_bf16 v[96:111], a[64:67], a[16:19], v[96:111]
    buffer_load_dwordx4 a[108:111], v253, s[40:43], s44 offen offset:3072 sc1
    s_waitcnt vmcnt(24) lgkmcnt(3)
    v_mfma_f32_32x32x16_bf16 v[0:15], a[68:71], a[20:23], v[0:15]
    ds_read_b128 a[40:43], v112 offset:43008
    ds_read_b128 a[44:47], v112 offset:44032
    v_mfma_f32_32x32x16_bf16 v[16:31], a[72:75], a[20:23], v[16:31]
    ds_read_b128 a[48:51], v112 offset:45056
    ds_read_b128 a[52:55], v112 offset:46080
    v_mfma_f32_32x32x16_bf16 v[32:47], a[76:79], a[20:23], v[32:47]
    s_waitcnt lgkmcnt(4)
    v_mfma_f32_32x32x16_bf16 v[48:63], a[80:83], a[20:23], v[48:63]
    ds_read_b128 a[56:59], v112 offset:47104
    ds_read_b128 a[60:63], v112 offset:48128
    v_mfma_f32_32x32x16_bf16 v[64:79], a[84:87], a[20:23], v[64:79]
    ds_read_b128 a[64:67], v112 offset:49152
    buffer_load_dwordx4 a[16:19], v253, s[24:27], s36 offen offset:2048 sc1
    v_mfma_f32_32x32x16_bf16 v[80:95], a[88:91], a[20:23], v[80:95]
    buffer_load_dwordx4 v253, s[20:23], s33 offen offset:1024 sc1 lds
    v_mfma_f32_32x32x16_bf16 v[96:111], a[92:95], a[20:23], v[96:111]
    buffer_load_dwordx4 a[112:115], v254, s[40:43], s44 offen sc1
    s_add_u32 s44, s44, 40960
    s_waitcnt vmcnt(23) lgkmcnt(3)
    v_mfma_f32_32x32x16_bf16 v[0:15], a[40:43], a[24:27], v[0:15]
    ds_read_b128 a[68:71], v112 offset:50176
    ds_read_b128 a[72:75], v112 offset:51200
    v_mfma_f32_32x32x16_bf16 v[16:31], a[44:47], a[24:27], v[16:31]
    ds_read_b128 a[76:79], v112 offset:52224
    ds_read_b128 a[80:83], v112 offset:53248
    v_mfma_f32_32x32x16_bf16 v[32:47], a[48:51], a[24:27], v[32:47]
    s_waitcnt lgkmcnt(4)
    v_mfma_f32_32x32x16_bf16 v[48:63], a[52:55], a[24:27], v[48:63]
    ds_read_b128 a[84:87], v112 offset:54272
    ds_read_b128 a[88:91], v112 offset:55296
    v_mfma_f32_32x32x16_bf16 v[64:79], a[56:59], a[24:27], v[64:79]
    ds_read_b128 a[92:95], v112 offset:56320
    buffer_load_dwordx4 a[20:23], v253, s[24:27], s36 offen offset:3072 sc1
    s_addk_i32 s36, 4096
    v_mfma_f32_32x32x16_bf16 v[80:95], a[60:63], a[24:27], v[80:95]
    buffer_load_dwordx4 a[116:119], v253, s[40:43], s44 offen offset:0 sc1
    v_mfma_f32_32x32x16_bf16 v[96:111], a[64:67], a[24:27], v[96:111]
    buffer_load_dwordx4 a[120:123], v253, s[40:43], s44 offen offset:1024 sc1
    s_waitcnt vmcnt(23) lgkmcnt(3)
    v_mfma_f32_32x32x16_bf16 v[0:15], a[68:71], a[28:31], v[0:15]
    buffer_load_dwordx4 a[24:27], v253, s[24:27], s36 offen offset:0 sc1
    v_mfma_f32_32x32x16_bf16 v[16:31], a[72:75], a[28:31], v[16:31]
    s_waitcnt lgkmcnt(0)
    s_barrier
    v_mfma_f32_32x32x16_bf16 v[32:47], a[76:79], a[28:31], v[32:47]
    ds_read_b128 a[40:43], v113 offset:0
    ds_read_b128 a[44:47], v113 offset:1024
    v_mfma_f32_32x32x16_bf16 v[48:63], a[80:83], a[28:31], v[48:63]
    ds_read_b128 a[48:51], v113 offset:2048
    ds_read_b128 a[52:55], v113 offset:3072
    v_mfma_f32_32x32x16_bf16 v[64:79], a[84:87], a[28:31], v[64:79]
    ds_read_b128 a[56:59], v113 offset:4096
    ds_read_b128 a[60:63], v113 offset:5120
    v_mfma_f32_32x32x16_bf16 v[80:95], a[88:91], a[28:31], v[80:95]
    ds_read_b128 a[64:67], v113 offset:6144
    buffer_load_dwordx4 a[124:127], v253, s[40:43], s44 offen offset:2048 sc1
    v_mfma_f32_32x32x16_bf16 v[96:111], a[92:95], a[28:31], v[96:111]
    s_waitcnt vmcnt(22) lgkmcnt(3)
    v_mfma_f32_32x32x16_bf16 v[0:15], a[40:43], a[32:35], v[0:15]
    ds_read_b128 a[68:71], v113 offset:7168
    ds_read_b128 a[72:75], v113 offset:8192
    v_mfma_f32_32x32x16_bf16 v[16:31], a[44:47], a[32:35], v[16:31]
    ds_read_b128 a[76:79], v113 offset:9216
    ds_read_b128 a[80:83], v113 offset:10240
    v_mfma_f32_32x32x16_bf16 v[32:47], a[48:51], a[32:35], v[32:47]
    s_waitcnt lgkmcnt(4)
    v_mfma_f32_32x32x16_bf16 v[48:63], a[52:55], a[32:35], v[48:63]
    ds_read_b128 a[84:87], v113 offset:11264
    ds_read_b128 a[88:91], v113 offset:12288
    v_mfma_f32_32x32x16_bf16 v[64:79], a[56:59], a[32:35], v[64:79]
    ds_read_b128 a[92:95], v113 offset:13312
    buffer_load_dwordx4 a[28:31], v253, s[24:27], s36 offen offset:1024 sc1
    v_mfma_f32_32x32x16_bf16 v[80:95], a[60:63], a[32:35], v[80:95]
    buffer_load_dwordx4 a[128:131], v253, s[40:43], s44 offen offset:3072 sc1
    v_mfma_f32_32x32x16_bf16 v[96:111], a[64:67], a[32:35], v[96:111]
    buffer_load_dwordx4 a[132:135], v254, s[40:43], s44 offen sc1
    s_add_u32 s44, s44, 40960
    s_waitcnt vmcnt(24) lgkmcnt(3)
    v_mfma_f32_32x32x16_bf16 v[0:15], a[68:71], a[36:39], v[0:15]
    ds_read_b128 a[40:43], v113 offset:14336
    ds_read_b128 a[44:47], v113 offset:15360
    v_mfma_f32_32x32x16_bf16 v[16:31], a[72:75], a[36:39], v[16:31]
    ds_read_b128 a[48:51], v113 offset:16384
    ds_read_b128 a[52:55], v113 offset:17408
    v_mfma_f32_32x32x16_bf16 v[32:47], a[76:79], a[36:39], v[32:47]
    s_waitcnt lgkmcnt(4)
    v_mfma_f32_32x32x16_bf16 v[48:63], a[80:83], a[36:39], v[48:63]
    ds_read_b128 a[56:59], v113 offset:18432
    ds_read_b128 a[60:63], v113 offset:19456
    v_mfma_f32_32x32x16_bf16 v[64:79], a[84:87], a[36:39], v[64:79]
    ds_read_b128 a[64:67], v113 offset:20480
    buffer_load_dwordx4 a[32:35], v253, s[24:27], s36 offen offset:2048 sc1
    v_mfma_f32_32x32x16_bf16 v[80:95], a[88:91], a[36:39], v[80:95]
    buffer_load_dwordx4 a[136:139], v253, s[40:43], s44 offen offset:0 sc1
    v_mfma_f32_32x32x16_bf16 v[96:111], a[92:95], a[36:39], v[96:111]
    buffer_load_dwordx4 a[140:143], v253, s[40:43], s44 offen offset:1024 sc1
    s_waitcnt vmcnt(23) lgkmcnt(3)
    v_mfma_f32_32x32x16_bf16 v[0:15], a[40:43], a[0:3], v[0:15]
    ds_read_b128 a[68:71], v113 offset:21504
    ds_read_b128 a[72:75], v113 offset:22528
    v_mfma_f32_32x32x16_bf16 v[16:31], a[44:47], a[0:3], v[16:31]
    ds_read_b128 a[76:79], v113 offset:23552
    ds_read_b128 a[80:83], v113 offset:24576
    v_mfma_f32_32x32x16_bf16 v[32:47], a[48:51], a[0:3], v[32:47]
    s_waitcnt lgkmcnt(4)
    v_mfma_f32_32x32x16_bf16 v[48:63], a[52:55], a[0:3], v[48:63]
    ds_read_b128 a[84:87], v113 offset:25600
    ds_read_b128 a[88:91], v113 offset:26624
    v_mfma_f32_32x32x16_bf16 v[64:79], a[56:59], a[0:3], v[64:79]
    ds_read_b128 a[92:95], v113 offset:27648
    buffer_load_dwordx4 a[36:39], v253, s[24:27], s36 offen offset:3072 sc1
    s_add_u32 s36, s36, 4096
    v_mfma_f32_32x32x16_bf16 v[80:95], a[60:63], a[0:3], v[80:95]
    buffer_load_dwordx4 a[144:147], v253, s[40:43], s44 offen offset:2048 sc1
    v_mfma_f32_32x32x16_bf16 v[96:111], a[64:67], a[0:3], v[96:111]
    buffer_load_dwordx4 a[148:151], v253, s[40:43], s44 offen offset:3072 sc1
    s_waitcnt vmcnt(23) lgkmcnt(3)
    v_mfma_f32_32x32x16_bf16 v[0:15], a[68:71], a[4:7], v[0:15]
    buffer_load_dwordx4 a[152:155], v254, s[40:43], s44 offen sc1
    s_add_u32 s44, s44, 40960
    v_mfma_f32_32x32x16_bf16 v[16:31], a[72:75], a[4:7], v[16:31]
    s_waitcnt lgkmcnt(0)
    s_barrier
    v_mfma_f32_32x32x16_bf16 v[32:47], a[76:79], a[4:7], v[32:47]
    ds_read_b128 a[40:43], v113 offset:28672
    ds_read_b128 a[44:47], v113 offset:29696
    v_mfma_f32_32x32x16_bf16 v[48:63], a[80:83], a[4:7], v[48:63]
    ds_read_b128 a[48:51], v113 offset:30720
    ds_read_b128 a[52:55], v113 offset:31744
    v_mfma_f32_32x32x16_bf16 v[64:79], a[84:87], a[4:7], v[64:79]
    ds_read_b128 a[56:59], v113 offset:32768
    ds_read_b128 a[60:63], v113 offset:33792
    v_mfma_f32_32x32x16_bf16 v[80:95], a[88:91], a[4:7], v[80:95]
    ds_read_b128 a[64:67], v113 offset:34816
    buffer_load_dwordx4 a[156:159], v253, s[40:43], s44 offen offset:0 sc1
    v_mfma_f32_32x32x16_bf16 v[96:111], a[92:95], a[4:7], v[96:111]
    s_waitcnt vmcnt(22) lgkmcnt(3)
    v_mfma_f32_32x32x16_bf16 v[0:15], a[40:43], a[8:11], v[0:15]
    ds_read_b128 a[68:71], v113 offset:35840
    ds_read_b128 a[72:75], v113 offset:36864
    v_mfma_f32_32x32x16_bf16 v[16:31], a[44:47], a[8:11], v[16:31]
    ds_read_b128 a[76:79], v113 offset:37888
    ds_read_b128 a[80:83], v113 offset:38912
    v_mfma_f32_32x32x16_bf16 v[32:47], a[48:51], a[8:11], v[32:47]
    s_waitcnt lgkmcnt(4)
    v_mfma_f32_32x32x16_bf16 v[48:63], a[52:55], a[8:11], v[48:63]
    ds_read_b128 a[84:87], v113 offset:39936
    ds_read_b128 a[88:91], v113 offset:40960
    v_mfma_f32_32x32x16_bf16 v[64:79], a[56:59], a[8:11], v[64:79]
    ds_read_b128 a[92:95], v113 offset:41984
    buffer_load_dwordx4 a[160:163], v253, s[40:43], s44 offen offset:1024 sc1
    v_mfma_f32_32x32x16_bf16 v[80:95], a[60:63], a[8:11], v[80:95]
    buffer_load_dwordx4 a[164:167], v253, s[40:43], s44 offen offset:2048 sc1
    v_mfma_f32_32x32x16_bf16 v[96:111], a[64:67], a[8:11], v[96:111]
    buffer_load_dwordx4 a[168:171], v253, s[40:43], s44 offen offset:3072 sc1
    s_waitcnt vmcnt(24) lgkmcnt(3)
    v_mfma_f32_32x32x16_bf16 v[0:15], a[68:71], a[12:15], v[0:15]
    ds_read_b128 a[40:43], v113 offset:43008
    ds_read_b128 a[44:47], v113 offset:44032
    v_mfma_f32_32x32x16_bf16 v[16:31], a[72:75], a[12:15], v[16:31]
    ds_read_b128 a[48:51], v113 offset:45056
    ds_read_b128 a[52:55], v113 offset:46080
    v_mfma_f32_32x32x16_bf16 v[32:47], a[76:79], a[12:15], v[32:47]
    s_waitcnt lgkmcnt(4)
    v_mfma_f32_32x32x16_bf16 v[48:63], a[80:83], a[12:15], v[48:63]
    ds_read_b128 a[56:59], v113 offset:47104
    ds_read_b128 a[60:63], v113 offset:48128
    v_mfma_f32_32x32x16_bf16 v[64:79], a[84:87], a[12:15], v[64:79]
    ds_read_b128 a[64:67], v113 offset:49152
    buffer_load_dwordx4 a[172:175], v254, s[40:43], s44 offen sc1
    s_add_u32 s44, s44, 40960
    v_mfma_f32_32x32x16_bf16 v[80:95], a[88:91], a[12:15], v[80:95]
    buffer_load_dwordx4 a[176:179], v253, s[40:43], s44 offen offset:0 sc1
    v_mfma_f32_32x32x16_bf16 v[96:111], a[92:95], a[12:15], v[96:111]
    buffer_load_dwordx4 a[180:183], v253, s[40:43], s44 offen offset:1024 sc1
    s_waitcnt vmcnt(24) lgkmcnt(3)
    v_mfma_f32_32x32x16_bf16 v[0:15], a[40:43], a[16:19], v[0:15]
    ds_read_b128 a[68:71], v113 offset:50176
    ds_read_b128 a[72:75], v113 offset:51200
    v_mfma_f32_32x32x16_bf16 v[16:31], a[44:47], a[16:19], v[16:31]
    ds_read_b128 a[76:79], v113 offset:52224
    ds_read_b128 a[80:83], v113 offset:53248
    v_mfma_f32_32x32x16_bf16 v[32:47], a[48:51], a[16:19], v[32:47]
    s_waitcnt lgkmcnt(4)
    v_mfma_f32_32x32x16_bf16 v[48:63], a[52:55], a[16:19], v[48:63]
    ds_read_b128 a[84:87], v113 offset:54272
    ds_read_b128 a[88:91], v113 offset:55296
    v_mfma_f32_32x32x16_bf16 v[64:79], a[56:59], a[16:19], v[64:79]
    ds_read_b128 a[92:95], v113 offset:56320
    buffer_load_dwordx4 a[184:187], v253, s[40:43], s44 offen offset:2048 sc1
    v_mfma_f32_32x32x16_bf16 v[80:95], a[60:63], a[16:19], v[80:95]
    buffer_load_dwordx4 a[188:191], v253, s[40:43], s44 offen offset:3072 sc1
    v_mfma_f32_32x32x16_bf16 v[96:111], a[64:67], a[16:19], v[96:111]
    buffer_load_dwordx4 a[192:195], v254, s[40:43], s44 offen sc1
    s_add_u32 s44, s44, 40960
    s_waitcnt vmcnt(24) lgkmcnt(3)
    v_mfma_f32_32x32x16_bf16 v[0:15], a[68:71], a[20:23], v[0:15]
    buffer_load_dwordx4 a[196:199], v253, s[40:43], s44 offen offset:0 sc1
    v_mfma_f32_32x32x16_bf16 v[16:31], a[72:75], a[20:23], v[16:31]
    s_waitcnt lgkmcnt(0)
    s_barrier
    v_mfma_f32_32x32x16_bf16 v[32:47], a[76:79], a[20:23], v[32:47]
    ds_read_b128 a[40:43], v114 offset:0
    ds_read_b128 a[44:47], v114 offset:1024
    v_mfma_f32_32x32x16_bf16 v[48:63], a[80:83], a[20:23], v[48:63]
    ds_read_b128 a[48:51], v114 offset:2048
    ds_read_b128 a[52:55], v114 offset:3072
    v_mfma_f32_32x32x16_bf16 v[64:79], a[84:87], a[20:23], v[64:79]
    ds_read_b128 a[56:59], v114 offset:4096
    ds_read_b128 a[60:63], v114 offset:5120
    v_mfma_f32_32x32x16_bf16 v[80:95], a[88:91], a[20:23], v[80:95]
    ds_read_b128 a[64:67], v114 offset:6144
    buffer_load_dwordx4 a[200:203], v253, s[40:43], s44 offen offset:1024 sc1
    v_mfma_f32_32x32x16_bf16 v[96:111], a[92:95], a[20:23], v[96:111]
    s_waitcnt vmcnt(23) lgkmcnt(3)
    v_mfma_f32_32x32x16_bf16 v[0:15], a[40:43], a[24:27], v[0:15]
    ds_read_b128 a[68:71], v114 offset:7168
    ds_read_b128 a[72:75], v114 offset:8192
    v_mfma_f32_32x32x16_bf16 v[16:31], a[44:47], a[24:27], v[16:31]
    ds_read_b128 a[76:79], v114 offset:9216
    ds_read_b128 a[80:83], v114 offset:10240
    v_mfma_f32_32x32x16_bf16 v[32:47], a[48:51], a[24:27], v[32:47]
    s_waitcnt lgkmcnt(4)
    v_mfma_f32_32x32x16_bf16 v[48:63], a[52:55], a[24:27], v[48:63]
    ds_read_b128 a[84:87], v114 offset:11264
    ds_read_b128 a[88:91], v114 offset:12288
    v_mfma_f32_32x32x16_bf16 v[64:79], a[56:59], a[24:27], v[64:79]
    ds_read_b128 a[92:95], v114 offset:13312
    buffer_load_dwordx4 a[204:207], v253, s[40:43], s44 offen offset:2048 sc1
    v_mfma_f32_32x32x16_bf16 v[80:95], a[60:63], a[24:27], v[80:95]
    buffer_load_dwordx4 a[208:211], v253, s[40:43], s44 offen offset:3072 sc1
    v_mfma_f32_32x32x16_bf16 v[96:111], a[64:67], a[24:27], v[96:111]
    buffer_load_dwordx4 a[212:215], v254, s[40:43], s44 offen sc1
    s_add_u32 s44, s44, 40960
    s_waitcnt vmcnt(24) lgkmcnt(3)
    v_mfma_f32_32x32x16_bf16 v[0:15], a[68:71], a[28:31], v[0:15]
    ds_read_b128 a[40:43], v114 offset:14336
    ds_read_b128 a[44:47], v114 offset:15360
    v_mfma_f32_32x32x16_bf16 v[16:31], a[72:75], a[28:31], v[16:31]
    ds_read_b128 a[48:51], v114 offset:16384
    ds_read_b128 a[52:55], v114 offset:17408
    v_mfma_f32_32x32x16_bf16 v[32:47], a[76:79], a[28:31], v[32:47]
    s_waitcnt lgkmcnt(4)
    v_mfma_f32_32x32x16_bf16 v[48:63], a[80:83], a[28:31], v[48:63]
    ds_read_b128 a[56:59], v114 offset:18432
    ds_read_b128 a[60:63], v114 offset:19456
    v_mfma_f32_32x32x16_bf16 v[64:79], a[84:87], a[28:31], v[64:79]
    ds_read_b128 a[64:67], v114 offset:20480
    buffer_load_dwordx4 v[160:163], v253, s[40:43], s44 offen offset:0 sc1
    v_mfma_f32_32x32x16_bf16 v[80:95], a[88:91], a[28:31], v[80:95]
    buffer_load_dwordx4 v[164:167], v253, s[40:43], s44 offen offset:1024 sc1
    v_mfma_f32_32x32x16_bf16 v[96:111], a[92:95], a[28:31], v[96:111]
    buffer_load_dwordx4 v[168:171], v253, s[40:43], s44 offen offset:2048 sc1
    s_waitcnt vmcnt(24) lgkmcnt(3)
    v_mfma_f32_32x32x16_bf16 v[0:15], a[40:43], a[32:35], v[0:15]
    ds_read_b128 a[68:71], v114 offset:21504
    ds_read_b128 a[72:75], v114 offset:22528
    v_mfma_f32_32x32x16_bf16 v[16:31], a[44:47], a[32:35], v[16:31]
    ds_read_b128 a[76:79], v114 offset:23552
    ds_read_b128 a[80:83], v114 offset:24576
    v_mfma_f32_32x32x16_bf16 v[32:47], a[48:51], a[32:35], v[32:47]
    s_waitcnt lgkmcnt(4)
    v_mfma_f32_32x32x16_bf16 v[48:63], a[52:55], a[32:35], v[48:63]
    ds_read_b128 a[84:87], v114 offset:25600
    ds_read_b128 a[88:91], v114 offset:26624
    v_mfma_f32_32x32x16_bf16 v[64:79], a[56:59], a[32:35], v[64:79]
    ds_read_b128 a[92:95], v114 offset:27648
    v_mfma_f32_32x32x16_bf16 v[80:95], a[60:63], a[32:35], v[80:95]
    buffer_load_dwordx4 v[172:175], v253, s[40:43], s44 offen offset:3072 sc1
    v_mfma_f32_32x32x16_bf16 v[96:111], a[64:67], a[32:35], v[96:111]
    buffer_load_dwordx4 v[176:179], v254, s[40:43], s44 offen sc1
    s_add_u32 s44, s44, 40960
    s_waitcnt vmcnt(23) lgkmcnt(3)
    v_mfma_f32_32x32x16_bf16 v[0:15], a[68:71], a[36:39], v[0:15]
    v_mfma_f32_32x32x16_bf16 v[16:31], a[72:75], a[36:39], v[16:31]
    s_waitcnt lgkmcnt(0)
    s_barrier
    v_mfma_f32_32x32x16_bf16 v[32:47], a[76:79], a[36:39], v[32:47]
    ds_read2st64_b32 a[40:41], v140 offset0:0 offset1:1
    ds_read2st64_b32 a[42:43], v140 offset0:2 offset1:3
    ds_read2st64_b32 a[44:45], v140 offset0:4 offset1:5
    ds_read2st64_b32 a[46:47], v140 offset0:6 offset1:7
    v_mfma_f32_32x32x16_bf16 v[48:63], a[80:83], a[36:39], v[48:63]
    ds_read2st64_b32 a[48:49], v140 offset0:8 offset1:9
    ds_read2st64_b32 a[50:51], v140 offset0:10 offset1:11
    ds_read2st64_b32 a[52:53], v140 offset0:12 offset1:13
    ds_read2st64_b32 a[54:55], v140 offset0:14 offset1:15
    v_mfma_f32_32x32x16_bf16 v[64:79], a[84:87], a[36:39], v[64:79]
    ds_read2st64_b32 a[56:57], v140 offset0:16 offset1:17
    ds_read2st64_b32 a[58:59], v140 offset0:18 offset1:19
    ds_read2st64_b32 a[60:61], v140 offset0:20 offset1:21
    ds_read2st64_b32 a[62:63], v140 offset0:22 offset1:23
    v_mfma_f32_32x32x16_bf16 v[80:95], a[88:91], a[36:39], v[80:95]
    ds_read2st64_b32 a[64:65], v140 offset0:24 offset1:25
    ds_read2st64_b32 a[66:67], v140 offset0:26 offset1:27
    v_mfma_f32_32x32x16_bf16 v[96:111], a[92:95], a[36:39], v[96:111]
    s_waitcnt lgkmcnt(6)
    v_mfma_f32_32x32x16_bf16 v[0:15], a[40:43], v[132:135], v[0:15]
    v_mfma_f32_32x32x16_bf16 v[16:31], a[44:47], v[132:135], v[16:31]
    v_mfma_f32_32x32x16_bf16 v[32:47], a[48:51], v[132:135], v[32:47]
    s_waitcnt lgkmcnt(0)
    v_mfma_f32_32x32x16_bf16 v[48:63], a[52:55], v[132:135], v[48:63]
    v_mfma_f32_32x32x16_bf16 v[64:79], a[56:59], v[132:135], v[64:79]
    v_mfma_f32_32x32x16_bf16 v[80:95], a[60:63], v[132:135], v[80:95]
    v_mfma_f32_32x32x16_bf16 v[96:111], a[64:67], v[132:135], v[96:111]
    s_nop 4
    v_pk_mul_f32 v[0:1], v[136:137], v[0:1]
    v_pk_mul_f32 v[2:3], v[136:137], v[2:3]
    v_pk_mul_f32 v[4:5], v[136:137], v[4:5]
    v_pk_mul_f32 v[6:7], v[136:137], v[6:7]
    v_pk_mul_f32 v[0:1], v[0:1], v[8:9]
    v_pk_mul_f32 v[2:3], v[2:3], v[10:11]
    v_pk_mul_f32 v[4:5], v[4:5], v[12:13]
    v_pk_mul_f32 v[6:7], v[6:7], v[14:15]
    v_cvt_pk_bf16_f32 v8, v0, v1
    v_cvt_pk_bf16_f32 v9, v2, v3
    v_cvt_pk_bf16_f32 v10, v4, v5
    v_cvt_pk_bf16_f32 v11, v6, v7
    buffer_store_dwordx4 v[8:11], v138, s[28:31], s12 offen sc1
    v_pk_mul_f32 v[16:17], v[136:137], v[16:17]
    v_pk_mul_f32 v[18:19], v[136:137], v[18:19]
    v_pk_mul_f32 v[20:21], v[136:137], v[20:21]
    v_pk_mul_f32 v[22:23], v[136:137], v[22:23]
    v_pk_mul_f32 v[16:17], v[16:17], v[24:25]
    v_pk_mul_f32 v[18:19], v[18:19], v[26:27]
    v_pk_mul_f32 v[20:21], v[20:21], v[28:29]
    v_pk_mul_f32 v[22:23], v[22:23], v[30:31]
    v_cvt_pk_bf16_f32 v24, v16, v17
    v_cvt_pk_bf16_f32 v25, v18, v19
    v_cvt_pk_bf16_f32 v26, v20, v21
    v_cvt_pk_bf16_f32 v27, v22, v23
    buffer_store_dwordx4 v[24:27], v138, s[28:31], s13 offen sc1
    v_pk_mul_f32 v[32:33], v[136:137], v[32:33]
    v_pk_mul_f32 v[34:35], v[136:137], v[34:35]
    v_pk_mul_f32 v[36:37], v[136:137], v[36:37]
    v_pk_mul_f32 v[38:39], v[136:137], v[38:39]
    v_pk_mul_f32 v[32:33], v[32:33], v[40:41]
    v_pk_mul_f32 v[34:35], v[34:35], v[42:43]
    v_pk_mul_f32 v[36:37], v[36:37], v[44:45]
    v_pk_mul_f32 v[38:39], v[38:39], v[46:47]
    v_cvt_pk_bf16_f32 v40, v32, v33
    v_cvt_pk_bf16_f32 v41, v34, v35
    v_cvt_pk_bf16_f32 v42, v36, v37
    v_cvt_pk_bf16_f32 v43, v38, v39
    buffer_store_dwordx4 v[40:43], v138, s[28:31], s14 offen sc1
    v_pk_mul_f32 v[48:49], v[136:137], v[48:49]
    v_pk_mul_f32 v[50:51], v[136:137], v[50:51]
    v_pk_mul_f32 v[52:53], v[136:137], v[52:53]
    v_pk_mul_f32 v[54:55], v[136:137], v[54:55]
    v_pk_mul_f32 v[48:49], v[48:49], v[56:57]
    v_pk_mul_f32 v[50:51], v[50:51], v[58:59]
    v_pk_mul_f32 v[52:53], v[52:53], v[60:61]
    v_pk_mul_f32 v[54:55], v[54:55], v[62:63]
    v_cvt_pk_bf16_f32 v56, v48, v49
    v_cvt_pk_bf16_f32 v57, v50, v51
    v_cvt_pk_bf16_f32 v58, v52, v53
    v_cvt_pk_bf16_f32 v59, v54, v55
    buffer_store_dwordx4 v[56:59], v138, s[28:31], s15 offen sc1
    v_pk_mul_f32 v[64:65], v[136:137], v[64:65]
    v_pk_mul_f32 v[66:67], v[136:137], v[66:67]
    v_pk_mul_f32 v[68:69], v[136:137], v[68:69]
    v_pk_mul_f32 v[70:71], v[136:137], v[70:71]
    v_pk_mul_f32 v[64:65], v[64:65], v[72:73]
    v_pk_mul_f32 v[66:67], v[66:67], v[74:75]
    v_pk_mul_f32 v[68:69], v[68:69], v[76:77]
    v_pk_mul_f32 v[70:71], v[70:71], v[78:79]
    v_cvt_pk_bf16_f32 v72, v64, v65
    v_cvt_pk_bf16_f32 v73, v66, v67
    v_cvt_pk_bf16_f32 v74, v68, v69
    v_cvt_pk_bf16_f32 v75, v70, v71
    buffer_store_dwordx4 v[72:75], v138, s[28:31], s16 offen sc1
    v_pk_mul_f32 v[80:81], v[136:137], v[80:81]
    v_pk_mul_f32 v[82:83], v[136:137], v[82:83]
    v_pk_mul_f32 v[84:85], v[136:137], v[84:85]
    v_pk_mul_f32 v[86:87], v[136:137], v[86:87]
    v_pk_mul_f32 v[80:81], v[80:81], v[88:89]
    v_pk_mul_f32 v[82:83], v[82:83], v[90:91]
    v_pk_mul_f32 v[84:85], v[84:85], v[92:93]
    v_pk_mul_f32 v[86:87], v[86:87], v[94:95]
    v_cvt_pk_bf16_f32 v88, v80, v81
    v_cvt_pk_bf16_f32 v89, v82, v83
    v_cvt_pk_bf16_f32 v90, v84, v85
    v_cvt_pk_bf16_f32 v91, v86, v87
    buffer_store_dwordx4 v[88:91], v138, s[28:31], s17 offen sc1
    v_pk_mul_f32 v[96:97], v[136:137], v[96:97]
    v_pk_mul_f32 v[98:99], v[136:137], v[98:99]
    v_pk_mul_f32 v[100:101], v[136:137], v[100:101]
    v_pk_mul_f32 v[102:103], v[136:137], v[102:103]
    v_pk_mul_f32 v[96:97], v[96:97], v[104:105]
    v_pk_mul_f32 v[98:99], v[98:99], v[106:107]
    v_pk_mul_f32 v[100:101], v[100:101], v[108:109]
    v_pk_mul_f32 v[102:103], v[102:103], v[110:111]
    v_cvt_pk_bf16_f32 v104, v96, v97
    v_cvt_pk_bf16_f32 v105, v98, v99
    v_cvt_pk_bf16_f32 v106, v100, v101
    v_cvt_pk_bf16_f32 v107, v102, v103
    buffer_store_dwordx4 v[104:107], v138, s[28:31], s18 offen sc1
    s_mul_i32 s61, s56, 884736
    s_lshl_b32 s62, s50, 10
    s_add_u32 s61, s61, s62
    s_add_u32 s61, s61, 16777216
    s_add_u32 s8, s90, s61
    s_addc_u32 s9, s91, 0
    s_mov_b32 s10, 881664
    s_mov_b32 s11, 0x00020000
    s_mov_b32 s20, s86
    s_mov_b32 s21, s87
    s_mov_b32 s22, 2621440
    s_mov_b32 s23, 0x00020000
    s_mul_i32 s24, s60, 57344
    s_add_u32 s3, s35, 224
    s_waitcnt vmcnt(0)
    s_lshl_b32 s63, s3, 8
    s_add_u32 s63, s63, 262144
    v_mov_b32 v0, s63
    v_mov_b32 v1, 1
    s_mov_b64 exec, 1
    global_atomic_add v0, v1, s[90:91] sc1
    s_mov_b64 exec, -1
    buffer_load_dwordx4 v[180:183], v253, s[40:43], s44 offen offset:0 sc1
    buffer_load_dwordx4 v[184:187], v253, s[40:43], s44 offen offset:1024 sc1
    buffer_load_dwordx4 v[188:191], v253, s[40:43], s44 offen offset:2048 sc1
    buffer_load_dwordx4 v[192:195], v253, s[40:43], s44 offen offset:3072 sc1
    buffer_load_dwordx4 v[196:199], v254, s[40:43], s44 offen sc1
    s_add_u32 s44, s44, 40960
    buffer_load_dwordx4 v[200:203], v253, s[40:43], s44 offen offset:0 sc1
    buffer_load_dwordx4 v[204:207], v253, s[40:43], s44 offen offset:1024 sc1
    buffer_load_dwordx4 v[208:211], v253, s[40:43], s44 offen offset:2048 sc1
    buffer_load_dwordx4 v[212:215], v253, s[40:43], s44 offen offset:3072 sc1
    buffer_load_dwordx4 v[216:219], v254, s[40:43], s44 offen sc1
    s_add_u32 s44, s44, 40960
    buffer_load_dwordx4 a[0:3], v253, s[40:43], s44 offen offset:0 sc1
    buffer_load_dwordx4 a[4:7], v253, s[40:43], s44 offen offset:1024 sc1
    buffer_load_dwordx4 a[8:11], v253, s[40:43], s44 offen offset:2048 sc1
    buffer_load_dwordx4 a[12:15], v253, s[40:43], s44 offen offset:3072 sc1
    buffer_load_dwordx4 a[16:19], v254, s[40:43], s44 offen sc1
    s_add_u32 s44, s44, 40960
    buffer_load_dwordx4 a[20:23], v253, s[40:43], s44 offen offset:0 sc1
    buffer_load_dwordx4 a[24:27], v253, s[40:43], s44 offen offset:1024 sc1
    buffer_load_dwordx4 a[28:31], v253, s[40:43], s44 offen offset:2048 sc1
    buffer_load_dwordx4 a[32:35], v253, s[40:43], s44 offen offset:3072 sc1
    buffer_load_dwordx4 a[36:39], v254, s[40:43], s44 offen sc1
    s_add_u32 s44, s44, 40960
    buffer_load_dwordx4 a[40:43], v253, s[40:43], s44 offen offset:0 sc1
    buffer_load_dwordx4 a[44:47], v253, s[40:43], s44 offen offset:1024 sc1
    buffer_load_dwordx4 a[48:51], v253, s[40:43], s44 offen offset:2048 sc1
    buffer_load_dwordx4 a[52:55], v253, s[40:43], s44 offen offset:3072 sc1
    buffer_load_dwordx4 a[56:59], v254, s[40:43], s44 offen sc1
    s_add_u32 s44, s44, 40960
    buffer_load_dwordx4 a[60:63], v253, s[40:43], s44 offen offset:0 sc1
    buffer_load_dwordx4 a[64:67], v253, s[40:43], s44 offen offset:1024 sc1
    buffer_load_dwordx4 a[68:71], v253, s[40:43], s44 offen offset:2048 sc1
    buffer_load_dwordx4 a[72:75], v253, s[40:43], s44 offen offset:3072 sc1
    buffer_load_dwordx4 a[76:79], v254, s[40:43], s44 offen sc1
    s_add_u32 s44, s44, 40960
    buffer_load_dwordx4 a[80:83], v253, s[40:43], s44 offen offset:0 sc1
    buffer_load_dwordx4 a[84:87], v253, s[40:43], s44 offen offset:1024 sc1
    buffer_load_dwordx4 a[88:91], v253, s[40:43], s44 offen offset:2048 sc1
    buffer_load_dwordx4 a[92:95], v253, s[40:43], s44 offen offset:3072 sc1
    buffer_load_dwordx4 a[216:219], v254, s[40:43], s44 offen sc1
    s_add_u32 s44, s44, 40960
    s_add_u32 s61, s60, 0
    s_and_b32 s61, s61, 3
    s_mul_i32 s62, s61, 221184
    v_add_u32_e64 v80, s62, v253
    s_mul_i32 s62, s61, 15360
    s_add_u32 s62, s62, 102400
    v_add_u32_e64 v87, s62, v253
    s_add_u32 s61, s60, 1
    s_and_b32 s61, s61, 3
    s_mul_i32 s62, s61, 221184
    v_add_u32_e64 v81, s62, v253
    s_mul_i32 s62, s61, 15360
    s_add_u32 s62, s62, 102400
    v_add_u32_e64 v84, s62, v253
    s_add_u32 s61, s60, 2
    s_and_b32 s61, s61, 3
    s_mul_i32 s62, s61, 221184
    v_add_u32_e64 v82, s62, v253
    s_mul_i32 s62, s61, 15360
    s_add_u32 s62, s62, 107520
    v_add_u32_e64 v85, s62, v253
    s_add_u32 s61, s60, 3
    s_and_b32 s61, s61, 3
    s_mul_i32 s62, s61, 221184
    v_add_u32_e64 v83, s62, v253
    s_mul_i32 s62, s61, 15360
    s_add_u32 s62, s62, 112640
    v_add_u32_e64 v86, s62, v253
    s_lshl_b32 s61, s56, 3
    s_lshr_b32 s62, s50, 1
    s_add_u32 s61, s61, s62
    s_lshl_b32 s61, s61, 8
    s_add_u32 s61, s61, 319488
    v_and_b32 v90, 1, v252
    v_lshlrev_b32 v88, 9, v252
    v_add_u32 v88, s61, v88
    v_mul_u32_u24 v90, 24, v90
    v_add_u32 v90, v250, v90
    s_cmp_lg_u32 s60, 0
    s_cbranch_scc1 L_p4_nopoll
    s_mov_b32 s94, 0
L_poll7:
    global_load_dword v89, v88, s[90:91] sc1
    s_add_u32 s94, s94, 1
    s_waitcnt vmcnt(0)
    v_cmp_gt_u32_e64 vcc, 16, v89
    s_cmp_gt_u32 s94, 65536
    s_cbranch_scc1 L_pdone7
    s_nop 2
    s_cbranch_vccz L_pdone7
    s_sleep 4
    s_branch L_poll7
L_pdone7:
L_p4_nopoll:
    s_barrier
    buffer_load_dwordx4 v[96:99], v80, s[8:11], s24 offen sc1
    buffer_load_dwordx4 v[100:103], v81, s[8:11], s24 offen sc1
    buffer_load_dwordx4 v[104:107], v82, s[8:11], s24 offen sc1
    buffer_load_dwordx4 v[108:111], v83, s[8:11], s24 offen sc1
    s_add_u32 s24, s24, 4096
    buffer_load_dwordx4 v[112:115], v80, s[8:11], s24 offen sc1
    buffer_load_dwordx4 v[116:119], v81, s[8:11], s24 offen sc1
    buffer_load_dwordx4 v[120:123], v82, s[8:11], s24 offen sc1
    buffer_load_dwordx4 v[124:127], v83, s[8:11], s24 offen sc1
    s_add_u32 s24, s24, 4096
    buffer_load_dwordx4 v[128:131], v80, s[8:11], s24 offen sc1
    buffer_load_dwordx4 v[132:135], v81, s[8:11], s24 offen sc1
    buffer_load_dwordx4 v[136:139], v82, s[8:11], s24 offen sc1
    buffer_load_dwordx4 v[140:143], v83, s[8:11], s24 offen sc1
    s_addk_i32 s24, 4096
    s_waitcnt vmcnt(8)
    v_mfma_f32_16x16x32_bf16 v[0:3], a[96:99], v[96:99], 0
    v_mfma_f32_16x16x32_bf16 v[4:7], a[100:103], v[96:99], 0
    v_mfma_f32_16x16x32_bf16 v[8:11], a[104:107], v[96:99], 0
    v_mfma_f32_16x16x32_bf16 v[12:15], a[108:111], v[96:99], 0
    v_mfma_f32_16x16x32_bf16 v[16:19], a[112:115], v[96:99], 0
    v_mfma_f32_16x16x32_bf16 v[20:23], a[96:99], v[100:103], 0
    v_mfma_f32_16x16x32_bf16 v[24:27], a[100:103], v[100:103], 0
    v_mfma_f32_16x16x32_bf16 v[28:31], a[104:107], v[100:103], 0
    v_mfma_f32_16x16x32_bf16 v[32:35], a[108:111], v[100:103], 0
    v_mfma_f32_16x16x32_bf16 v[36:39], a[112:115], v[100:103], 0
    v_mfma_f32_16x16x32_bf16 v[40:43], a[96:99], v[104:107], 0
    v_mfma_f32_16x16x32_bf16 v[44:47], a[100:103], v[104:107], 0
    v_mfma_f32_16x16x32_bf16 v[48:51], a[104:107], v[104:107], 0
    v_mfma_f32_16x16x32_bf16 v[52:55], a[108:111], v[104:107], 0
    v_mfma_f32_16x16x32_bf16 v[56:59], a[112:115], v[104:107], 0
    v_mfma_f32_16x16x32_bf16 v[60:63], a[96:99], v[108:111], 0
    buffer_load_dwordx4 v[144:147], v80, s[8:11], s24 offen sc1
    v_mfma_f32_16x16x32_bf16 v[64:67], a[100:103], v[108:111], 0
    buffer_load_dwordx4 v[148:151], v81, s[8:11], s24 offen sc1
    v_mfma_f32_16x16x32_bf16 v[68:71], a[104:107], v[108:111], 0
    buffer_load_dwordx4 v[152:155], v82, s[8:11], s24 offen sc1
    v_mfma_f32_16x16x32_bf16 v[72:75], a[108:111], v[108:111], 0
    buffer_load_dwordx4 v[156:159], v83, s[8:11], s24 offen sc1
    v_mfma_f32_16x16x32_bf16 v[76:79], a[112:115], v[108:111], 0
    s_addk_i32 s24, 4096
    s_waitcnt vmcnt(8)
    v_mfma_f32_16x16x32_bf16 v[0:3], a[116:119], v[112:115], v[0:3]
    v_mfma_f32_16x16x32_bf16 v[4:7], a[120:123], v[112:115], v[4:7]
    v_mfma_f32_16x16x32_bf16 v[8:11], a[124:127], v[112:115], v[8:11]
    v_mfma_f32_16x16x32_bf16 v[12:15], a[128:131], v[112:115], v[12:15]
    v_mfma_f32_16x16x32_bf16 v[16:19], a[132:135], v[112:115], v[16:19]
    v_mfma_f32_16x16x32_bf16 v[20:23], a[116:119], v[116:119], v[20:23]
    v_mfma_f32_16x16x32_bf16 v[24:27], a[120:123], v[116:119], v[24:27]
    v_mfma_f32_16x16x32_bf16 v[28:31], a[124:127], v[116:119], v[28:31]
    v_mfma_f32_16x16x32_bf16 v[32:35], a[128:131], v[116:119], v[32:35]
    v_mfma_f32_16x16x32_bf16 v[36:39], a[132:135], v[116:119], v[36:39]
    v_mfma_f32_16x16x32_bf16 v[40:43], a[116:119], v[120:123], v[40:43]
    v_mfma_f32_16x16x32_bf16 v[44:47], a[120:123], v[120:123], v[44:47]
    v_mfma_f32_16x16x32_bf16 v[48:51], a[124:127], v[120:123], v[48:51]
    v_mfma_f32_16x16x32_bf16 v[52:55], a[128:131], v[120:123], v[52:55]
    v_mfma_f32_16x16x32_bf16 v[56:59], a[132:135], v[120:123], v[56:59]
    v_mfma_f32_16x16x32_bf16 v[60:63], a[116:119], v[124:127], v[60:63]
    buffer_load_dwordx4 v[96:99], v80, s[8:11], s24 offen sc1
    v_mfma_f32_16x16x32_bf16 v[64:67], a[120:123], v[124:127], v[64:67]
    buffer_load_dwordx4 v[100:103], v81, s[8:11], s24 offen sc1
    v_mfma_f32_16x16x32_bf16 v[68:71], a[124:127], v[124:127], v[68:71]
    buffer_load_dwordx4 v[104:107], v82, s[8:11], s24 offen sc1
    v_mfma_f32_16x16x32_bf16 v[72:75], a[128:131], v[124:127], v[72:75]
    buffer_load_dwordx4 v[108:111], v83, s[8:11], s24 offen sc1
    v_mfma_f32_16x16x32_bf16 v[76:79], a[132:135], v[124:127], v[76:79]
    s_addk_i32 s24, 4096
    s_waitcnt vmcnt(8)
    v_mfma_f32_16x16x32_bf16 v[0:3], a[136:139], v[128:131], v[0:3]
    v_mfma_f32_16x16x32_bf16 v[4:7], a[140:143], v[128:131], v[4:7]
    v_mfma_f32_16x16x32_bf16 v[8:11], a[144:147], v[128:131], v[8:11]
    v_mfma_f32_16x16x32_bf16 v[12:15], a[148:151], v[128:131], v[12:15]
    v_mfma_f32_16x16x32_bf16 v[16:19], a[152:155], v[128:131], v[16:19]
    v_mfma_f32_16x16x32_bf16 v[20:23], a[136:139], v[132:135], v[20:23]
    v_mfma_f32_16x16x32_bf16 v[24:27], a[140:143], v[132:135], v[24:27]
    v_mfma_f32_16x16x32_bf16 v[28:31], a[144:147], v[132:135], v[28:31]
    v_mfma_f32_16x16x32_bf16 v[32:35], a[148:151], v[132:135], v[32:35]
    v_mfma_f32_16x16x32_bf16 v[36:39], a[152:155], v[132:135], v[36:39]
    v_mfma_f32_16x16x32_bf16 v[40:43], a[136:139], v[136:139], v[40:43]
    v_mfma_f32_16x16x32_bf16 v[44:47], a[140:143], v[136:139], v[44:47]
    v_mfma_f32_16x16x32_bf16 v[48:51], a[144:147], v[136:139], v[48:51]
    v_mfma_f32_16x16x32_bf16 v[52:55], a[148:151], v[136:139], v[52:55]
    v_mfma_f32_16x16x32_bf16 v[56:59], a[152:155], v[136:139], v[56:59]
    v_mfma_f32_16x16x32_bf16 v[60:63], a[136:139], v[140:143], v[60:63]
    buffer_load_dwordx4 v[112:115], v80, s[8:11], s24 offen sc1
    v_mfma_f32_16x16x32_bf16 v[64:67], a[140:143], v[140:143], v[64:67]
    buffer_load_dwordx4 v[116:119], v81, s[8:11], s24 offen sc1
    v_mfma_f32_16x16x32_bf16 v[68:71], a[144:147], v[140:143], v[68:71]
    buffer_load_dwordx4 v[120:123], v82, s[8:11], s24 offen sc1
    v_mfma_f32_16x16x32_bf16 v[72:75], a[148:151], v[140:143], v[72:75]
    buffer_load_dwordx4 v[124:127], v83, s[8:11], s24 offen sc1
    v_mfma_f32_16x16x32_bf16 v[76:79], a[152:155], v[140:143], v[76:79]
    s_addk_i32 s24, 4096
    s_waitcnt vmcnt(8)
    v_mfma_f32_16x16x32_bf16 v[0:3], a[156:159], v[144:147], v[0:3]
    v_mfma_f32_16x16x32_bf16 v[4:7], a[160:163], v[144:147], v[4:7]
    v_mfma_f32_16x16x32_bf16 v[8:11], a[164:167], v[144:147], v[8:11]
    v_mfma_f32_16x16x32_bf16 v[12:15], a[168:171], v[144:147], v[12:15]
    v_mfma_f32_16x16x32_bf16 v[16:19], a[172:175], v[144:147], v[16:19]
    v_mfma_f32_16x16x32_bf16 v[20:23], a[156:159], v[148:151], v[20:23]
    v_mfma_f32_16x16x32_bf16 v[24:27], a[160:163], v[148:151], v[24:27]
    v_mfma_f32_16x16x32_bf16 v[28:31], a[164:167], v[148:151], v[28:31]
    v_mfma_f32_16x16x32_bf16 v[32:35], a[168:171], v[148:151], v[32:35]
    v_mfma_f32_16x16x32_bf16 v[36:39], a[172:175], v[148:151], v[36:39]
    v_mfma_f32_16x16x32_bf16 v[40:43], a[156:159], v[152:155], v[40:43]
    v_mfma_f32_16x16x32_bf16 v[44:47], a[160:163], v[152:155], v[44:47]
    v_mfma_f32_16x16x32_bf16 v[48:51], a[164:167], v[152:155], v[48:51]
    v_mfma_f32_16x16x32_bf16 v[52:55], a[168:171], v[152:155], v[52:55]
    v_mfma_f32_16x16x32_bf16 v[56:59], a[172:175], v[152:155], v[56:59]
    v_mfma_f32_16x16x32_bf16 v[60:63], a[156:159], v[156:159], v[60:63]
    buffer_load_dwordx4 v[128:131], v80, s[8:11], s24 offen sc1
    v_mfma_f32_16x16x32_bf16 v[64:67], a[160:163], v[156:159], v[64:67]
    buffer_load_dwordx4 v[132:135], v81, s[8:11], s24 offen sc1
    v_mfma_f32_16x16x32_bf16 v[68:71], a[164:167], v[156:159], v[68:71]
    buffer_load_dwordx4 v[136:139], v82, s[8:11], s24 offen sc1
    v_mfma_f32_16x16x32_bf16 v[72:75], a[168:171], v[156:159], v[72:75]
    buffer_load_dwordx4 v[140:143], v83, s[8:11], s24 offen sc1
    v_mfma_f32_16x16x32_bf16 v[76:79], a[172:175], v[156:159], v[76:79]
    s_addk_i32 s24, 4096
    s_waitcnt vmcnt(8)
    v_mfma_f32_16x16x32_bf16 v[0:3], a[176:179], v[96:99], v[0:3]
    v_mfma_f32_16x16x32_bf16 v[4:7], a[180:183], v[96:99], v[4:7]
    v_mfma_f32_16x16x32_bf16 v[8:11], a[184:187], v[96:99], v[8:11]
    v_mfma_f32_16x16x32_bf16 v[12:15], a[188:191], v[96:99], v[12:15]
    v_mfma_f32_16x16x32_bf16 v[16:19], a[192:195], v[96:99], v[16:19]
    v_mfma_f32_16x16x32_bf16 v[20:23], a[176:179], v[100:103], v[20:23]
    v_mfma_f32_16x16x32_bf16 v[24:27], a[180:183], v[100:103], v[24:27]
    v_mfma_f32_16x16x32_bf16 v[28:31], a[184:187], v[100:103], v[28:31]
    v_mfma_f32_16x16x32_bf16 v[32:35], a[188:191], v[100:103], v[32:35]
    v_mfma_f32_16x16x32_bf16 v[36:39], a[192:195], v[100:103], v[36:39]
    v_mfma_f32_16x16x32_bf16 v[40:43], a[176:179], v[104:107], v[40:43]
    v_mfma_f32_16x16x32_bf16 v[44:47], a[180:183], v[104:107], v[44:47]
    v_mfma_f32_16x16x32_bf16 v[48:51], a[184:187], v[104:107], v[48:51]
    v_mfma_f32_16x16x32_bf16 v[52:55], a[188:191], v[104:107], v[52:55]
    v_mfma_f32_16x16x32_bf16 v[56:59], a[192:195], v[104:107], v[56:59]
    v_mfma_f32_16x16x32_bf16 v[60:63], a[176:179], v[108:111], v[60:63]
    buffer_load_dwordx4 v[144:147], v80, s[8:11], s24 offen sc1
    v_mfma_f32_16x16x32_bf16 v[64:67], a[180:183], v[108:111], v[64:67]
    buffer_load_dwordx4 v[148:151], v81, s[8:11], s24 offen sc1
    v_mfma_f32_16x16x32_bf16 v[68:71], a[184:187], v[108:111], v[68:71]
    buffer_load_dwordx4 v[152:155], v82, s[8:11], s24 offen sc1
    v_mfma_f32_16x16x32_bf16 v[72:75], a[188:191], v[108:111], v[72:75]
    buffer_load_dwordx4 v[156:159], v83, s[8:11], s24 offen sc1
    v_mfma_f32_16x16x32_bf16 v[76:79], a[192:195], v[108:111], v[76:79]
    s_addk_i32 s24, 4096
    s_waitcnt vmcnt(8)
    v_mfma_f32_16x16x32_bf16 v[0:3], a[196:199], v[112:115], v[0:3]
    v_mfma_f32_16x16x32_bf16 v[4:7], a[200:203], v[112:115], v[4:7]
    v_mfma_f32_16x16x32_bf16 v[8:11], a[204:207], v[112:115], v[8:11]
    v_mfma_f32_16x16x32_bf16 v[12:15], a[208:211], v[112:115], v[12:15]
    v_mfma_f32_16x16x32_bf16 v[16:19], a[212:215], v[112:115], v[16:19]
    v_mfma_f32_16x16x32_bf16 v[20:23], a[196:199], v[116:119], v[20:23]
    v_mfma_f32_16x16x32_bf16 v[24:27], a[200:203], v[116:119], v[24:27]
    v_mfma_f32_16x16x32_bf16 v[28:31], a[204:207], v[116:119], v[28:31]
    v_mfma_f32_16x16x32_bf16 v[32:35], a[208:211], v[116:119], v[32:35]
    v_mfma_f32_16x16x32_bf16 v[36:39], a[212:215], v[116:119], v[36:39]
    v_mfma_f32_16x16x32_bf16 v[40:43], a[196:199], v[120:123], v[40:43]
    v_mfma_f32_16x16x32_bf16 v[44:47], a[200:203], v[120:123], v[44:47]
    v_mfma_f32_16x16x32_bf16 v[48:51], a[204:207], v[120:123], v[48:51]
    v_mfma_f32_16x16x32_bf16 v[52:55], a[208:211], v[120:123], v[52:55]
    v_mfma_f32_16x16x32_bf16 v[56:59], a[212:215], v[120:123], v[56:59]
    v_mfma_f32_16x16x32_bf16 v[60:63], a[196:199], v[124:127], v[60:63]
    buffer_load_dwordx4 v[96:99], v80, s[8:11], s24 offen sc1
    v_mfma_f32_16x16x32_bf16 v[64:67], a[200:203], v[124:127], v[64:67]
    buffer_load_dwordx4 v[100:103], v81, s[8:11], s24 offen sc1
    v_mfma_f32_16x16x32_bf16 v[68:71], a[204:207], v[124:127], v[68:71]
    buffer_load_dwordx4 v[104:107], v82, s[8:11], s24 offen sc1
    v_mfma_f32_16x16x32_bf16 v[72:75], a[208:211], v[124:127], v[72:75]
    buffer_load_dwordx4 v[108:111], v83, s[8:11], s24 offen sc1
    v_mfma_f32_16x16x32_bf16 v[76:79], a[212:215], v[124:127], v[76:79]
    s_addk_i32 s24, 4096
    s_waitcnt vmcnt(8)
    v_mfma_f32_16x16x32_bf16 v[0:3], v[160:163], v[128:131], v[0:3]
    v_mfma_f32_16x16x32_bf16 v[4:7], v[164:167], v[128:131], v[4:7]
    v_mfma_f32_16x16x32_bf16 v[8:11], v[168:171], v[128:131], v[8:11]
    v_mfma_f32_16x16x32_bf16 v[12:15], v[172:175], v[128:131], v[12:15]
    v_mfma_f32_16x16x32_bf16 v[16:19], v[176:179], v[128:131], v[16:19]
    v_mfma_f32_16x16x32_bf16 v[20:23], v[160:163], v[132:135], v[20:23]
    v_mfma_f32_16x16x32_bf16 v[24:27], v[164:167], v[132:135], v[24:27]
    v_mfma_f32_16x16x32_bf16 v[28:31], v[168:171], v[132:135], v[28:31]
    v_mfma_f32_16x16x32_bf16 v[32:35], v[172:175], v[132:135], v[32:35]
    v_mfma_f32_16x16x32_bf16 v[36:39], v[176:179], v[132:135], v[36:39]
    v_mfma_f32_16x16x32_bf16 v[40:43], v[160:163], v[136:139], v[40:43]
    v_mfma_f32_16x16x32_bf16 v[44:47], v[164:167], v[136:139], v[44:47]
    v_mfma_f32_16x16x32_bf16 v[48:51], v[168:171], v[136:139], v[48:51]
    v_mfma_f32_16x16x32_bf16 v[52:55], v[172:175], v[136:139], v[52:55]
    v_mfma_f32_16x16x32_bf16 v[56:59], v[176:179], v[136:139], v[56:59]
    v_mfma_f32_16x16x32_bf16 v[60:63], v[160:163], v[140:143], v[60:63]
    buffer_load_dwordx4 v[112:115], v80, s[8:11], s24 offen sc1
    v_mfma_f32_16x16x32_bf16 v[64:67], v[164:167], v[140:143], v[64:67]
    buffer_load_dwordx4 v[116:119], v81, s[8:11], s24 offen sc1
    v_mfma_f32_16x16x32_bf16 v[68:71], v[168:171], v[140:143], v[68:71]
    buffer_load_dwordx4 v[120:123], v82, s[8:11], s24 offen sc1
    v_mfma_f32_16x16x32_bf16 v[72:75], v[172:175], v[140:143], v[72:75]
    buffer_load_dwordx4 v[124:127], v83, s[8:11], s24 offen sc1
    v_mfma_f32_16x16x32_bf16 v[76:79], v[176:179], v[140:143], v[76:79]
    s_addk_i32 s24, 4096
    s_waitcnt vmcnt(8)
    v_mfma_f32_16x16x32_bf16 v[0:3], v[180:183], v[144:147], v[0:3]
    v_mfma_f32_16x16x32_bf16 v[4:7], v[184:187], v[144:147], v[4:7]
    v_mfma_f32_16x16x32_bf16 v[8:11], v[188:191], v[144:147], v[8:11]
    v_mfma_f32_16x16x32_bf16 v[12:15], v[192:195], v[144:147], v[12:15]
    v_mfma_f32_16x16x32_bf16 v[16:19], v[196:199], v[144:147], v[16:19]
    v_mfma_f32_16x16x32_bf16 v[20:23], v[180:183], v[148:151], v[20:23]
    v_mfma_f32_16x16x32_bf16 v[24:27], v[184:187], v[148:151], v[24:27]
    v_mfma_f32_16x16x32_bf16 v[28:31], v[188:191], v[148:151], v[28:31]
    v_mfma_f32_16x16x32_bf16 v[32:35], v[192:195], v[148:151], v[32:35]
    v_mfma_f32_16x16x32_bf16 v[36:39], v[196:199], v[148:151], v[36:39]
    v_mfma_f32_16x16x32_bf16 v[40:43], v[180:183], v[152:155], v[40:43]
    v_mfma_f32_16x16x32_bf16 v[44:47], v[184:187], v[152:155], v[44:47]
    v_mfma_f32_16x16x32_bf16 v[48:51], v[188:191], v[152:155], v[48:51]
    v_mfma_f32_16x16x32_bf16 v[52:55], v[192:195], v[152:155], v[52:55]
    v_mfma_f32_16x16x32_bf16 v[56:59], v[196:199], v[152:155], v[56:59]
    v_mfma_f32_16x16x32_bf16 v[60:63], v[180:183], v[156:159], v[60:63]
    buffer_load_dwordx4 v[128:131], v80, s[8:11], s24 offen sc1
    v_mfma_f32_16x16x32_bf16 v[64:67], v[184:187], v[156:159], v[64:67]
    buffer_load_dwordx4 v[132:135], v81, s[8:11], s24 offen sc1
    v_mfma_f32_16x16x32_bf16 v[68:71], v[188:191], v[156:159], v[68:71]
    buffer_load_dwordx4 v[136:139], v82, s[8:11], s24 offen sc1
    v_mfma_f32_16x16x32_bf16 v[72:75], v[192:195], v[156:159], v[72:75]
    buffer_load_dwordx4 v[140:143], v83, s[8:11], s24 offen sc1
    v_mfma_f32_16x16x32_bf16 v[76:79], v[196:199], v[156:159], v[76:79]
    s_addk_i32 s24, 4096
    s_waitcnt vmcnt(8)
    v_mfma_f32_16x16x32_bf16 v[0:3], v[200:203], v[96:99], v[0:3]
    v_mfma_f32_16x16x32_bf16 v[4:7], v[204:207], v[96:99], v[4:7]
    v_mfma_f32_16x16x32_bf16 v[8:11], v[208:211], v[96:99], v[8:11]
    v_mfma_f32_16x16x32_bf16 v[12:15], v[212:215], v[96:99], v[12:15]
    v_mfma_f32_16x16x32_bf16 v[16:19], v[216:219], v[96:99], v[16:19]
    v_mfma_f32_16x16x32_bf16 v[20:23], v[200:203], v[100:103], v[20:23]
    v_mfma_f32_16x16x32_bf16 v[24:27], v[204:207], v[100:103], v[24:27]
    v_mfma_f32_16x16x32_bf16 v[28:31], v[208:211], v[100:103], v[28:31]
    v_mfma_f32_16x16x32_bf16 v[32:35], v[212:215], v[100:103], v[32:35]
    v_mfma_f32_16x16x32_bf16 v[36:39], v[216:219], v[100:103], v[36:39]
    v_mfma_f32_16x16x32_bf16 v[40:43], v[200:203], v[104:107], v[40:43]
    v_mfma_f32_16x16x32_bf16 v[44:47], v[204:207], v[104:107], v[44:47]
    v_mfma_f32_16x16x32_bf16 v[48:51], v[208:211], v[104:107], v[48:51]
    v_mfma_f32_16x16x32_bf16 v[52:55], v[212:215], v[104:107], v[52:55]
    v_mfma_f32_16x16x32_bf16 v[56:59], v[216:219], v[104:107], v[56:59]
    v_mfma_f32_16x16x32_bf16 v[60:63], v[200:203], v[108:111], v[60:63]
    buffer_load_dwordx4 v[144:147], v80, s[8:11], s24 offen sc1
    v_mfma_f32_16x16x32_bf16 v[64:67], v[204:207], v[108:111], v[64:67]
    buffer_load_dwordx4 v[148:151], v81, s[8:11], s24 offen sc1
    v_mfma_f32_16x16x32_bf16 v[68:71], v[208:211], v[108:111], v[68:71]
    buffer_load_dwordx4 v[152:155], v82, s[8:11], s24 offen sc1
    v_mfma_f32_16x16x32_bf16 v[72:75], v[212:215], v[108:111], v[72:75]
    buffer_load_dwordx4 v[156:159], v83, s[8:11], s24 offen sc1
    v_mfma_f32_16x16x32_bf16 v[76:79], v[216:219], v[108:111], v[76:79]
    s_addk_i32 s24, 4096
    s_waitcnt vmcnt(8)
    v_mfma_f32_16x16x32_bf16 v[0:3], a[0:3], v[112:115], v[0:3]
    v_mfma_f32_16x16x32_bf16 v[4:7], a[4:7], v[112:115], v[4:7]
    v_mfma_f32_16x16x32_bf16 v[8:11], a[8:11], v[112:115], v[8:11]
    v_mfma_f32_16x16x32_bf16 v[12:15], a[12:15], v[112:115], v[12:15]
    v_mfma_f32_16x16x32_bf16 v[16:19], a[16:19], v[112:115], v[16:19]
    v_mfma_f32_16x16x32_bf16 v[20:23], a[0:3], v[116:119], v[20:23]
    v_mfma_f32_16x16x32_bf16 v[24:27], a[4:7], v[116:119], v[24:27]
    v_mfma_f32_16x16x32_bf16 v[28:31], a[8:11], v[116:119], v[28:31]
    v_mfma_f32_16x16x32_bf16 v[32:35], a[12:15], v[116:119], v[32:35]
    v_mfma_f32_16x16x32_bf16 v[36:39], a[16:19], v[116:119], v[36:39]
    v_mfma_f32_16x16x32_bf16 v[40:43], a[0:3], v[120:123], v[40:43]
    v_mfma_f32_16x16x32_bf16 v[44:47], a[4:7], v[120:123], v[44:47]
    v_mfma_f32_16x16x32_bf16 v[48:51], a[8:11], v[120:123], v[48:51]
    v_mfma_f32_16x16x32_bf16 v[52:55], a[12:15], v[120:123], v[52:55]
    v_mfma_f32_16x16x32_bf16 v[56:59], a[16:19], v[120:123], v[56:59]
    v_mfma_f32_16x16x32_bf16 v[60:63], a[0:3], v[124:127], v[60:63]
    buffer_load_dwordx4 v[96:99], v80, s[8:11], s24 offen sc1
    v_mfma_f32_16x16x32_bf16 v[64:67], a[4:7], v[124:127], v[64:67]
    buffer_load_dwordx4 v[100:103], v81, s[8:11], s24 offen sc1
    v_mfma_f32_16x16x32_bf16 v[68:71], a[8:11], v[124:127], v[68:71]
    buffer_load_dwordx4 v[104:107], v82, s[8:11], s24 offen sc1
    v_mfma_f32_16x16x32_bf16 v[72:75], a[12:15], v[124:127], v[72:75]
    buffer_load_dwordx4 v[108:111], v83, s[8:11], s24 offen sc1
    v_mfma_f32_16x16x32_bf16 v[76:79], a[16:19], v[124:127], v[76:79]
    s_addk_i32 s24, 4096
    s_waitcnt vmcnt(8)
    v_mfma_f32_16x16x32_bf16 v[0:3], a[20:23], v[128:131], v[0:3]
    v_mfma_f32_16x16x32_bf16 v[4:7], a[24:27], v[128:131], v[4:7]
    v_mfma_f32_16x16x32_bf16 v[8:11], a[28:31], v[128:131], v[8:11]
    v_mfma_f32_16x16x32_bf16 v[12:15], a[32:35], v[128:131], v[12:15]
    v_mfma_f32_16x16x32_bf16 v[16:19], a[36:39], v[128:131], v[16:19]
    v_mfma_f32_16x16x32_bf16 v[20:23], a[20:23], v[132:135], v[20:23]
    v_mfma_f32_16x16x32_bf16 v[24:27], a[24:27], v[132:135], v[24:27]
    v_mfma_f32_16x16x32_bf16 v[28:31], a[28:31], v[132:135], v[28:31]
    v_mfma_f32_16x16x32_bf16 v[32:35], a[32:35], v[132:135], v[32:35]
    v_mfma_f32_16x16x32_bf16 v[36:39], a[36:39], v[132:135], v[36:39]
    v_mfma_f32_16x16x32_bf16 v[40:43], a[20:23], v[136:139], v[40:43]
    v_mfma_f32_16x16x32_bf16 v[44:47], a[24:27], v[136:139], v[44:47]
    v_mfma_f32_16x16x32_bf16 v[48:51], a[28:31], v[136:139], v[48:51]
    v_mfma_f32_16x16x32_bf16 v[52:55], a[32:35], v[136:139], v[52:55]
    v_mfma_f32_16x16x32_bf16 v[56:59], a[36:39], v[136:139], v[56:59]
    v_mfma_f32_16x16x32_bf16 v[60:63], a[20:23], v[140:143], v[60:63]
    buffer_load_dwordx4 v[112:115], v80, s[8:11], s24 offen sc1
    v_mfma_f32_16x16x32_bf16 v[64:67], a[24:27], v[140:143], v[64:67]
    buffer_load_dwordx4 v[116:119], v81, s[8:11], s24 offen sc1
    v_mfma_f32_16x16x32_bf16 v[68:71], a[28:31], v[140:143], v[68:71]
    buffer_load_dwordx4 v[120:123], v82, s[8:11], s24 offen sc1
    v_mfma_f32_16x16x32_bf16 v[72:75], a[32:35], v[140:143], v[72:75]
    buffer_load_dwordx4 v[124:127], v83, s[8:11], s24 offen sc1
    v_mfma_f32_16x16x32_bf16 v[76:79], a[36:39], v[140:143], v[76:79]
    s_addk_i32 s24, 4096
    s_waitcnt vmcnt(8)
    v_mfma_f32_16x16x32_bf16 v[0:3], a[40:43], v[144:147], v[0:3]
    v_mfma_f32_16x16x32_bf16 v[4:7], a[44:47], v[144:147], v[4:7]
    v_mfma_f32_16x16x32_bf16 v[8:11], a[48:51], v[144:147], v[8:11]
    v_mfma_f32_16x16x32_bf16 v[12:15], a[52:55], v[144:147], v[12:15]
    v_mfma_f32_16x16x32_bf16 v[16:19], a[56:59], v[144:147], v[16:19]
    v_mfma_f32_16x16x32_bf16 v[20:23], a[40:43], v[148:151], v[20:23]
    v_mfma_f32_16x16x32_bf16 v[24:27], a[44:47], v[148:151], v[24:27]
    v_mfma_f32_16x16x32_bf16 v[28:31], a[48:51], v[148:151], v[28:31]
    v_mfma_f32_16x16x32_bf16 v[32:35], a[52:55], v[148:151], v[32:35]
    v_mfma_f32_16x16x32_bf16 v[36:39], a[56:59], v[148:151], v[36:39]
    v_mfma_f32_16x16x32_bf16 v[40:43], a[40:43], v[152:155], v[40:43]
    v_mfma_f32_16x16x32_bf16 v[44:47], a[44:47], v[152:155], v[44:47]
    v_mfma_f32_16x16x32_bf16 v[48:51], a[48:51], v[152:155], v[48:51]
    v_mfma_f32_16x16x32_bf16 v[52:55], a[52:55], v[152:155], v[52:55]
    v_mfma_f32_16x16x32_bf16 v[56:59], a[56:59], v[152:155], v[56:59]
    v_mfma_f32_16x16x32_bf16 v[60:63], a[40:43], v[156:159], v[60:63]
    v_mfma_f32_16x16x32_bf16 v[64:67], a[44:47], v[156:159], v[64:67]
    v_mfma_f32_16x16x32_bf16 v[68:71], a[48:51], v[156:159], v[68:71]
    v_mfma_f32_16x16x32_bf16 v[72:75], a[52:55], v[156:159], v[72:75]
    v_mfma_f32_16x16x32_bf16 v[76:79], a[56:59], v[156:159], v[76:79]
    s_waitcnt vmcnt(4)
    v_mfma_f32_16x16x32_bf16 v[0:3], a[60:63], v[96:99], v[0:3]
    v_mfma_f32_16x16x32_bf16 v[4:7], a[64:67], v[96:99], v[4:7]
    v_mfma_f32_16x16x32_bf16 v[8:11], a[68:71], v[96:99], v[8:11]
    v_mfma_f32_16x16x32_bf16 v[12:15], a[72:75], v[96:99], v[12:15]
    v_mfma_f32_16x16x32_bf16 v[16:19], a[76:79], v[96:99], v[16:19]
    v_mfma_f32_16x16x32_bf16 v[20:23], a[60:63], v[100:103], v[20:23]
    v_mfma_f32_16x16x32_bf16 v[24:27], a[64:67], v[100:103], v[24:27]
    v_mfma_f32_16x16x32_bf16 v[28:31], a[68:71], v[100:103], v[28:31]
    v_mfma_f32_16x16x32_bf16 v[32:35], a[72:75], v[100:103], v[32:35]
    v_mfma_f32_16x16x32_bf16 v[36:39], a[76:79], v[100:103], v[36:39]
    v_mfma_f32_16x16x32_bf16 v[40:43], a[60:63], v[104:107], v[40:43]
    v_mfma_f32_16x16x32_bf16 v[44:47], a[64:67], v[104:107], v[44:47]
    v_mfma_f32_16x16x32_bf16 v[48:51], a[68:71], v[104:107], v[48:51]
    v_mfma_f32_16x16x32_bf16 v[52:55], a[72:75], v[104:107], v[52:55]
    v_mfma_f32_16x16x32_bf16 v[56:59], a[76:79], v[104:107], v[56:59]
    v_mfma_f32_16x16x32_bf16 v[60:63], a[60:63], v[108:111], v[60:63]
    v_mfma_f32_16x16x32_bf16 v[64:67], a[64:67], v[108:111], v[64:67]
    v_mfma_f32_16x16x32_bf16 v[68:71], a[68:71], v[108:111], v[68:71]
    v_mfma_f32_16x16x32_bf16 v[72:75], a[72:75], v[108:111], v[72:75]
    v_mfma_f32_16x16x32_bf16 v[76:79], a[76:79], v[108:111], v[76:79]
    s_waitcnt vmcnt(0)
    v_mfma_f32_16x16x32_bf16 v[20:23], a[80:83], v[116:119], v[20:23]
    v_mfma_f32_16x16x32_bf16 v[24:27], a[84:87], v[116:119], v[24:27]
    v_mfma_f32_16x16x32_bf16 v[28:31], a[88:91], v[116:119], v[28:31]
    v_mfma_f32_16x16x32_bf16 v[32:35], a[92:95], v[116:119], v[32:35]
    v_mfma_f32_16x16x32_bf16 v[36:39], a[216:219], v[116:119], v[36:39]
    v_mfma_f32_16x16x32_bf16 v[40:43], a[80:83], v[120:123], v[40:43]
    v_mfma_f32_16x16x32_bf16 v[44:47], a[84:87], v[120:123], v[44:47]
    v_mfma_f32_16x16x32_bf16 v[48:51], a[88:91], v[120:123], v[48:51]
    v_mfma_f32_16x16x32_bf16 v[52:55], a[92:95], v[120:123], v[52:55]
    v_mfma_f32_16x16x32_bf16 v[56:59], a[216:219], v[120:123], v[56:59]
    ds_write_b128 v84, v[20:23] offset:0
    v_mfma_f32_16x16x32_bf16 v[60:63], a[80:83], v[124:127], v[60:63]
    ds_write_b128 v84, v[24:27] offset:1024
    v_mfma_f32_16x16x32_bf16 v[64:67], a[84:87], v[124:127], v[64:67]
    ds_write_b128 v84, v[28:31] offset:2048
    v_mfma_f32_16x16x32_bf16 v[68:71], a[88:91], v[124:127], v[68:71]
    ds_write_b128 v84, v[32:35] offset:3072
    v_mfma_f32_16x16x32_bf16 v[72:75], a[92:95], v[124:127], v[72:75]
    ds_write_b128 v84, v[36:39] offset:4096
    v_mfma_f32_16x16x32_bf16 v[76:79], a[216:219], v[124:127], v[76:79]
    ds_write_b128 v85, v[40:43] offset:0
    v_mfma_f32_16x16x32_bf16 v[0:3], a[80:83], v[112:115], v[0:3]
    ds_write_b128 v85, v[44:47] offset:1024
    v_mfma_f32_16x16x32_bf16 v[4:7], a[84:87], v[112:115], v[4:7]
    ds_write_b128 v85, v[48:51] offset:2048
    v_mfma_f32_16x16x32_bf16 v[8:11], a[88:91], v[112:115], v[8:11]
    ds_write_b128 v85, v[52:55] offset:3072
    v_mfma_f32_16x16x32_bf16 v[12:15], a[92:95], v[112:115], v[12:15]
    ds_write_b128 v85, v[56:59] offset:4096
    v_mfma_f32_16x16x32_bf16 v[16:19], a[216:219], v[112:115], v[16:19]
    ds_write_b128 v86, v[60:63] offset:0
    ds_write_b128 v86, v[64:67] offset:1024
    ds_write_b128 v86, v[68:71] offset:2048
    ds_write_b128 v86, v[72:75] offset:3072
    ds_write_b128 v86, v[76:79] offset:4096
    s_waitcnt lgkmcnt(0)
    s_barrier
    ds_read_b128 v[20:23], v87 offset:0
    ds_read_b128 v[24:27], v87 offset:1024
    ds_read_b128 v[28:31], v87 offset:2048
    ds_read_b128 v[32:35], v87 offset:3072
    ds_read_b128 v[36:39], v87 offset:4096
    ds_read_b128 v[40:43], v87 offset:5120
    ds_read_b128 v[44:47], v87 offset:6144
    ds_read_b128 v[48:51], v87 offset:7168
    ds_read_b128 v[52:55], v87 offset:8192
    ds_read_b128 v[56:59], v87 offset:9216
    ds_read_b128 v[60:63], v87 offset:10240
    ds_read_b128 v[64:67], v87 offset:11264
    ds_read_b128 v[68:71], v87 offset:12288
    ds_read_b128 v[72:75], v87 offset:13312
    ds_read_b128 v[76:79], v87 offset:14336
    s_waitcnt lgkmcnt(14)
    v_pk_add_f32 v[0:1], v[0:1], v[20:21]
    v_pk_add_f32 v[2:3], v[2:3], v[22:23]
    s_waitcnt lgkmcnt(13)
    v_pk_add_f32 v[4:5], v[4:5], v[24:25]
    v_pk_add_f32 v[6:7], v[6:7], v[26:27]
    s_waitcnt lgkmcnt(12)
    v_pk_add_f32 v[8:9], v[8:9], v[28:29]
    v_pk_add_f32 v[10:11], v[10:11], v[30:31]
    s_waitcnt lgkmcnt(11)
    v_pk_add_f32 v[12:13], v[12:13], v[32:33]
    v_pk_add_f32 v[14:15], v[14:15], v[34:35]
    s_waitcnt lgkmcnt(10)
    v_pk_add_f32 v[16:17], v[16:17], v[36:37]
    v_pk_add_f32 v[18:19], v[18:19], v[38:39]
    s_waitcnt lgkmcnt(4)
    v_pk_add_f32 v[40:41], v[40:41], v[60:61]
    v_pk_add_f32 v[42:43], v[42:43], v[62:63]
    s_waitcnt lgkmcnt(3)
    v_pk_add_f32 v[44:45], v[44:45], v[64:65]
    v_pk_add_f32 v[46:47], v[46:47], v[66:67]
    s_waitcnt lgkmcnt(2)
    v_pk_add_f32 v[48:49], v[48:49], v[68:69]
    v_pk_add_f32 v[50:51], v[50:51], v[70:71]
    s_waitcnt lgkmcnt(1)
    v_pk_add_f32 v[52:53], v[52:53], v[72:73]
    v_pk_add_f32 v[54:55], v[54:55], v[74:75]
    s_waitcnt lgkmcnt(0)
    v_pk_add_f32 v[56:57], v[56:57], v[76:77]
    v_pk_add_f32 v[58:59], v[58:59], v[78:79]
    v_pk_add_f32 v[0:1], v[0:1], v[40:41]
    v_pk_add_f32 v[2:3], v[2:3], v[42:43]
    v_pk_add_f32 v[4:5], v[4:5], v[44:45]
    v_pk_add_f32 v[6:7], v[6:7], v[46:47]
    v_pk_add_f32 v[8:9], v[8:9], v[48:49]
    v_pk_add_f32 v[10:11], v[10:11], v[50:51]
    v_pk_add_f32 v[12:13], v[12:13], v[52:53]
    v_pk_add_f32 v[14:15], v[14:15], v[54:55]
    v_pk_add_f32 v[16:17], v[16:17], v[56:57]
    v_pk_add_f32 v[18:19], v[18:19], v[58:59]
    v_lshlrev_b32_e64 v40, 16, v240
    v_and_b32 v41, 0xffff0000, v240
    v_pk_fma_f32 v[40:41], v[220:221], v[0:1], v[40:41]
    v_cvt_pk_bf16_f32 v20, v40, v41
    v_lshlrev_b32_e64 v40, 16, v241
    v_and_b32 v41, 0xffff0000, v241
    v_pk_fma_f32 v[40:41], v[222:223], v[2:3], v[40:41]
    v_cvt_pk_bf16_f32 v21, v40, v41
    v_lshlrev_b32_e64 v40, 16, v242
    v_and_b32 v41, 0xffff0000, v242
    v_pk_fma_f32 v[40:41], v[224:225], v[4:5], v[40:41]
    v_cvt_pk_bf16_f32 v22, v40, v41
    v_lshlrev_b32_e64 v40, 16, v243
    v_and_b32 v41, 0xffff0000, v243
    v_pk_fma_f32 v[40:41], v[226:227], v[6:7], v[40:41]
    v_cvt_pk_bf16_f32 v23, v40, v41
    v_lshlrev_b32_e64 v40, 16, v244
    v_and_b32 v41, 0xffff0000, v244
    v_pk_fma_f32 v[40:41], v[228:229], v[8:9], v[40:41]
    v_cvt_pk_bf16_f32 v24, v40, v41
    v_lshlrev_b32_e64 v40, 16, v245
    v_and_b32 v41, 0xffff0000, v245
    v_pk_fma_f32 v[40:41], v[230:231], v[10:11], v[40:41]
    v_cvt_pk_bf16_f32 v25, v40, v41
    v_lshlrev_b32_e64 v40, 16, v246
    v_and_b32 v41, 0xffff0000, v246
    v_pk_fma_f32 v[40:41], v[232:233], v[12:13], v[40:41]
    v_cvt_pk_bf16_f32 v26, v40, v41
    v_lshlrev_b32_e64 v40, 16, v247
    v_and_b32 v41, 0xffff0000, v247
    v_pk_fma_f32 v[40:41], v[234:235], v[14:15], v[40:41]
    v_cvt_pk_bf16_f32 v27, v40, v41
    v_lshlrev_b32_e64 v40, 16, v248
    v_and_b32 v41, 0xffff0000, v248
    v_pk_fma_f32 v[40:41], v[236:237], v[16:17], v[40:41]
    v_cvt_pk_bf16_f32 v28, v40, v41
    v_lshlrev_b32_e64 v40, 16, v249
    v_and_b32 v41, 0xffff0000, v249
    v_pk_fma_f32 v[40:41], v[238:239], v[18:19], v[40:41]
    v_cvt_pk_bf16_f32 v29, v40, v41
    v_permlane16_swap_b32 v20, v22
    v_permlane16_swap_b32 v21, v23
    v_permlane16_swap_b32 v24, v26
    v_permlane16_swap_b32 v25, v27
    buffer_store_dwordx4 v[20:23], v90, s[20:23], 0 offen
    buffer_store_dwordx4 v[24:27], v90, s[20:23], 0 offen offset:64
    buffer_store_dwordx2 v[28:29], v250, s[20:23], 0 offen offset:128
L_end:
    s_endpgm
L_switch:
    v_mbcnt_lo_u32_b32 v240, -1, 0
    v_mbcnt_hi_u32_b32 v240, -1, v240
    v_lshrrev_b32 v241, 4, v240
    v_and_b32 v242, 15, v240
    v_lshlrev_b32 v240, 2, v241
    v_xor_b32 v242, v240, v242
    v_lshlrev_b32 v242, 4, v242
    v_lshl_add_u32 v242, v241, 8, v242
    s_lshl_b32 s61, s60, 11
    s_addk_i32 s61, 4096
    v_add_u32 v248, s61, v242
    v_subrev_u32 v249, 16, v248
    v_mov_b32_e64 v250, v248
    v_mov_b32 v251, v249
    s_mov_b32 s28, s8
    s_mov_b32 s29, s9
    s_mov_b32 s30, s10
    s_mov_b32 s32, s12
    s_mov_b32 s33, s13
    s_mov_b32 s34, 0
    s_mov_b32 s36, 0
    s_mov_b32 s37, 8192
    s_branch L_qp
L_exact:
    s_waitcnt vmcnt(0) lgkmcnt(0)
    s_nop 15
    s_lshl_b32 s61, s45, 19
    s_add_u32 s61, s61, 393216
    s_add_u32 s8, s66, s61
    s_addc_u32 s9, s67, 0
    s_mov_b32 s10, 131072
    s_mov_b32 s11, 0x00020000
    s_add_u32 s12, s68, s61
    s_addc_u32 s13, s69, 0
    s_mov_b32 s14, 131072
    s_mov_b32 s15, 0x00020000
    v_mbcnt_lo_u32_b32 v156, -1, 0
    v_mbcnt_hi_u32_b32 v156, -1, v156
    v_and_b32 v157, 31, v156
    v_lshlrev_b32 v157, 8, v157
    v_lshrrev_b32_e64 v164, 5, v156
    v_lshl_add_u32 v157, v164, 4, v157
    v_lshrrev_b32 v165, 4, v156
    v_and_b32 v158, 15, v156
    v_lshlrev_b32 v166, 2, v165
    v_xor_b32 v158, v166, v158
    v_lshlrev_b32_e64 v158, 4, v158
    v_lshl_add_u32 v158, v165, 8, v158
    s_add_u32 s61, s51, 143360
    s_mov_b32 m0, s61
    v_lshlrev_b32 v164, 10, v164
    v_bfe_u32 v166, v156, 2, 2
    v_lshl_add_u32 v164, v166, 8, v164
    v_and_b32_e64 v165, 1, v165
    v_lshl_add_u32 v164, v165, 5, v164
    v_and_b32_e64 v165, 3, v156
    v_lshl_add_u32 v164, v165, 3, v164
    v_add_u32 v164, s61, v164
    v_xor_b32 v165, 0, v166
    v_lshl_add_u32 v160, v165, 6, v164
    v_xor_b32_e64 v165, 1, v166
    v_lshl_add_u32 v161, v165, 6, v164
    v_xor_b32_e64 v165, 2, v166
    v_lshl_add_u32 v162, v165, 6, v164
    v_xor_b32 v165, 3, v166
    v_lshl_add_u32 v163, v165, 6, v164
    v_mov_b32 v164, 0xff800000
    v_mov_b32 v166, 0xff800000
    s_mov_b32 s36, 0
L_ex1:
    buffer_load_dwordx4 a[192:195], v157, s[8:11], s36 offen offset:0
    buffer_load_dwordx4 a[196:199], v157, s[8:11], s36 offen offset:32
    buffer_load_dwordx4 a[200:203], v157, s[8:11], s36 offen offset:64
    buffer_load_dwordx4 a[204:207], v157, s[8:11], s36 offen offset:96
    buffer_load_dwordx4 a[208:211], v157, s[8:11], s36 offen offset:128
    buffer_load_dwordx4 a[212:215], v157, s[8:11], s36 offen offset:160
    buffer_load_dwordx4 a[216:219], v157, s[8:11], s36 offen offset:192
    buffer_load_dwordx4 a[220:223], v157, s[8:11], s36 offen offset:224
    s_waitcnt vmcnt(0)
    v_mfma_f32_32x32x16_bf16 v[64:79], a[192:195], v[0:3], 0
    v_mfma_f32_32x32x16_bf16 v[80:95], a[192:195], v[8:11], 0
    v_mfma_f32_32x32x16_bf16 v[64:79], a[196:199], v[4:7], v[64:79]
    v_mfma_f32_32x32x16_bf16 v[80:95], a[196:199], v[12:15], v[80:95]
    v_mfma_f32_32x32x16_bf16 v[64:79], a[200:203], v[16:19], v[64:79]
    v_mfma_f32_32x32x16_bf16 v[80:95], a[200:203], v[24:27], v[80:95]
    v_mfma_f32_32x32x16_bf16 v[64:79], a[204:207], v[20:23], v[64:79]
    v_mfma_f32_32x32x16_bf16 v[80:95], a[204:207], v[28:31], v[80:95]
    v_mfma_f32_32x32x16_bf16 v[64:79], a[208:211], v[32:35], v[64:79]
    v_mfma_f32_32x32x16_bf16 v[80:95], a[208:211], v[40:43], v[80:95]
    v_mfma_f32_32x32x16_bf16 v[64:79], a[212:215], v[36:39], v[64:79]
    v_mfma_f32_32x32x16_bf16 v[80:95], a[212:215], v[44:47], v[80:95]
    v_mfma_f32_32x32x16_bf16 v[64:79], a[216:219], v[48:51], v[64:79]
    v_mfma_f32_32x32x16_bf16 v[80:95], a[216:219], v[56:59], v[80:95]
    v_mfma_f32_32x32x16_bf16 v[64:79], a[220:223], v[52:55], v[64:79]
    v_mfma_f32_32x32x16_bf16 v[80:95], a[220:223], v[60:63], v[80:95]
    s_nop 10
    v_max3_f32 v164, v164, v64, v65
    v_max3_f32 v164, v164, v66, v67
    v_max3_f32 v164, v164, v68, v69
    v_max3_f32 v164, v164, v70, v71
    v_max3_f32 v164, v164, v72, v73
    v_max3_f32 v164, v164, v74, v75
    v_max3_f32 v164, v164, v76, v77
    v_max3_f32 v164, v164, v78, v79
    v_max3_f32 v166, v166, v80, v81
    v_max3_f32 v166, v166, v82, v83
    v_max3_f32 v166, v166, v84, v85
    v_max3_f32 v166, v166, v86, v87
    v_max3_f32 v166, v166, v88, v89
    v_max3_f32 v166, v166, v90, v91
    v_max3_f32 v166, v166, v92, v93
    v_max3_f32 v166, v166, v94, v95
    s_add_u32 s36, s36, 8192
    s_cmp_lt_u32 s36, 131072
    s_cbranch_scc1 L_ex1
    v_mov_b32 v165, v164
    s_nop 1
    v_permlane32_swap_b32 v164, v165
    v_max_f32 v164, v164, v165
    v_sub_f32 v192, 0, v164
    v_sub_f32 v193, 0, v164
    v_sub_f32 v194, 0, v164
    v_sub_f32 v195, 0, v164
    v_sub_f32 v196, 0, v164
    v_sub_f32 v197, 0, v164
    v_sub_f32 v198, 0, v164
    v_sub_f32 v199, 0, v164
    v_sub_f32 v200, 0, v164
    v_sub_f32 v201, 0, v164
    v_sub_f32 v202, 0, v164
    v_sub_f32 v203, 0, v164
    v_sub_f32 v204, 0, v164
    v_sub_f32 v205, 0, v164
    v_sub_f32 v206, 0, v164
    v_sub_f32 v207, 0, v164
    v_mov_b32 v167, v166
    s_nop 1
    v_permlane32_swap_b32 v166, v167
    v_max_f32 v166, v166, v167
    v_sub_f32 v208, 0, v166
    v_sub_f32 v209, 0, v166
    v_sub_f32 v210, 0, v166
    v_sub_f32 v211, 0, v166
    v_sub_f32 v212, 0, v166
    v_sub_f32 v213, 0, v166
    v_sub_f32 v214, 0, v166
    v_sub_f32 v215, 0, v166
    v_sub_f32 v216, 0, v166
    v_sub_f32 v217, 0, v166
    v_sub_f32 v218, 0, v166
    v_sub_f32 v219, 0, v166
    v_sub_f32 v220, 0, v166
    v_sub_f32 v221, 0, v166
    v_sub_f32 v222, 0, v166
    v_sub_f32_e64 v223, 0, v166
    v_accvgpr_write_b32 a0, 0
    v_accvgpr_write_b32 a1, 0
    v_accvgpr_write_b32 a2, 0
    v_accvgpr_write_b32 a3, 0
    v_accvgpr_write_b32 a4, 0
    v_accvgpr_write_b32 a5, 0
    v_accvgpr_write_b32 a6, 0
    v_accvgpr_write_b32 a7, 0
    v_accvgpr_write_b32 a8, 0
    v_accvgpr_write_b32 a9, 0
    v_accvgpr_write_b32 a10, 0
    v_accvgpr_write_b32 a11, 0
    v_accvgpr_write_b32 a12, 0
    v_accvgpr_write_b32 a13, 0
    v_accvgpr_write_b32 a14, 0
    v_accvgpr_write_b32 a15, 0
    v_accvgpr_write_b32 a16, 0
    v_accvgpr_write_b32 a17, 0
    v_accvgpr_write_b32 a18, 0
    v_accvgpr_write_b32 a19, 0
    v_accvgpr_write_b32 a20, 0
    v_accvgpr_write_b32 a21, 0
    v_accvgpr_write_b32 a22, 0
    v_accvgpr_write_b32 a23, 0
    v_accvgpr_write_b32 a24, 0
    v_accvgpr_write_b32 a25, 0
    v_accvgpr_write_b32 a26, 0
    v_accvgpr_write_b32 a27, 0
    v_accvgpr_write_b32 a28, 0
    v_accvgpr_write_b32 a29, 0
    v_accvgpr_write_b32 a30, 0
    v_accvgpr_write_b32 a31, 0
    v_accvgpr_write_b32 a32, 0
    v_accvgpr_write_b32 a33, 0
    v_accvgpr_write_b32 a34, 0
    v_accvgpr_write_b32 a35, 0
    v_accvgpr_write_b32 a36, 0
    v_accvgpr_write_b32 a37, 0
    v_accvgpr_write_b32 a38, 0
    v_accvgpr_write_b32 a39, 0
    v_accvgpr_write_b32 a40, 0
    v_accvgpr_write_b32 a41, 0
    v_accvgpr_write_b32 a42, 0
    v_accvgpr_write_b32 a43, 0
    v_accvgpr_write_b32 a44, 0
    v_accvgpr_write_b32 a45, 0
    v_accvgpr_write_b32 a46, 0
    v_accvgpr_write_b32 a47, 0
    v_accvgpr_write_b32 a48, 0
    v_accvgpr_write_b32 a49, 0
    v_accvgpr_write_b32 a50, 0
    v_accvgpr_write_b32 a51, 0
    v_accvgpr_write_b32 a52, 0
    v_accvgpr_write_b32 a53, 0
    v_accvgpr_write_b32 a54, 0
    v_accvgpr_write_b32 a55, 0
    v_accvgpr_write_b32 a56, 0
    v_accvgpr_write_b32 a57, 0
    v_accvgpr_write_b32 a58, 0
    v_accvgpr_write_b32 a59, 0
    v_accvgpr_write_b32 a60, 0
    v_accvgpr_write_b32 a61, 0
    v_accvgpr_write_b32 a62, 0
    v_accvgpr_write_b32 a63, 0
    v_accvgpr_write_b32 a64, 0
    v_accvgpr_write_b32 a65, 0
    v_accvgpr_write_b32 a66, 0
    v_accvgpr_write_b32 a67, 0
    v_accvgpr_write_b32 a68, 0
    v_accvgpr_write_b32 a69, 0
    v_accvgpr_write_b32 a70, 0
    v_accvgpr_write_b32 a71, 0
    v_accvgpr_write_b32 a72, 0
    v_accvgpr_write_b32 a73, 0
    v_accvgpr_write_b32 a74, 0
    v_accvgpr_write_b32 a75, 0
    v_accvgpr_write_b32 a76, 0
    v_accvgpr_write_b32 a77, 0
    v_accvgpr_write_b32 a78, 0
    v_accvgpr_write_b32 a79, 0
    v_accvgpr_write_b32 a80, 0
    v_accvgpr_write_b32 a81, 0
    v_accvgpr_write_b32 a82, 0
    v_accvgpr_write_b32 a83, 0
    v_accvgpr_write_b32 a84, 0
    v_accvgpr_write_b32 a85, 0
    v_accvgpr_write_b32 a86, 0
    v_accvgpr_write_b32 a87, 0
    v_accvgpr_write_b32 a88, 0
    v_accvgpr_write_b32 a89, 0
    v_accvgpr_write_b32 a90, 0
    v_accvgpr_write_b32 a91, 0
    v_accvgpr_write_b32 a92, 0
    v_accvgpr_write_b32 a93, 0
    v_accvgpr_write_b32 a94, 0
    v_accvgpr_write_b32 a95, 0
    v_accvgpr_write_b32 a96, 0
    v_accvgpr_write_b32 a97, 0
    v_accvgpr_write_b32 a98, 0
    v_accvgpr_write_b32 a99, 0
    v_accvgpr_write_b32 a100, 0
    v_accvgpr_write_b32 a101, 0
    v_accvgpr_write_b32 a102, 0
    v_accvgpr_write_b32 a103, 0
    v_accvgpr_write_b32 a104, 0
    v_accvgpr_write_b32 a105, 0
    v_accvgpr_write_b32 a106, 0
    v_accvgpr_write_b32 a107, 0
    v_accvgpr_write_b32 a108, 0
    v_accvgpr_write_b32 a109, 0
    v_accvgpr_write_b32 a110, 0
    v_accvgpr_write_b32 a111, 0
    v_accvgpr_write_b32 a112, 0
    v_accvgpr_write_b32 a113, 0
    v_accvgpr_write_b32 a114, 0
    v_accvgpr_write_b32 a115, 0
    v_accvgpr_write_b32 a116, 0
    v_accvgpr_write_b32 a117, 0
    v_accvgpr_write_b32 a118, 0
    v_accvgpr_write_b32 a119, 0
    v_accvgpr_write_b32 a120, 0
    v_accvgpr_write_b32 a121, 0
    v_accvgpr_write_b32 a122, 0
    v_accvgpr_write_b32 a123, 0
    v_accvgpr_write_b32 a124, 0
    v_accvgpr_write_b32 a125, 0
    v_accvgpr_write_b32 a126, 0
    v_accvgpr_write_b32 a127, 0
    v_mov_b32 v254, 0
    v_mov_b32 v255, 0
    s_mov_b32 s36, 0
L_ex2:
    buffer_load_dwordx4 a[192:195], v157, s[8:11], s36 offen offset:0
    buffer_load_dwordx4 a[196:199], v157, s[8:11], s36 offen offset:32
    buffer_load_dwordx4 a[200:203], v157, s[8:11], s36 offen offset:64
    buffer_load_dwordx4 a[204:207], v157, s[8:11], s36 offen offset:96
    buffer_load_dwordx4 a[208:211], v157, s[8:11], s36 offen offset:128
    buffer_load_dwordx4 a[212:215], v157, s[8:11], s36 offen offset:160
    buffer_load_dwordx4 a[216:219], v157, s[8:11], s36 offen offset:192
    buffer_load_dwordx4 a[220:223], v157, s[8:11], s36 offen offset:224
    s_waitcnt vmcnt(0)
    v_mfma_f32_32x32x16_bf16 v[64:79], a[192:195], v[0:3], v[192:207]
    v_mfma_f32_32x32x16_bf16 v[80:95], a[192:195], v[8:11], v[208:223]
    v_mfma_f32_32x32x16_bf16 v[64:79], a[196:199], v[4:7], v[64:79]
    v_mfma_f32_32x32x16_bf16 v[80:95], a[196:199], v[12:15], v[80:95]
    v_mfma_f32_32x32x16_bf16 v[64:79], a[200:203], v[16:19], v[64:79]
    v_mfma_f32_32x32x16_bf16 v[80:95], a[200:203], v[24:27], v[80:95]
    v_mfma_f32_32x32x16_bf16 v[64:79], a[204:207], v[20:23], v[64:79]
    v_mfma_f32_32x32x16_bf16 v[80:95], a[204:207], v[28:31], v[80:95]
    v_mfma_f32_32x32x16_bf16 v[64:79], a[208:211], v[32:35], v[64:79]
    v_mfma_f32_32x32x16_bf16 v[80:95], a[208:211], v[40:43], v[80:95]
    v_mfma_f32_32x32x16_bf16 v[64:79], a[212:215], v[36:39], v[64:79]
    v_mfma_f32_32x32x16_bf16 v[80:95], a[212:215], v[44:47], v[80:95]
    v_mfma_f32_32x32x16_bf16 v[64:79], a[216:219], v[48:51], v[64:79]
    v_mfma_f32_32x32x16_bf16 v[80:95], a[216:219], v[56:59], v[80:95]
    v_mfma_f32_32x32x16_bf16 v[64:79], a[220:223], v[52:55], v[64:79]
    v_mfma_f32_32x32x16_bf16 v[80:95], a[220:223], v[60:63], v[80:95]
    s_nop 10
    v_exp_f32 v64, v64
    v_exp_f32 v65, v65
    v_add_f32 v254, v254, v64
    v_exp_f32 v66, v66
    v_add_f32 v254, v254, v65
    v_cvt_pk_bf16_f32 v224, v64, v65
    v_exp_f32 v67, v67
    v_add_f32 v254, v254, v66
    v_exp_f32 v68, v68
    v_add_f32 v254, v254, v67
    v_cvt_pk_bf16_f32 v225, v66, v67
    v_exp_f32 v69, v69
    v_add_f32 v254, v254, v68
    v_exp_f32 v70, v70
    v_add_f32 v254, v254, v69
    v_cvt_pk_bf16_f32 v226, v68, v69
    v_exp_f32 v71, v71
    v_add_f32 v254, v254, v70
    v_exp_f32 v80, v80
    v_add_f32 v254, v254, v71
    v_cvt_pk_bf16_f32 v227, v70, v71
    v_exp_f32 v81, v81
    v_add_f32 v255, v255, v80
    v_exp_f32 v82, v82
    v_add_f32 v255, v255, v81
    v_cvt_pk_bf16_f32 v232, v80, v81
    v_exp_f32 v83, v83
    v_add_f32 v255, v255, v82
    v_exp_f32 v84, v84
    v_add_f32 v255, v255, v83
    v_cvt_pk_bf16_f32 v233, v82, v83
    v_exp_f32 v85, v85
    v_add_f32 v255, v255, v84
    v_exp_f32 v86, v86
    v_add_f32 v255, v255, v85
    v_cvt_pk_bf16_f32 v234, v84, v85
    v_exp_f32 v87, v87
    v_add_f32 v255, v255, v86
    v_exp_f32 v72, v72
    v_add_f32 v255, v255, v87
    v_cvt_pk_bf16_f32 v235, v86, v87
    v_exp_f32 v73, v73
    v_add_f32 v254, v254, v72
    v_exp_f32 v74, v74
    v_add_f32 v254, v254, v73
    v_cvt_pk_bf16_f32 v228, v72, v73
    v_exp_f32 v75, v75
    v_add_f32 v254, v254, v74
    v_exp_f32 v76, v76
    v_add_f32 v254, v254, v75
    v_cvt_pk_bf16_f32 v229, v74, v75
    v_exp_f32 v77, v77
    v_add_f32 v254, v254, v76
    v_exp_f32 v78, v78
    v_add_f32 v254, v254, v77
    v_cvt_pk_bf16_f32 v230, v76, v77
    v_exp_f32 v79, v79
    v_add_f32 v254, v254, v78
    v_exp_f32 v88, v88
    v_add_f32 v254, v254, v79
    v_cvt_pk_bf16_f32 v231, v78, v79
    v_exp_f32 v89, v89
    v_add_f32 v255, v255, v88
    v_exp_f32 v90, v90
    v_add_f32 v255, v255, v89
    v_cvt_pk_bf16_f32 v236, v88, v89
    v_exp_f32 v91, v91
    v_add_f32 v255, v255, v90
    v_exp_f32 v92, v92
    v_add_f32 v255, v255, v91
    v_cvt_pk_bf16_f32 v237, v90, v91
    v_exp_f32 v93, v93
    v_add_f32 v255, v255, v92
    v_exp_f32 v94, v94
    v_add_f32 v255, v255, v93
    v_cvt_pk_bf16_f32 v238, v92, v93
    v_exp_f32 v95, v95
    v_add_f32 v255, v255, v94
    v_add_f32_e64 v255, v255, v95
    v_cvt_pk_bf16_f32 v239, v94, v95
    buffer_load_dwordx4 v158, s[12:15], s36 offen offset:0 lds
    buffer_load_dwordx4 v158, s[12:15], s36 offen offset:1024 lds
    buffer_load_dwordx4 v158, s[12:15], s36 offen offset:2048 lds
    buffer_load_dwordx4 v158, s[12:15], s36 offen offset:3072 lds
    s_add_u32 s36, s36, 4096
    s_waitcnt vmcnt(0)
    ds_read_b64_tr_b16 a[160:161], v160 offset:0
    ds_read_b64_tr_b16 a[162:163], v160 offset:2048
    ds_read_b64_tr_b16 a[164:165], v161 offset:0
    ds_read_b64_tr_b16 a[166:167], v161 offset:2048
    ds_read_b64_tr_b16 a[168:169], v162 offset:0
    ds_read_b64_tr_b16 a[170:171], v162 offset:2048
    ds_read_b64_tr_b16 a[172:173], v163 offset:0
    ds_read_b64_tr_b16 a[174:175], v163 offset:2048
    s_waitcnt lgkmcnt(0)
    v_mfma_f32_32x32x16_bf16 a[0:15], a[160:163], v[224:227], a[0:15]
    v_mfma_f32_32x32x16_bf16 a[16:31], a[160:163], v[232:235], a[16:31]
    v_mfma_f32_32x32x16_bf16 a[32:47], a[164:167], v[224:227], a[32:47]
    v_mfma_f32_32x32x16_bf16 a[48:63], a[164:167], v[232:235], a[48:63]
    v_mfma_f32_32x32x16_bf16 a[64:79], a[168:171], v[224:227], a[64:79]
    v_mfma_f32_32x32x16_bf16 a[80:95], a[168:171], v[232:235], a[80:95]
    v_mfma_f32_32x32x16_bf16 a[96:111], a[172:175], v[224:227], a[96:111]
    v_mfma_f32_32x32x16_bf16 a[112:127], a[172:175], v[232:235], a[112:127]
    buffer_load_dwordx4 v158, s[12:15], s36 offen offset:0 lds
    buffer_load_dwordx4 v158, s[12:15], s36 offen offset:1024 lds
    buffer_load_dwordx4 v158, s[12:15], s36 offen offset:2048 lds
    buffer_load_dwordx4 v158, s[12:15], s36 offen offset:3072 lds
    s_add_u32 s36, s36, 4096
    s_waitcnt vmcnt(0)
    ds_read_b64_tr_b16 a[176:177], v160 offset:0
    ds_read_b64_tr_b16 a[178:179], v160 offset:2048
    ds_read_b64_tr_b16 a[180:181], v161 offset:0
    ds_read_b64_tr_b16 a[182:183], v161 offset:2048
    ds_read_b64_tr_b16 a[184:185], v162 offset:0
    ds_read_b64_tr_b16 a[186:187], v162 offset:2048
    ds_read_b64_tr_b16 a[188:189], v163 offset:0
    ds_read_b64_tr_b16 a[190:191], v163 offset:2048
    s_waitcnt lgkmcnt(0)
    v_mfma_f32_32x32x16_bf16 a[0:15], a[176:179], v[228:231], a[0:15]
    v_mfma_f32_32x32x16_bf16 a[16:31], a[176:179], v[236:239], a[16:31]
    v_mfma_f32_32x32x16_bf16 a[32:47], a[180:183], v[228:231], a[32:47]
    v_mfma_f32_32x32x16_bf16 a[48:63], a[180:183], v[236:239], a[48:63]
    v_mfma_f32_32x32x16_bf16 a[64:79], a[184:187], v[228:231], a[64:79]
    v_mfma_f32_32x32x16_bf16 a[80:95], a[184:187], v[236:239], a[80:95]
    v_mfma_f32_32x32x16_bf16 a[96:111], a[188:191], v[228:231], a[96:111]
    v_mfma_f32_32x32x16_bf16 a[112:127], a[188:191], v[236:239], a[112:127]
    s_cmp_lt_u32 s36, 131072
    s_cbranch_scc1 L_ex2
    v_mov_b32 v164, v254
    v_mov_b32 v165, v255
    s_nop 0
    v_permlane32_swap_b32 v254, v164
    v_permlane32_swap_b32 v255, v165
    v_add_f32 v254, v254, v164
    v_add_f32 v255, v255, v165
    v_mov_b32 v128, 0
    v_mov_b32 v129, 0
    v_mov_b32 v130, 0
    v_mov_b32 v131, 0
    v_mov_b32 v132, 0
    v_mov_b32 v133, 0
    v_mov_b32 v134, 0
    v_mov_b32 v135, 0
    v_mov_b32 v136, 0
    v_mov_b32 v137, 0
    v_mov_b32 v138, 0
    v_mov_b32 v139, 0
    v_mov_b32 v140, 0
    v_mov_b32 v141, 0
    v_mov_b32 v142, 0
    v_mov_b32 v143, 0
    v_mbcnt_lo_u32_b32 v90, -1, 0
    v_mbcnt_hi_u32_b32 v90, -1, v90
    s_nop 15
    s_branch L_exact_ret
L_codeend:
.section .rodata,"a"
.p2align 6
.amdhsa_kernel adaLN_cond__sliding_block_cached__glu_gated_bilinear__prompt_kernel
  .amdhsa_next_free_vgpr 512
  .amdhsa_next_free_sgpr 102
  .amdhsa_accum_offset 256
  .amdhsa_group_segment_fixed_size 0
  .amdhsa_kernarg_size 112
  .amdhsa_user_sgpr_count 2
  .amdhsa_user_sgpr_kernarg_segment_ptr 1
  .amdhsa_system_sgpr_workgroup_id_x 1
  .amdhsa_float_denorm_mode_32 3
  .amdhsa_float_denorm_mode_16_64 3
.end_amdhsa_kernel
```
